```python
import torch

def _softmax(x, axis=-1):
    return torch.softmax(x, dim=axis)
def _gelu(x):
    return torch.nn.functional.gelu(x, approximate="tanh")
def _silu(x):
    return torch.nn.functional.silu(x)
def _sigmoid(x):
    return torch.sigmoid(x)
def _layernorm(x, axis=-1, eps=1e-5):
    m = x.mean(dim=axis, keepdim=True)
    v = x.var(dim=axis, keepdim=True, unbiased=False)
    return (x - m) / torch.sqrt(v + eps)
def _scatter_add(tgt, idx, src, axis=0):
    return tgt.clone().index_add_(axis, idx, src)
def _segment_sum(src, seg, n):
    out = torch.zeros((n,) + src.shape[1:], dtype=src.dtype)
    return out.index_add_(0, seg, src)
def _pad(x, pw):
    flat = tuple(v for pair in reversed(pw) for v in pair)
    return torch.nn.functional.pad(x, flat)

kernel_name = 'interleave_layers__grouped_kv_mqa__mixer_channel_mlp__prompt'

def setup_inputs():

    _w = (lambda a: (lambda t: t.to(torch.bfloat16) if t.is_floating_point() else t)(torch.as_tensor(a)))
    def _A_setup():
        B, S, D, H = 1, 2048, 1024, 32
        Dh = D // H
        return {
            "x": _w((lambda *s: torch.randn(*s, dtype=torch.bfloat16) * 0.05)(B, S, D)),
            "wq": _w((lambda *s: torch.randn(*s, dtype=torch.bfloat16) * 0.05)(D, H * Dh)),
            "wk": _w((lambda *s: torch.randn(*s, dtype=torch.bfloat16) * 0.05)(D, Dh)),
            "wv": _w((lambda *s: torch.randn(*s, dtype=torch.bfloat16) * 0.05)(D, Dh)),
            "wo": _w((lambda *s: torch.randn(*s, dtype=torch.bfloat16) * 0.05)(H * Dh, D)),
        }
    _A_in = _A_setup()

    def _B_setup():
        B, S, D, F = 1, 2048, 1024, 3584
        return {
            "x": _w((lambda *s: torch.randn(*s, dtype=torch.bfloat16) * 0.05)(B, S, D)),
            "w1": _w((lambda *s: torch.randn(*s, dtype=torch.bfloat16) * 3.2)(D, F) * (D ** -0.5)),
            "b1": _w((lambda *s: torch.randn(*s, dtype=torch.bfloat16) * 1.6)(F)),
            "w2": _w((lambda *s: torch.randn(*s, dtype=torch.bfloat16) * 0.8)(F, D) * (F ** -0.5)),
            "b2": _w((lambda *s: torch.randn(*s, dtype=torch.bfloat16) * 0.8)(D)),
        }
    _B_in = _B_setup()

    return {
        "A_x": _A_in["x"],
        "A_wq": _A_in["wq"],
        "A_wk": _A_in["wk"],
        "A_wv": _A_in["wv"],
        "A_wo": _A_in["wo"],
        "B_x": _B_in["x"],
        "B_w1": _B_in["w1"],
        "B_b1": _B_in["b1"],
        "B_w2": _B_in["w2"],
        "B_b2": _B_in["b2"],
    }

def reference(A_x, A_wq, A_wk, A_wv, A_wo, B_x, B_w1, B_b1, B_w2, B_b2):
    def _A_ref(x, wq, wk, wv, wo):
        B, S, D = x.shape
        H = 32
        Dh = D // H
        q = (lambda x, *d: x.permute(*d))((x @ wq).reshape(B, S, H, Dh), 0, 2, 1, 3)
        k = x @ wk
        v = x @ wv
        scores = torch.einsum("bhqd,bkd->bhqk", q, k) * (Dh ** -0.5)
        p = _softmax(scores, axis=-1)
        o = torch.einsum("bhqk,bkd->bhqd", p, v)
        return (lambda x, *d: x.permute(*d))(o, 0, 2, 1, 3).reshape(B, S, H * Dh) @ wo

    def _B_ref(x, w1, b1, w2, b2):
        y = _layernorm(x, axis=-1)
        h = _gelu(torch.einsum("bsd,df->bsf", y, w1) + b1)
        return torch.einsum("bsf,fd->bsd", h, w2) + b2

    x = A_x
    x = x + _A_ref(_layernorm(x, axis=-1), A_wq, A_wk, A_wv, A_wo)
    x = x + _B_ref(_layernorm(x, axis=-1), B_w1, B_b1, B_w2, B_b2)
    x = x + _A_ref(_layernorm(x, axis=-1), A_wq, A_wk, A_wv, A_wo)
    x = x + _B_ref(_layernorm(x, axis=-1), B_w1, B_b1, B_w2, B_b2)
    return x
```

```asm
; @launch grid=(256,1,1) block=(512,1,1) lds=163840
.amdgcn_target "amdgcn-amd-amdhsa--gfx950"
.text
.globl interleave_layers__grouped_kv_mqa__mixer_channel_mlp__prompt_kernel
.p2align 8
.type interleave_layers__grouped_kv_mqa__mixer_channel_mlp__prompt_kernel,@function
interleave_layers__grouped_kv_mqa__mixer_channel_mlp__prompt_kernel:
    s_getpc_b64 s[100:101]
.Lcode_pc:
    v_cmp_lt_u32 vcc, 0x1bf, v0
    s_cbranch_vccz .Lnopf_2
    s_lshr_b32 s42, s2, 3
    s_lshl_b32 s42, s42, 11
    v_and_b32 v9, 15, v0
    v_lshl_add_u32 v9, v9, 7, s42
    v_min_u32 v9, .Lcode_end - .Lcode_pc - 4, v9
    global_load_dword v11, v9, s[100:101]
.Lnopf_2:
    s_load_dwordx4 s[4:7], s[0:1], 0
    s_load_dwordx4 s[96:99], s[0:1], 88
    s_load_dwordx4 s[8:11], s[0:1], 16
    s_load_dwordx2 s[12:13], s[0:1], 32
    s_load_dwordx4 s[16:19], s[0:1], 48
    s_load_dwordx2 s[14:15], s[0:1], 64
    s_load_dwordx4 s[92:95], s[0:1], 72
    s_cmp_ge_u32 s2, 256
    s_cbranch_scc1 .Ldone_1
    v_lshrrev_b32 v4, 6, v0
    v_and_b32 v0, 63, v0
    v_readfirstlane_b32 s20, v4
    v_lshlrev_b32 v1, 4, v0
    v_mov_b32 v2, 0
    v_mov_b32 v3, 0
    s_and_b32 s42, s2, 7
    s_lshr_b32 s43, s2, 3
    s_lshr_b32 s22, s42, 1
    s_lshl_b32 s22, s22, 2
    s_and_b32 s44, s43, 3
    s_add_u32 s22, s22, s44
    s_lshr_b32 s23, s43, 2
    s_lshl_b32 s23, s23, 1
    s_and_b32 s44, s42, 1
    s_add_u32 s23, s23, s44
    s_and_b32 s21, s20, 3
    s_lshl_b32 s59, s22, 2
    s_add_u32 s59, s59, s21
    s_mov_b32 s53, 0x07060302
    s_mov_b32 s54, 0xffff0000
    s_mov_b32 s40, 0x1600000
    s_mov_b32 s41, 0
    s_waitcnt lgkmcnt(0)
    s_mov_b32 s24, s98
    s_mov_b32 s25, s99
    s_mov_b32 s26, 0x5c00000
    s_mov_b32 s27, 0x20000
    s_mov_b32 s68, s96
    s_mov_b32 s69, s97
    s_mov_b32 s70, 0x100
    s_mov_b32 s71, 0x20000
    s_add_u32 s98, s98, 0x3200000
    s_addc_u32 s99, s99, 0
    s_mov_b32 s28, s98
    s_mov_b32 s29, s99
    s_mov_b32 s30, 0x40000
    s_mov_b32 s31, 0x20000
    s_cmp_lt_u32 s20, 4
    s_cbranch_scc1 .Lcinit_6
    s_mov_b32 s32, s6
    s_mov_b32 s33, s7
    s_mov_b32 s34, 0x200000
    s_mov_b32 s35, 0x20000
    v_lshrrev_b32 v8, 3, v0
    v_and_b32 v4, 6, v8
    v_and_b32 v5, 7, v0
    v_xor_b32 v4, v4, v5
    v_lshlrev_b32 v8, 11, v8
    v_lshl_add_u32 v8, v4, 4, v8
    s_lshl_b32 s42, s23, 7
    s_mov_b32 s87, s42
    s_lshl_b32 s86, s23, 1
    s_add_u32 s86, s86, 2
    s_lshl_b32 s43, s59, 15
    s_add_u32 s42, s42, s43
    v_and_b32 v9, 15, v0
    v_lshlrev_b32 v10, 11, v9
    buffer_load_dword v16, v10, s[32:35], s42 offen
    s_bitcmp1_b32 s23, 0
    s_cselect_b32 s8, s10, s8
    s_cselect_b32 s9, s11, s9
    s_mov_b32 s64, s8
    s_mov_b32 s65, s9
    s_mov_b32 s66, 0x10000
    s_mov_b32 s67, 0x20000
    s_lshr_b32 s42, s2, 3
    s_lshl_b32 s42, s42, 11
    v_and_b32 v9, 15, v0
    v_lshlrev_b32 v9, 7, v9
    buffer_load_dword v7, v9, s[64:67], s42 offen
    s_barrier
    s_branch .Llinit_5
.Lcinit_6:
    s_lshl_b32 s45, s21, 8
    s_add_u32 s45, s45, s2
    s_cmp_ge_u32 s45, 5
    s_cbranch_scc1 .Lnoz_7
    s_mul_i32 s42, s2, 81920
    s_add_u32 s42, s42, 0x32c0000
    v_lshrrev_b32 v4, 3, v0
    v_mul_u32_u24 v4, 1152, v4
    v_add_u32 v4, v4, v1
    v_mov_b32 v44, 0
    v_mov_b32 v45, 0
    v_mov_b32 v46, 0
    v_mov_b32 v47, 0
    buffer_store_dwordx4 v[44:47], v4, s[24:27], s42 offen sc1
    s_add_u32 s42, s42, 10240
    buffer_store_dwordx4 v[44:47], v4, s[24:27], s42 offen sc1
    s_add_u32 s42, s42, 10240
    buffer_store_dwordx4 v[44:47], v4, s[24:27], s42 offen sc1
    s_add_u32 s42, s42, 10240
    buffer_store_dwordx4 v[44:47], v4, s[24:27], s42 offen sc1
    s_add_u32 s42, s42, 10240
    buffer_store_dwordx4 v[44:47], v4, s[24:27], s42 offen sc1
    s_add_u32 s42, s42, 10240
    buffer_store_dwordx4 v[44:47], v4, s[24:27], s42 offen sc1
    s_add_u32 s42, s42, 10240
    buffer_store_dwordx4 v[44:47], v4, s[24:27], s42 offen sc1
    s_add_u32 s42, s42, 10240
    buffer_store_dwordx4 v[44:47], v4, s[24:27], s42 offen sc1
    s_add_u32 s42, s42, 10240
.Lnoz_7:
    s_mov_b32 s64, s4
    s_mov_b32 s65, s5
    s_mov_b32 s66, 0x400000
    s_mov_b32 s67, 0x20000
    s_lshl_b32 s42, s59, 16
    s_lshl_b32 s43, s23, 7
    s_add_u32 s42, s42, s43
    v_and_b32 v8, 15, v0
    v_lshl_add_u32 v8, v8, 11, s42
    v_bfe_u32 v9, v0, 4, 1
    v_lshl_add_u32 v8, v9, 5, v8
    v_lshrrev_b32 v9, 5, v0
    v_lshl_add_u32 v8, v9, 4, v8
    v_add_u32 v9, 0x8000, v8
    s_barrier
    buffer_load_dwordx4 v[48:51], v8, s[64:67], 0 offen offset:0
    buffer_load_dwordx4 v[52:55], v9, s[64:67], 0 offen offset:0
    buffer_load_dwordx4 v[56:59], v8, s[64:67], 0 offen offset:64
    buffer_load_dwordx4 v[60:63], v9, s[64:67], 0 offen offset:64
    s_cmp_ge_u32 s45, 5
    s_cbranch_scc1 .Lnoz_8
    v_mov_b32 v5, 1
    s_lshl_b32 s43, s2, 2
    s_cselect_b32 s44, 124, 0
    s_add_u32 s43, s43, s44
    s_mov_b64 exec, 1
    s_waitcnt vmcnt(4)
    buffer_store_dword v5, v2, s[68:71], s43 offen sc1
    s_mov_b64 exec, -1
.Lnoz_8:
    s_mov_b32 s36, s92
    s_mov_b32 s37, s93
    s_mov_b32 s38, 0x800
    s_mov_b32 s39, 0x20000
    s_mov_b32 s32, s94
    s_mov_b32 s33, s95
    s_mov_b32 s34, 0x400000
    s_mov_b32 s35, 0x20000
    s_mul_i32 s4, s22, 262144
    s_lshl_b32 s46, s21, 11
    s_add_u32 s4, s4, s46
    s_add_u32 s4, s4, s40
    s_lshl_b32 s42, s23, 14
    s_add_u32 s5, s4, s42
    s_mul_i32 s6, s22, 917504
    s_lshl_b32 s46, s21, 11
    s_add_u32 s6, s6, s46
    s_add_u32 s6, s6, s40
    s_add_u32 s6, s6, 0xd80000
    s_and_b32 s43, s23, 1
    s_mul_i32 s44, s43, 458752
    s_add_u32 s6, s6, s44
    s_lshr_b32 s44, s23, 1
    s_lshl_b32 s42, s44, 13
    s_add_u32 s7, s6, s42
    s_lshl_b32 s45, s59, 1
    s_add_u32 s45, s45, s43
    s_mul_i32 s11, s45, 1280
    s_add_u32 s11, s11, s40
    s_add_u32 s11, s11, 0x1cc0000
    s_mul_i32 s9, s59, 1280
    s_add_u32 s9, s9, s40
    s_add_u32 s9, s9, 0x1cc0000
    s_movk_i32 s43, 0x2000
    s_movk_i32 s45, 0x4000
    s_cmp_eq_u32 s44, 1
    s_cselect_b32 s72, s45, s43
    s_cmp_eq_u32 s44, 2
    s_cselect_b32 s73, s45, s43
    s_cmp_eq_u32 s44, 3
    s_cselect_b32 s74, s45, s43
    s_cmp_eq_u32 s44, 4
    s_cselect_b32 s75, s45, s43
    s_cmp_eq_u32 s44, 5
    s_cselect_b32 s76, s45, s43
    s_cmp_eq_u32 s44, 6
    s_cselect_b32 s77, s45, s43
    s_cmp_eq_u32 s44, 7
    s_cselect_b32 s78, s45, s43
    s_cmp_eq_u32 s44, 0
    s_cselect_b32 s78, s45, s78
    s_cselect_b32 s43, s43, 0
    s_add_u32 s6, s6, s43
    s_lshl_b32 s44, s59, 4
    s_add_u32 s44, s44, s23
    s_lshl_b32 s10, s44, 8
    s_add_u32 s10, s10, s40
    s_lshl_b32 s8, s44, 12
    s_add_u32 s8, s8, 0x3500000
    s_lshr_b32 s45, s44, 1
    s_mul_i32 s12, s45, 1280
    s_add_u32 s12, s12, s40
    s_add_u32 s12, s12, 0x1cc0000
    v_and_b32 v14, 15, v0
    v_lshlrev_b32 v14, 4, v14
    v_lshrrev_b32 v4, 4, v0
    v_lshl_add_u32 v14, v4, 2, v14
    s_mov_b32 s42, s5
    s_add_u32 s43, s42, 8192
    s_waitcnt vmcnt(0)
    v_permlane16_swap_b32 v48, v50
    v_permlane16_swap_b32 v49, v51
    buffer_store_dwordx4 v[48:51], v1, s[24:27], s42 offen offset:0 sc1
    v_permlane16_swap_b32 v52, v54
    v_permlane16_swap_b32 v53, v55
    buffer_store_dwordx4 v[52:55], v1, s[24:27], s42 offen offset:1024 sc1
    v_permlane16_swap_b32 v56, v58
    v_permlane16_swap_b32 v57, v59
    buffer_store_dwordx4 v[56:59], v1, s[24:27], s43 offen offset:0 sc1
    v_permlane16_swap_b32 v60, v62
    v_permlane16_swap_b32 v61, v63
    buffer_store_dwordx4 v[60:63], v1, s[24:27], s43 offen offset:1024 sc1
    s_lshl_b32 s44, s2, 2
    s_add_u32 s44, s44, s21
    s_mul_i32 s44, s44, 1280
    s_add_u32 s44, s44, 0x32c0000
    s_mov_b32 s45, 36208640
    v_mov_b32 v10, 491520
    v_lshrrev_b32 v12, 3, v0
    v_min_u32 v12, 1, v12
    v_mul_lo_u32 v12, v12, s45
    v_bfe_u32 v13, v0, 4, 1
    v_mul_u32_u24 v13, 491520, v13
    v_add3_u32 v10, v10, v12, v13
    v_and_b32 v12, 7, v0
    v_lshl_add_u32 v10, v12, 4, v10
    v_mov_b32 v44, 0
    v_mov_b32 v45, 0
    v_mov_b32 v46, 0
    v_mov_b32 v47, 0
    s_mov_b64 exec, 0xffffff
    buffer_store_dwordx4 v[44:47], v10, s[24:27], s44 offen sc1
    s_mov_b64 exec, -1
    v_lshlrev_b32 v224, 16, v48
    v_and_b32 v225, s54, v48
    v_lshlrev_b32 v226, 16, v49
    v_and_b32 v227, s54, v49
    v_lshlrev_b32 v232, 16, v50
    v_and_b32 v233, s54, v50
    v_lshlrev_b32 v234, 16, v51
    v_and_b32 v235, s54, v51
    v_lshlrev_b32 v228, 16, v52
    v_and_b32 v229, s54, v52
    v_lshlrev_b32 v230, 16, v53
    v_and_b32 v231, s54, v53
    v_lshlrev_b32 v236, 16, v54
    v_and_b32 v237, s54, v54
    v_lshlrev_b32 v238, 16, v55
    v_and_b32 v239, s54, v55
    v_lshlrev_b32 v240, 16, v56
    v_and_b32 v241, s54, v56
    v_lshlrev_b32 v242, 16, v57
    v_and_b32 v243, s54, v57
    v_lshlrev_b32 v248, 16, v58
    v_and_b32 v249, s54, v58
    v_lshlrev_b32 v250, 16, v59
    v_and_b32 v251, s54, v59
    v_lshlrev_b32 v244, 16, v60
    v_and_b32 v245, s54, v60
    v_lshlrev_b32 v246, 16, v61
    v_and_b32 v247, s54, v61
    v_lshlrev_b32 v252, 16, v62
    v_and_b32 v253, s54, v62
    v_lshlrev_b32 v254, 16, v63
    v_and_b32 v255, s54, v63
    v_pk_add_f32 v[32:33], v[224:225], v[226:227]
    v_pk_mul_f32 v[34:35], v[224:225], v[224:225]
    v_pk_fma_f32 v[34:35], v[226:227], v[226:227], v[34:35]
    v_pk_add_f32 v[32:33], v[32:33], v[232:233]
    v_pk_fma_f32 v[34:35], v[232:233], v[232:233], v[34:35]
    v_pk_add_f32 v[32:33], v[32:33], v[234:235]
    v_pk_fma_f32 v[34:35], v[234:235], v[234:235], v[34:35]
    v_pk_add_f32 v[32:33], v[32:33], v[240:241]
    v_pk_fma_f32 v[34:35], v[240:241], v[240:241], v[34:35]
    v_pk_add_f32 v[32:33], v[32:33], v[242:243]
    v_pk_fma_f32 v[34:35], v[242:243], v[242:243], v[34:35]
    v_pk_add_f32 v[32:33], v[32:33], v[248:249]
    v_pk_fma_f32 v[34:35], v[248:249], v[248:249], v[34:35]
    v_pk_add_f32 v[32:33], v[32:33], v[250:251]
    v_pk_fma_f32 v[34:35], v[250:251], v[250:251], v[34:35]
    v_pk_add_f32 v[36:37], v[228:229], v[230:231]
    v_pk_mul_f32 v[38:39], v[228:229], v[228:229]
    v_pk_fma_f32 v[38:39], v[230:231], v[230:231], v[38:39]
    v_pk_add_f32 v[36:37], v[36:37], v[236:237]
    v_pk_fma_f32 v[38:39], v[236:237], v[236:237], v[38:39]
    v_pk_add_f32 v[36:37], v[36:37], v[238:239]
    v_pk_fma_f32 v[38:39], v[238:239], v[238:239], v[38:39]
    v_pk_add_f32 v[36:37], v[36:37], v[244:245]
    v_pk_fma_f32 v[38:39], v[244:245], v[244:245], v[38:39]
    v_pk_add_f32 v[36:37], v[36:37], v[246:247]
    v_pk_fma_f32 v[38:39], v[246:247], v[246:247], v[38:39]
    v_pk_add_f32 v[36:37], v[36:37], v[252:253]
    v_pk_fma_f32 v[38:39], v[252:253], v[252:253], v[38:39]
    v_pk_add_f32 v[36:37], v[36:37], v[254:255]
    v_pk_fma_f32 v[38:39], v[254:255], v[254:255], v[38:39]
    v_add_f32 v32, v32, v33
    v_add_f32 v34, v34, v35
    v_add_f32 v36, v36, v37
    v_add_f32 v38, v38, v39
    s_add_u32 s46, s10, 0x1c40000
    s_nop 0
    v_permlane16_swap_b32 v32, v36
    v_permlane16_swap_b32 v34, v38
    v_add_f32 v32, v32, v36
    v_add_f32 v34, v34, v38
    s_nop 1
    v_permlane32_swap_b32 v32, v34
    v_add_f32 v32, v32, v34
    buffer_store_dword v32, v14, s[24:27], s46 offen sc1
    v_mov_b32 v13, 0
    s_mov_b32 s58, 0x40000
.Linit_9:
    buffer_load_dword v15, v13, s[68:71], 0 offen sc1
    s_waitcnt vmcnt(0)
    v_cmp_eq_u32 vcc, 0, v15
    s_cbranch_vccz .Linitok_10
    s_sub_u32 s58, s58, 1
    s_cbranch_scc0 .Linit_9
.Linitok_10:
    s_add_u32 s47, s9, 0x0
    v_mov_b32 v15, 1
    s_waitcnt vmcnt(0)
    s_mov_b64 exec, 1
    buffer_atomic_add v15, v2, s[24:27], s47 offen sc0 sc1
    s_mov_b64 exec, -1
.Lctop_3:
    v_add_u32 v8, 98304, v1
    v_mov_b32 v7, 0xdddd
    v_and_b32 v4, 15, v0
    v_cmp_eq_u32 vcc, 0, v4
    v_cmp_eq_u32 s[60:61], 4, v4
    v_mov_b32 v5, 0x3f803f80
    v_mov_b32 v16, 0
    v_mov_b32 v17, 0
    v_mov_b32 v18, 0
    v_mov_b32 v19, 0
    v_mov_b32 v20, 0
    v_mov_b32 v21, 0
    v_mov_b32 v22, 0
    v_mov_b32 v23, 0
    v_mov_b32 v24, 0
    v_mov_b32 v25, 0
    v_mov_b32 v26, 0
    v_mov_b32 v27, 0
    v_mov_b32 v28, 0
    v_mov_b32 v29, 0
    v_mov_b32 v30, 0
    v_mov_b32 v31, 0
    v_mov_b32 v32, 0
    v_mov_b32 v33, 0
    v_mov_b32 v34, 0
    v_mov_b32 v35, 0
    v_mov_b32 v36, 0
    v_mov_b32 v37, 0
    v_mov_b32 v38, 0
    v_mov_b32 v39, 0
    v_mov_b32 v40, 0
    v_mov_b32 v41, 0
    v_mov_b32 v42, 0
    v_mov_b32 v43, 0
    v_mov_b32 v44, 0
    v_mov_b32 v45, 0
    v_mov_b32 v46, 0
    v_mov_b32 v47, 0
    v_mov_b32 v144, 0
    v_mov_b32 v145, 0
    v_mov_b32 v146, 0
    v_mov_b32 v147, 0
    v_mov_b32 v148, 0
    v_mov_b32 v149, 0
    v_mov_b32 v150, 0
    v_mov_b32 v151, 0
    v_cndmask_b32 v152, 0, v5, vcc
    v_cndmask_b32 v153, 0, v5, vcc
    v_cndmask_b32 v154, 0, v5, s[60:61]
    v_cndmask_b32 v155, 0, v5, s[60:61]
    v_lshlrev_b32 v9, 4, v4
    v_bfe_u32 v6, v0, 4, 1
    v_lshl_add_u32 v9, v6, 10, v9
    v_lshrrev_b32 v6, 5, v0
    v_lshl_add_u32 v9, v6, 8, v9
    v_add_u32 v13, 159744, v1
    v_bfe_u32 v4, v0, 2, 3
    v_lshrrev_b32 v5, 5, v0
    v_lshl_add_u32 v5, v5, 3, v4
    v_lshlrev_b32 v216, 7, v5
    v_lshrrev_b32 v4, 1, v4
    v_lshl_add_u32 v216, v4, 5, v216
    v_and_b32 v4, 3, v0
    v_lshl_add_u32 v216, v4, 3, v216
    v_xor_b32 v217, 32, v216
    v_xor_b32 v218, 64, v216
    v_xor_b32 v219, 96, v216
    s_mov_b32 s50, s4
    s_mov_b32 s79, s5
    s_cmp_eq_u32 s50, s79
    s_cselect_b32 s43, 16384, 0
    s_add_u32 s50, s50, s43
    s_mov_b32 s58, 0x40000
    s_mov_b64 exec, 1
    s_waitcnt vmcnt(0)
    v_cmp_gt_u32 vcc, 15, v15
    s_cbranch_vccz .Lpollok_12
.Lpoll_11:
    v_mov_b32 v15, 0
    buffer_atomic_add v15, v2, s[24:27], s47 offen sc0 sc1
    s_waitcnt vmcnt(0)
    v_cmp_gt_u32 vcc, 16, v15
    s_cbranch_vccz .Lpollok_12
    s_sub_u32 s58, s58, 1
    s_cbranch_scc0 .Lpoll_11
.Lpollok_12:
    s_mov_b64 exec, -1
    buffer_load_dwordx4 v[64:67], v1, s[24:27], s50 offen offset:0 sc1
    buffer_load_dwordx4 v[68:71], v1, s[24:27], s50 offen offset:1024 sc1
    s_add_u32 s50, s50, 8192
    buffer_load_dwordx4 v[72:75], v1, s[24:27], s50 offen offset:0 sc1
    buffer_load_dwordx4 v[76:79], v1, s[24:27], s50 offen offset:1024 sc1
    s_add_u32 s50, s50, 8192
    s_cmp_eq_u32 s50, s79
    s_cselect_b32 s43, 16384, 0
    s_add_u32 s50, s50, s43
    buffer_load_dwordx4 v[80:83], v1, s[24:27], s50 offen offset:0 sc1
    buffer_load_dwordx4 v[84:87], v1, s[24:27], s50 offen offset:1024 sc1
    s_add_u32 s50, s50, 8192
    buffer_load_dwordx4 v[88:91], v1, s[24:27], s50 offen offset:0 sc1
    buffer_load_dwordx4 v[92:95], v1, s[24:27], s50 offen offset:1024 sc1
    s_add_u32 s50, s50, 8192
    s_cmp_eq_u32 s50, s79
    s_cselect_b32 s43, 16384, 0
    s_add_u32 s50, s50, s43
    buffer_load_dwordx4 v[96:99], v1, s[24:27], s50 offen offset:0 sc1
    buffer_load_dwordx4 v[100:103], v1, s[24:27], s50 offen offset:1024 sc1
    s_add_u32 s50, s50, 8192
    buffer_load_dwordx4 v[104:107], v1, s[24:27], s50 offen offset:0 sc1
    buffer_load_dwordx4 v[108:111], v1, s[24:27], s50 offen offset:1024 sc1
    s_add_u32 s50, s50, 8192
    s_cmp_eq_u32 s50, s79
    s_cselect_b32 s43, 16384, 0
    s_add_u32 s50, s50, s43
    s_barrier
    ds_read_b64_tr_b16 v[112:113], v216 offset:0
    ds_read_b64_tr_b16 v[114:115], v216 offset:2048
    ds_read_b64_tr_b16 v[116:117], v217 offset:0
    ds_read_b64_tr_b16 v[118:119], v217 offset:2048
    ds_read_b64_tr_b16 v[120:121], v218 offset:0
    ds_read_b64_tr_b16 v[122:123], v218 offset:2048
    ds_read_b64_tr_b16 v[124:125], v219 offset:0
    ds_read_b64_tr_b16 v[126:127], v219 offset:2048
    ds_read_b64_tr_b16 v[128:129], v216 offset:4096
    ds_read_b64_tr_b16 v[130:131], v216 offset:6144
    s_waitcnt lgkmcnt(6)
    v_mfma_f32_16x16x32_bf16 v[176:179], v[112:115], v[48:51], 0
    ds_read_b64_tr_b16 v[132:133], v217 offset:4096
    ds_read_b64_tr_b16 v[134:135], v217 offset:6144
    v_mfma_f32_16x16x32_bf16 v[180:183], v[112:115], v[52:55], 0
    v_mfma_f32_16x16x32_bf16 v[188:191], v[116:119], v[52:55], 0
    ds_read_b64_tr_b16 v[136:137], v218 offset:4096
    ds_read_b64_tr_b16 v[138:139], v218 offset:6144
    v_mfma_f32_16x16x32_bf16 v[184:187], v[116:119], v[48:51], 0
    s_waitcnt lgkmcnt(6)
    v_mfma_f32_16x16x32_bf16 v[192:195], v[120:123], v[48:51], 0
    ds_read_b64_tr_b16 v[140:141], v219 offset:4096
    ds_read_b64_tr_b16 v[142:143], v219 offset:6144
    v_mfma_f32_16x16x32_bf16 v[196:199], v[120:123], v[52:55], 0
    v_mfma_f32_16x16x32_bf16 v[204:207], v[124:127], v[52:55], 0
    ds_read_b64_tr_b16 v[112:113], v216 offset:8192
    ds_read_b64_tr_b16 v[114:115], v216 offset:10240
    v_mfma_f32_16x16x32_bf16 v[200:203], v[124:127], v[48:51], 0
    s_waitcnt lgkmcnt(6)
    v_mfma_f32_16x16x32_bf16 v[176:179], v[128:131], v[56:59], v[176:179]
    ds_read_b64_tr_b16 v[116:117], v217 offset:8192
    ds_read_b64_tr_b16 v[118:119], v217 offset:10240
    v_mfma_f32_16x16x32_bf16 v[180:183], v[128:131], v[60:63], v[180:183]
    buffer_load_dwordx4 v[48:51], v1, s[24:27], s50 offen offset:0 sc1
    v_mfma_f32_16x16x32_bf16 v[188:191], v[132:135], v[60:63], v[188:191]
    ds_read_b64_tr_b16 v[120:121], v218 offset:8192
    ds_read_b64_tr_b16 v[122:123], v218 offset:10240
    v_mfma_f32_16x16x32_bf16 v[184:187], v[132:135], v[56:59], v[184:187]
    buffer_load_dwordx4 v[52:55], v1, s[24:27], s50 offen offset:1024 sc1
    s_waitcnt lgkmcnt(6)
    v_mfma_f32_16x16x32_bf16 v[192:195], v[136:139], v[56:59], v[192:195]
    ds_read_b64_tr_b16 v[124:125], v219 offset:8192
    ds_read_b64_tr_b16 v[126:127], v219 offset:10240
    v_mfma_f32_16x16x32_bf16 v[196:199], v[136:139], v[60:63], v[196:199]
    s_add_u32 s50, s50, 8192
    v_mfma_f32_16x16x32_bf16 v[204:207], v[140:143], v[60:63], v[204:207]
    ds_read_b64_tr_b16 v[128:129], v216 offset:12288
    ds_read_b64_tr_b16 v[130:131], v216 offset:14336
    v_mfma_f32_16x16x32_bf16 v[200:203], v[140:143], v[56:59], v[200:203]
    s_waitcnt vmcnt(12) lgkmcnt(6)
    v_mfma_f32_16x16x32_bf16 v[176:179], v[112:115], v[64:67], v[176:179]
    ds_read_b64_tr_b16 v[132:133], v217 offset:12288
    ds_read_b64_tr_b16 v[134:135], v217 offset:14336
    v_mfma_f32_16x16x32_bf16 v[180:183], v[112:115], v[68:71], v[180:183]
    buffer_load_dwordx4 v[56:59], v1, s[24:27], s50 offen offset:0 sc1
    v_mfma_f32_16x16x32_bf16 v[188:191], v[116:119], v[68:71], v[188:191]
    ds_read_b64_tr_b16 v[136:137], v218 offset:12288
    ds_read_b64_tr_b16 v[138:139], v218 offset:14336
    v_mfma_f32_16x16x32_bf16 v[184:187], v[116:119], v[64:67], v[184:187]
    buffer_load_dwordx4 v[60:63], v1, s[24:27], s50 offen offset:1024 sc1
    s_waitcnt lgkmcnt(6)
    v_mfma_f32_16x16x32_bf16 v[192:195], v[120:123], v[64:67], v[192:195]
    ds_read_b64_tr_b16 v[140:141], v219 offset:12288
    ds_read_b64_tr_b16 v[142:143], v219 offset:14336
    v_mfma_f32_16x16x32_bf16 v[196:199], v[120:123], v[68:71], v[196:199]
    s_add_u32 s50, s50, 8192
    s_cmp_eq_u32 s50, s79
    s_cselect_b32 s43, 16384, 0
    s_add_u32 s50, s50, s43
    v_mfma_f32_16x16x32_bf16 v[204:207], v[124:127], v[68:71], v[204:207]
    ds_read_b64_tr_b16 v[112:113], v216 offset:16384
    ds_read_b64_tr_b16 v[114:115], v216 offset:18432
    v_mfma_f32_16x16x32_bf16 v[200:203], v[124:127], v[64:67], v[200:203]
    s_waitcnt vmcnt(12) lgkmcnt(6)
    v_mfma_f32_16x16x32_bf16 v[176:179], v[128:131], v[72:75], v[176:179]
    ds_read_b64_tr_b16 v[116:117], v217 offset:16384
    ds_read_b64_tr_b16 v[118:119], v217 offset:18432
    v_mfma_f32_16x16x32_bf16 v[180:183], v[128:131], v[76:79], v[180:183]
    buffer_load_dwordx4 v[64:67], v1, s[24:27], s50 offen offset:0 sc1
    v_mfma_f32_16x16x32_bf16 v[188:191], v[132:135], v[76:79], v[188:191]
    ds_read_b64_tr_b16 v[120:121], v218 offset:16384
    ds_read_b64_tr_b16 v[122:123], v218 offset:18432
    v_mfma_f32_16x16x32_bf16 v[184:187], v[132:135], v[72:75], v[184:187]
    buffer_load_dwordx4 v[68:71], v1, s[24:27], s50 offen offset:1024 sc1
    s_waitcnt lgkmcnt(6)
    v_mfma_f32_16x16x32_bf16 v[192:195], v[136:139], v[72:75], v[192:195]
    ds_read_b64_tr_b16 v[124:125], v219 offset:16384
    ds_read_b64_tr_b16 v[126:127], v219 offset:18432
    v_mfma_f32_16x16x32_bf16 v[196:199], v[136:139], v[76:79], v[196:199]
    s_add_u32 s50, s50, 8192
    v_mfma_f32_16x16x32_bf16 v[204:207], v[140:143], v[76:79], v[204:207]
    ds_read_b64_tr_b16 v[128:129], v216 offset:20480
    ds_read_b64_tr_b16 v[130:131], v216 offset:22528
    v_mfma_f32_16x16x32_bf16 v[200:203], v[140:143], v[72:75], v[200:203]
    s_waitcnt vmcnt(12) lgkmcnt(6)
    v_mfma_f32_16x16x32_bf16 v[176:179], v[112:115], v[80:83], v[176:179]
    ds_read_b64_tr_b16 v[132:133], v217 offset:20480
    ds_read_b64_tr_b16 v[134:135], v217 offset:22528
    v_mfma_f32_16x16x32_bf16 v[180:183], v[112:115], v[84:87], v[180:183]
    buffer_load_dwordx4 v[72:75], v1, s[24:27], s50 offen offset:0 sc1
    v_mfma_f32_16x16x32_bf16 v[188:191], v[116:119], v[84:87], v[188:191]
    ds_read_b64_tr_b16 v[136:137], v218 offset:20480
    ds_read_b64_tr_b16 v[138:139], v218 offset:22528
    v_mfma_f32_16x16x32_bf16 v[184:187], v[116:119], v[80:83], v[184:187]
    buffer_load_dwordx4 v[76:79], v1, s[24:27], s50 offen offset:1024 sc1
    s_waitcnt lgkmcnt(6)
    v_mfma_f32_16x16x32_bf16 v[192:195], v[120:123], v[80:83], v[192:195]
    ds_read_b64_tr_b16 v[140:141], v219 offset:20480
    ds_read_b64_tr_b16 v[142:143], v219 offset:22528
    v_mfma_f32_16x16x32_bf16 v[196:199], v[120:123], v[84:87], v[196:199]
    s_add_u32 s50, s50, 8192
    s_cmp_eq_u32 s50, s79
    s_cselect_b32 s43, 16384, 0
    s_add_u32 s50, s50, s43
    v_mfma_f32_16x16x32_bf16 v[204:207], v[124:127], v[84:87], v[204:207]
    ds_read_b64_tr_b16 v[112:113], v216 offset:24576
    ds_read_b64_tr_b16 v[114:115], v216 offset:26624
    v_mfma_f32_16x16x32_bf16 v[200:203], v[124:127], v[80:83], v[200:203]
    s_waitcnt vmcnt(12) lgkmcnt(6)
    v_mfma_f32_16x16x32_bf16 v[176:179], v[128:131], v[88:91], v[176:179]
    ds_read_b64_tr_b16 v[116:117], v217 offset:24576
    ds_read_b64_tr_b16 v[118:119], v217 offset:26624
    v_mfma_f32_16x16x32_bf16 v[180:183], v[128:131], v[92:95], v[180:183]
    buffer_load_dwordx4 v[80:83], v1, s[24:27], s50 offen offset:0 sc1
    v_mfma_f32_16x16x32_bf16 v[188:191], v[132:135], v[92:95], v[188:191]
    ds_read_b64_tr_b16 v[120:121], v218 offset:24576
    ds_read_b64_tr_b16 v[122:123], v218 offset:26624
    v_mfma_f32_16x16x32_bf16 v[184:187], v[132:135], v[88:91], v[184:187]
    buffer_load_dwordx4 v[84:87], v1, s[24:27], s50 offen offset:1024 sc1
    s_waitcnt lgkmcnt(6)
    v_mfma_f32_16x16x32_bf16 v[192:195], v[136:139], v[88:91], v[192:195]
    ds_read_b64_tr_b16 v[124:125], v219 offset:24576
    ds_read_b64_tr_b16 v[126:127], v219 offset:26624
    v_mfma_f32_16x16x32_bf16 v[196:199], v[136:139], v[92:95], v[196:199]
    s_add_u32 s50, s50, 8192
    v_mfma_f32_16x16x32_bf16 v[204:207], v[140:143], v[92:95], v[204:207]
    ds_read_b64_tr_b16 v[128:129], v216 offset:28672
    ds_read_b64_tr_b16 v[130:131], v216 offset:30720
    v_mfma_f32_16x16x32_bf16 v[200:203], v[140:143], v[88:91], v[200:203]
    s_waitcnt vmcnt(12) lgkmcnt(6)
    v_mfma_f32_16x16x32_bf16 v[176:179], v[112:115], v[96:99], v[176:179]
    ds_read_b64_tr_b16 v[132:133], v217 offset:28672
    ds_read_b64_tr_b16 v[134:135], v217 offset:30720
    v_mfma_f32_16x16x32_bf16 v[180:183], v[112:115], v[100:103], v[180:183]
    buffer_load_dwordx4 v[88:91], v1, s[24:27], s50 offen offset:0 sc1
    v_mfma_f32_16x16x32_bf16 v[188:191], v[116:119], v[100:103], v[188:191]
    ds_read_b64_tr_b16 v[136:137], v218 offset:28672
    ds_read_b64_tr_b16 v[138:139], v218 offset:30720
    v_mfma_f32_16x16x32_bf16 v[184:187], v[116:119], v[96:99], v[184:187]
    buffer_load_dwordx4 v[92:95], v1, s[24:27], s50 offen offset:1024 sc1
    s_waitcnt lgkmcnt(6)
    v_mfma_f32_16x16x32_bf16 v[192:195], v[120:123], v[96:99], v[192:195]
    ds_read_b64_tr_b16 v[140:141], v219 offset:28672
    ds_read_b64_tr_b16 v[142:143], v219 offset:30720
    v_mfma_f32_16x16x32_bf16 v[196:199], v[120:123], v[100:103], v[196:199]
    s_add_u32 s50, s50, 8192
    s_cmp_eq_u32 s50, s79
    s_cselect_b32 s43, 16384, 0
    s_add_u32 s50, s50, s43
    v_mfma_f32_16x16x32_bf16 v[204:207], v[124:127], v[100:103], v[204:207]
    ds_read_b64_tr_b16 v[112:113], v216 offset:32768
    ds_read_b64_tr_b16 v[114:115], v216 offset:34816
    v_mfma_f32_16x16x32_bf16 v[200:203], v[124:127], v[96:99], v[200:203]
    s_waitcnt vmcnt(12) lgkmcnt(6)
    v_mfma_f32_16x16x32_bf16 v[176:179], v[128:131], v[104:107], v[176:179]
    ds_read_b64_tr_b16 v[116:117], v217 offset:32768
    ds_read_b64_tr_b16 v[118:119], v217 offset:34816
    v_mfma_f32_16x16x32_bf16 v[180:183], v[128:131], v[108:111], v[180:183]
    buffer_load_dwordx4 v[96:99], v1, s[24:27], s50 offen offset:0 sc1
    v_mfma_f32_16x16x32_bf16 v[188:191], v[132:135], v[108:111], v[188:191]
    ds_read_b64_tr_b16 v[120:121], v218 offset:32768
    ds_read_b64_tr_b16 v[122:123], v218 offset:34816
    v_mfma_f32_16x16x32_bf16 v[184:187], v[132:135], v[104:107], v[184:187]
    buffer_load_dwordx4 v[100:103], v1, s[24:27], s50 offen offset:1024 sc1
    s_waitcnt lgkmcnt(6)
    v_mfma_f32_16x16x32_bf16 v[192:195], v[136:139], v[104:107], v[192:195]
    ds_read_b64_tr_b16 v[124:125], v219 offset:32768
    ds_read_b64_tr_b16 v[126:127], v219 offset:34816
    v_mfma_f32_16x16x32_bf16 v[196:199], v[136:139], v[108:111], v[196:199]
    s_add_u32 s50, s50, 8192
    v_mfma_f32_16x16x32_bf16 v[204:207], v[140:143], v[108:111], v[204:207]
    ds_read_b64_tr_b16 v[128:129], v216 offset:36864
    ds_read_b64_tr_b16 v[130:131], v216 offset:38912
    v_mfma_f32_16x16x32_bf16 v[200:203], v[140:143], v[104:107], v[200:203]
    s_waitcnt vmcnt(12) lgkmcnt(6)
    v_mfma_f32_16x16x32_bf16 v[176:179], v[112:115], v[48:51], v[176:179]
    ds_read_b64_tr_b16 v[132:133], v217 offset:36864
    ds_read_b64_tr_b16 v[134:135], v217 offset:38912
    v_mfma_f32_16x16x32_bf16 v[180:183], v[112:115], v[52:55], v[180:183]
    buffer_load_dwordx4 v[104:107], v1, s[24:27], s50 offen offset:0 sc1
    v_mfma_f32_16x16x32_bf16 v[188:191], v[116:119], v[52:55], v[188:191]
    ds_read_b64_tr_b16 v[136:137], v218 offset:36864
    ds_read_b64_tr_b16 v[138:139], v218 offset:38912
    v_mfma_f32_16x16x32_bf16 v[184:187], v[116:119], v[48:51], v[184:187]
    buffer_load_dwordx4 v[108:111], v1, s[24:27], s50 offen offset:1024 sc1
    s_waitcnt lgkmcnt(6)
    v_mfma_f32_16x16x32_bf16 v[192:195], v[120:123], v[48:51], v[192:195]
    ds_read_b64_tr_b16 v[140:141], v219 offset:36864
    ds_read_b64_tr_b16 v[142:143], v219 offset:38912
    v_mfma_f32_16x16x32_bf16 v[196:199], v[120:123], v[52:55], v[196:199]
    s_add_u32 s50, s50, 8192
    s_cmp_eq_u32 s50, s79
    s_cselect_b32 s43, 16384, 0
    s_add_u32 s50, s50, s43
    v_mfma_f32_16x16x32_bf16 v[204:207], v[124:127], v[52:55], v[204:207]
    ds_read_b64_tr_b16 v[112:113], v216 offset:40960
    ds_read_b64_tr_b16 v[114:115], v216 offset:43008
    v_mfma_f32_16x16x32_bf16 v[200:203], v[124:127], v[48:51], v[200:203]
    s_waitcnt vmcnt(12) lgkmcnt(6)
    v_mfma_f32_16x16x32_bf16 v[176:179], v[128:131], v[56:59], v[176:179]
    ds_read_b64_tr_b16 v[116:117], v217 offset:40960
    ds_read_b64_tr_b16 v[118:119], v217 offset:43008
    v_mfma_f32_16x16x32_bf16 v[180:183], v[128:131], v[60:63], v[180:183]
    buffer_load_dwordx4 v[48:51], v1, s[24:27], s50 offen offset:0 sc1
    v_mfma_f32_16x16x32_bf16 v[188:191], v[132:135], v[60:63], v[188:191]
    ds_read_b64_tr_b16 v[120:121], v218 offset:40960
    ds_read_b64_tr_b16 v[122:123], v218 offset:43008
    v_mfma_f32_16x16x32_bf16 v[184:187], v[132:135], v[56:59], v[184:187]
    buffer_load_dwordx4 v[52:55], v1, s[24:27], s50 offen offset:1024 sc1
    s_waitcnt lgkmcnt(6)
    v_mfma_f32_16x16x32_bf16 v[192:195], v[136:139], v[56:59], v[192:195]
    ds_read_b64_tr_b16 v[124:125], v219 offset:40960
    ds_read_b64_tr_b16 v[126:127], v219 offset:43008
    v_mfma_f32_16x16x32_bf16 v[196:199], v[136:139], v[60:63], v[196:199]
    s_add_u32 s50, s50, 8192
    v_mfma_f32_16x16x32_bf16 v[204:207], v[140:143], v[60:63], v[204:207]
    ds_read_b64_tr_b16 v[128:129], v216 offset:45056
    ds_read_b64_tr_b16 v[130:131], v216 offset:47104
    v_mfma_f32_16x16x32_bf16 v[200:203], v[140:143], v[56:59], v[200:203]
    s_waitcnt vmcnt(12) lgkmcnt(6)
    v_mfma_f32_16x16x32_bf16 v[176:179], v[112:115], v[64:67], v[176:179]
    ds_read_b64_tr_b16 v[132:133], v217 offset:45056
    ds_read_b64_tr_b16 v[134:135], v217 offset:47104
    v_mfma_f32_16x16x32_bf16 v[180:183], v[112:115], v[68:71], v[180:183]
    buffer_load_dwordx4 v[56:59], v1, s[24:27], s50 offen offset:0 sc1
    v_mfma_f32_16x16x32_bf16 v[188:191], v[116:119], v[68:71], v[188:191]
    ds_read_b64_tr_b16 v[136:137], v218 offset:45056
    ds_read_b64_tr_b16 v[138:139], v218 offset:47104
    v_mfma_f32_16x16x32_bf16 v[184:187], v[116:119], v[64:67], v[184:187]
    buffer_load_dwordx4 v[60:63], v1, s[24:27], s50 offen offset:1024 sc1
    s_waitcnt lgkmcnt(6)
    v_mfma_f32_16x16x32_bf16 v[192:195], v[120:123], v[64:67], v[192:195]
    ds_read_b64_tr_b16 v[140:141], v219 offset:45056
    ds_read_b64_tr_b16 v[142:143], v219 offset:47104
    v_mfma_f32_16x16x32_bf16 v[196:199], v[120:123], v[68:71], v[196:199]
    s_add_u32 s50, s50, 8192
    s_cmp_eq_u32 s50, s79
    s_cselect_b32 s43, 16384, 0
    s_add_u32 s50, s50, s43
    v_mfma_f32_16x16x32_bf16 v[204:207], v[124:127], v[68:71], v[204:207]
    v_add_u32 v216, 49152, v216
    ds_read_b64_tr_b16 v[112:113], v216 offset:0
    ds_read_b64_tr_b16 v[114:115], v216 offset:2048
    v_mfma_f32_16x16x32_bf16 v[200:203], v[124:127], v[64:67], v[200:203]
    s_lshl_b32 s46, s59, 12
    s_add_u32 s46, s46, s40
    s_add_u32 s46, s46, 0x1c40000
    buffer_load_dwordx4 v[160:163], v1, s[24:27], s46 offen offset:0 sc1
    buffer_load_dwordx4 v[164:167], v1, s[24:27], s46 offen offset:1024 sc1
    buffer_load_dwordx4 v[168:171], v1, s[24:27], s46 offen offset:2048 sc1
    buffer_load_dwordx4 v[172:175], v1, s[24:27], s46 offen offset:3072 sc1
    s_waitcnt vmcnt(16) lgkmcnt(6)
    v_mfma_f32_16x16x32_bf16 v[176:179], v[128:131], v[72:75], v[176:179]
    v_add_u32 v217, 49152, v217
    ds_read_b64_tr_b16 v[116:117], v217 offset:0
    ds_read_b64_tr_b16 v[118:119], v217 offset:2048
    v_mfma_f32_16x16x32_bf16 v[180:183], v[128:131], v[76:79], v[180:183]
    buffer_load_dwordx4 v[64:67], v1, s[24:27], s50 offen offset:0 sc1
    v_mfma_f32_16x16x32_bf16 v[188:191], v[132:135], v[76:79], v[188:191]
    v_add_u32 v218, 49152, v218
    ds_read_b64_tr_b16 v[120:121], v218 offset:0
    ds_read_b64_tr_b16 v[122:123], v218 offset:2048
    v_mfma_f32_16x16x32_bf16 v[184:187], v[132:135], v[72:75], v[184:187]
    buffer_load_dwordx4 v[68:71], v1, s[24:27], s50 offen offset:1024 sc1
    s_waitcnt lgkmcnt(6)
    v_mfma_f32_16x16x32_bf16 v[192:195], v[136:139], v[72:75], v[192:195]
    v_add_u32 v219, 49152, v219
    ds_read_b64_tr_b16 v[124:125], v219 offset:0
    ds_read_b64_tr_b16 v[126:127], v219 offset:2048
    v_mfma_f32_16x16x32_bf16 v[196:199], v[136:139], v[76:79], v[196:199]
    s_add_u32 s50, s50, 8192
    v_mfma_f32_16x16x32_bf16 v[204:207], v[140:143], v[76:79], v[204:207]
    ds_read_b64_tr_b16 v[128:129], v216 offset:4096
    ds_read_b64_tr_b16 v[130:131], v216 offset:6144
    v_mfma_f32_16x16x32_bf16 v[200:203], v[140:143], v[72:75], v[200:203]
    s_waitcnt vmcnt(16) lgkmcnt(6)
    v_mfma_f32_16x16x32_bf16 v[176:179], v[112:115], v[80:83], v[176:179]
    ds_read_b64_tr_b16 v[132:133], v217 offset:4096
    ds_read_b64_tr_b16 v[134:135], v217 offset:6144
    v_mfma_f32_16x16x32_bf16 v[180:183], v[112:115], v[84:87], v[180:183]
    buffer_load_dwordx4 v[72:75], v1, s[24:27], s50 offen offset:0 sc1
    v_mfma_f32_16x16x32_bf16 v[188:191], v[116:119], v[84:87], v[188:191]
    ds_read_b64_tr_b16 v[136:137], v218 offset:4096
    ds_read_b64_tr_b16 v[138:139], v218 offset:6144
    v_mfma_f32_16x16x32_bf16 v[184:187], v[116:119], v[80:83], v[184:187]
    buffer_load_dwordx4 v[76:79], v1, s[24:27], s50 offen offset:1024 sc1
    s_waitcnt lgkmcnt(6)
    v_mfma_f32_16x16x32_bf16 v[192:195], v[120:123], v[80:83], v[192:195]
    ds_read_b64_tr_b16 v[140:141], v219 offset:4096
    ds_read_b64_tr_b16 v[142:143], v219 offset:6144
    v_mfma_f32_16x16x32_bf16 v[196:199], v[120:123], v[84:87], v[196:199]
    s_add_u32 s50, s50, 8192
    s_cmp_eq_u32 s50, s79
    s_cselect_b32 s43, 16384, 0
    s_add_u32 s50, s50, s43
    v_mfma_f32_16x16x32_bf16 v[204:207], v[124:127], v[84:87], v[204:207]
    ds_read_b64_tr_b16 v[112:113], v216 offset:8192
    ds_read_b64_tr_b16 v[114:115], v216 offset:10240
    v_mfma_f32_16x16x32_bf16 v[200:203], v[124:127], v[80:83], v[200:203]
    s_waitcnt vmcnt(16) lgkmcnt(6)
    v_mfma_f32_16x16x32_bf16 v[176:179], v[128:131], v[88:91], v[176:179]
    ds_read_b64_tr_b16 v[116:117], v217 offset:8192
    ds_read_b64_tr_b16 v[118:119], v217 offset:10240
    v_mfma_f32_16x16x32_bf16 v[180:183], v[128:131], v[92:95], v[180:183]
    buffer_load_dwordx4 v[80:83], v1, s[24:27], s50 offen offset:0 sc1
    v_mfma_f32_16x16x32_bf16 v[188:191], v[132:135], v[92:95], v[188:191]
    ds_read_b64_tr_b16 v[120:121], v218 offset:8192
    ds_read_b64_tr_b16 v[122:123], v218 offset:10240
    v_mfma_f32_16x16x32_bf16 v[184:187], v[132:135], v[88:91], v[184:187]
    buffer_load_dwordx4 v[84:87], v1, s[24:27], s50 offen offset:1024 sc1
    s_waitcnt lgkmcnt(6)
    v_mfma_f32_16x16x32_bf16 v[192:195], v[136:139], v[88:91], v[192:195]
    ds_read_b64_tr_b16 v[124:125], v219 offset:8192
    ds_read_b64_tr_b16 v[126:127], v219 offset:10240
    v_mfma_f32_16x16x32_bf16 v[196:199], v[136:139], v[92:95], v[196:199]
    s_add_u32 s50, s50, 8192
    v_mfma_f32_16x16x32_bf16 v[204:207], v[140:143], v[92:95], v[204:207]
    ds_read_b64_tr_b16 v[128:129], v216 offset:12288
    ds_read_b64_tr_b16 v[130:131], v216 offset:14336
    v_mfma_f32_16x16x32_bf16 v[200:203], v[140:143], v[88:91], v[200:203]
    s_waitcnt vmcnt(16) lgkmcnt(6)
    v_mfma_f32_16x16x32_bf16 v[176:179], v[112:115], v[96:99], v[176:179]
    ds_read_b64_tr_b16 v[132:133], v217 offset:12288
    ds_read_b64_tr_b16 v[134:135], v217 offset:14336
    v_mfma_f32_16x16x32_bf16 v[180:183], v[112:115], v[100:103], v[180:183]
    buffer_load_dwordx4 v[88:91], v1, s[24:27], s50 offen offset:0 sc1
    v_mfma_f32_16x16x32_bf16 v[188:191], v[116:119], v[100:103], v[188:191]
    ds_read_b64_tr_b16 v[136:137], v218 offset:12288
    ds_read_b64_tr_b16 v[138:139], v218 offset:14336
    v_mfma_f32_16x16x32_bf16 v[184:187], v[116:119], v[96:99], v[184:187]
    buffer_load_dwordx4 v[92:95], v1, s[24:27], s50 offen offset:1024 sc1
    s_waitcnt lgkmcnt(6)
    v_mfma_f32_16x16x32_bf16 v[192:195], v[120:123], v[96:99], v[192:195]
    ds_read_b64_tr_b16 v[140:141], v219 offset:12288
    ds_read_b64_tr_b16 v[142:143], v219 offset:14336
    v_mfma_f32_16x16x32_bf16 v[196:199], v[120:123], v[100:103], v[196:199]
    s_add_u32 s50, s50, 8192
    s_cmp_eq_u32 s50, s79
    s_cselect_b32 s43, 16384, 0
    s_add_u32 s50, s50, s43
    s_cmp_lg_u32 s41, 0
    s_cbranch_scc1 .Lnob1b_13
    s_barrier
.Lnob1b_13:
    v_mfma_f32_16x16x32_bf16 v[204:207], v[124:127], v[100:103], v[204:207]
    ds_read_b64_tr_b16 v[112:113], v216 offset:16384
    ds_read_b64_tr_b16 v[114:115], v216 offset:18432
    v_mfma_f32_16x16x32_bf16 v[200:203], v[124:127], v[96:99], v[200:203]
    s_waitcnt vmcnt(16) lgkmcnt(6)
    v_mfma_f32_16x16x32_bf16 v[176:179], v[128:131], v[104:107], v[176:179]
    ds_read_b64_tr_b16 v[116:117], v217 offset:16384
    ds_read_b64_tr_b16 v[118:119], v217 offset:18432
    v_mfma_f32_16x16x32_bf16 v[180:183], v[128:131], v[108:111], v[180:183]
    buffer_load_dwordx4 v[96:99], v1, s[24:27], s50 offen offset:0 sc1
    v_mfma_f32_16x16x32_bf16 v[188:191], v[132:135], v[108:111], v[188:191]
    ds_read_b64_tr_b16 v[120:121], v218 offset:16384
    ds_read_b64_tr_b16 v[122:123], v218 offset:18432
    v_mfma_f32_16x16x32_bf16 v[184:187], v[132:135], v[104:107], v[184:187]
    buffer_load_dwordx4 v[100:103], v1, s[24:27], s50 offen offset:1024 sc1
    s_waitcnt lgkmcnt(6)
    v_mfma_f32_16x16x32_bf16 v[192:195], v[136:139], v[104:107], v[192:195]
    ds_read_b64_tr_b16 v[124:125], v219 offset:16384
    ds_read_b64_tr_b16 v[126:127], v219 offset:18432
    v_mfma_f32_16x16x32_bf16 v[196:199], v[136:139], v[108:111], v[196:199]
    s_add_u32 s50, s50, 8192
    v_mfma_f32_16x16x32_bf16 v[204:207], v[140:143], v[108:111], v[204:207]
    ds_read_b64_tr_b16 v[128:129], v216 offset:20480
    ds_read_b64_tr_b16 v[130:131], v216 offset:22528
    v_mfma_f32_16x16x32_bf16 v[200:203], v[140:143], v[104:107], v[200:203]
    s_waitcnt vmcnt(16) lgkmcnt(6)
    v_mfma_f32_16x16x32_bf16 v[176:179], v[112:115], v[48:51], v[176:179]
    ds_read_b64_tr_b16 v[132:133], v217 offset:20480
    ds_read_b64_tr_b16 v[134:135], v217 offset:22528
    v_mfma_f32_16x16x32_bf16 v[180:183], v[112:115], v[52:55], v[180:183]
    buffer_load_dwordx4 v[104:107], v1, s[24:27], s50 offen offset:0 sc1
    v_mfma_f32_16x16x32_bf16 v[188:191], v[116:119], v[52:55], v[188:191]
    ds_read_b64_tr_b16 v[136:137], v218 offset:20480
    ds_read_b64_tr_b16 v[138:139], v218 offset:22528
    v_mfma_f32_16x16x32_bf16 v[184:187], v[116:119], v[48:51], v[184:187]
    buffer_load_dwordx4 v[108:111], v1, s[24:27], s50 offen offset:1024 sc1
    s_waitcnt lgkmcnt(6)
    v_mfma_f32_16x16x32_bf16 v[192:195], v[120:123], v[48:51], v[192:195]
    ds_read_b64_tr_b16 v[140:141], v219 offset:20480
    ds_read_b64_tr_b16 v[142:143], v219 offset:22528
    v_mfma_f32_16x16x32_bf16 v[196:199], v[120:123], v[52:55], v[196:199]
    s_add_u32 s50, s50, 8192
    s_cmp_eq_u32 s50, s79
    s_cselect_b32 s43, 16384, 0
    s_add_u32 s50, s50, s43
    v_mfma_f32_16x16x32_bf16 v[204:207], v[124:127], v[52:55], v[204:207]
    ds_read_b64_tr_b16 v[112:113], v216 offset:24576
    ds_read_b64_tr_b16 v[114:115], v216 offset:26624
    v_mfma_f32_16x16x32_bf16 v[200:203], v[124:127], v[48:51], v[200:203]
    s_waitcnt vmcnt(16) lgkmcnt(6)
    v_mfma_f32_16x16x32_bf16 v[176:179], v[128:131], v[56:59], v[176:179]
    ds_read_b64_tr_b16 v[116:117], v217 offset:24576
    ds_read_b64_tr_b16 v[118:119], v217 offset:26624
    v_mfma_f32_16x16x32_bf16 v[180:183], v[128:131], v[60:63], v[180:183]
    buffer_load_dwordx4 v[48:51], v1, s[24:27], s50 offen offset:0 sc1
    v_mfma_f32_16x16x32_bf16 v[188:191], v[132:135], v[60:63], v[188:191]
    ds_read_b64_tr_b16 v[120:121], v218 offset:24576
    ds_read_b64_tr_b16 v[122:123], v218 offset:26624
    v_mfma_f32_16x16x32_bf16 v[184:187], v[132:135], v[56:59], v[184:187]
    buffer_load_dwordx4 v[52:55], v1, s[24:27], s50 offen offset:1024 sc1
    s_waitcnt lgkmcnt(6)
    v_mfma_f32_16x16x32_bf16 v[192:195], v[136:139], v[56:59], v[192:195]
    ds_read_b64_tr_b16 v[124:125], v219 offset:24576
    ds_read_b64_tr_b16 v[126:127], v219 offset:26624
    v_mfma_f32_16x16x32_bf16 v[196:199], v[136:139], v[60:63], v[196:199]
    s_add_u32 s50, s50, 8192
    v_mfma_f32_16x16x32_bf16 v[204:207], v[140:143], v[60:63], v[204:207]
    ds_read_b64_tr_b16 v[128:129], v216 offset:28672
    ds_read_b64_tr_b16 v[130:131], v216 offset:30720
    v_mfma_f32_16x16x32_bf16 v[200:203], v[140:143], v[56:59], v[200:203]
    s_waitcnt vmcnt(12) lgkmcnt(6)
    v_mfma_f32_16x16x32_bf16 v[176:179], v[112:115], v[64:67], v[176:179]
    ds_read_b64_tr_b16 v[132:133], v217 offset:28672
    ds_read_b64_tr_b16 v[134:135], v217 offset:30720
    v_mfma_f32_16x16x32_bf16 v[180:183], v[112:115], v[68:71], v[180:183]
    buffer_load_dwordx4 v[56:59], v1, s[24:27], s50 offen offset:0 sc1
    v_add_f32 v160, v160, v168
    v_mfma_f32_16x16x32_bf16 v[188:191], v[116:119], v[68:71], v[188:191]
    ds_read_b64_tr_b16 v[136:137], v218 offset:28672
    ds_read_b64_tr_b16 v[138:139], v218 offset:30720
    v_mfma_f32_16x16x32_bf16 v[184:187], v[116:119], v[64:67], v[184:187]
    buffer_load_dwordx4 v[60:63], v1, s[24:27], s50 offen offset:1024 sc1
    v_add_f32 v161, v161, v169
    s_waitcnt lgkmcnt(6)
    v_mfma_f32_16x16x32_bf16 v[192:195], v[120:123], v[64:67], v[192:195]
    ds_read_b64_tr_b16 v[140:141], v219 offset:28672
    ds_read_b64_tr_b16 v[142:143], v219 offset:30720
    v_mfma_f32_16x16x32_bf16 v[196:199], v[120:123], v[68:71], v[196:199]
    s_add_u32 s50, s50, 8192
    s_cmp_eq_u32 s50, s79
    s_cselect_b32 s43, 16384, 0
    s_add_u32 s50, s50, s43
    v_add_f32 v162, v162, v170
    v_mfma_f32_16x16x32_bf16 v[204:207], v[124:127], v[68:71], v[204:207]
    ds_read_b64_tr_b16 v[112:113], v216 offset:32768
    ds_read_b64_tr_b16 v[114:115], v216 offset:34816
    v_mfma_f32_16x16x32_bf16 v[200:203], v[124:127], v[64:67], v[200:203]
    v_add_f32 v163, v163, v171
    s_waitcnt vmcnt(12) lgkmcnt(6)
    v_mfma_f32_16x16x32_bf16 v[176:179], v[128:131], v[72:75], v[176:179]
    ds_read_b64_tr_b16 v[116:117], v217 offset:32768
    ds_read_b64_tr_b16 v[118:119], v217 offset:34816
    v_mfma_f32_16x16x32_bf16 v[180:183], v[128:131], v[76:79], v[180:183]
    buffer_load_dwordx4 v[64:67], v1, s[24:27], s50 offen offset:0 sc1
    v_add_f32 v164, v164, v172
    v_mfma_f32_16x16x32_bf16 v[188:191], v[132:135], v[76:79], v[188:191]
    ds_read_b64_tr_b16 v[120:121], v218 offset:32768
    ds_read_b64_tr_b16 v[122:123], v218 offset:34816
    v_mfma_f32_16x16x32_bf16 v[184:187], v[132:135], v[72:75], v[184:187]
    buffer_load_dwordx4 v[68:71], v1, s[24:27], s50 offen offset:1024 sc1
    v_add_f32 v165, v165, v173
    s_waitcnt lgkmcnt(6)
    v_mfma_f32_16x16x32_bf16 v[192:195], v[136:139], v[72:75], v[192:195]
    ds_read_b64_tr_b16 v[124:125], v219 offset:32768
    ds_read_b64_tr_b16 v[126:127], v219 offset:34816
    v_mfma_f32_16x16x32_bf16 v[196:199], v[136:139], v[76:79], v[196:199]
    s_add_u32 s50, s50, 8192
    v_add_f32 v166, v166, v174
    v_mfma_f32_16x16x32_bf16 v[204:207], v[140:143], v[76:79], v[204:207]
    ds_read_b64_tr_b16 v[128:129], v216 offset:36864
    ds_read_b64_tr_b16 v[130:131], v216 offset:38912
    v_mfma_f32_16x16x32_bf16 v[200:203], v[140:143], v[72:75], v[200:203]
    v_add_f32 v167, v167, v175
    s_waitcnt vmcnt(12) lgkmcnt(6)
    v_mfma_f32_16x16x32_bf16 v[176:179], v[112:115], v[80:83], v[176:179]
    ds_read_b64_tr_b16 v[132:133], v217 offset:36864
    ds_read_b64_tr_b16 v[134:135], v217 offset:38912
    v_mfma_f32_16x16x32_bf16 v[180:183], v[112:115], v[84:87], v[180:183]
    buffer_load_dwordx4 v[72:75], v1, s[24:27], s50 offen offset:0 sc1
    v_add_f32 v160, v160, v164
    v_mfma_f32_16x16x32_bf16 v[188:191], v[116:119], v[84:87], v[188:191]
    ds_read_b64_tr_b16 v[136:137], v218 offset:36864
    ds_read_b64_tr_b16 v[138:139], v218 offset:38912
    v_mfma_f32_16x16x32_bf16 v[184:187], v[116:119], v[80:83], v[184:187]
    buffer_load_dwordx4 v[76:79], v1, s[24:27], s50 offen offset:1024 sc1
    v_add_f32 v161, v161, v165
    s_waitcnt lgkmcnt(6)
    v_mfma_f32_16x16x32_bf16 v[192:195], v[120:123], v[80:83], v[192:195]
    ds_read_b64_tr_b16 v[140:141], v219 offset:36864
    ds_read_b64_tr_b16 v[142:143], v219 offset:38912
    v_mfma_f32_16x16x32_bf16 v[196:199], v[120:123], v[84:87], v[196:199]
    s_add_u32 s50, s50, 8192
    s_cmp_eq_u32 s50, s79
    s_cselect_b32 s43, 16384, 0
    s_add_u32 s50, s50, s43
    v_add_f32 v162, v162, v166
    v_mfma_f32_16x16x32_bf16 v[204:207], v[124:127], v[84:87], v[204:207]
    ds_read_b64_tr_b16 v[112:113], v216 offset:40960
    ds_read_b64_tr_b16 v[114:115], v216 offset:43008
    v_mfma_f32_16x16x32_bf16 v[200:203], v[124:127], v[80:83], v[200:203]
    v_add_f32 v163, v163, v167
    s_waitcnt vmcnt(12) lgkmcnt(6)
    v_mfma_f32_16x16x32_bf16 v[176:179], v[128:131], v[88:91], v[176:179]
    ds_read_b64_tr_b16 v[116:117], v217 offset:40960
    ds_read_b64_tr_b16 v[118:119], v217 offset:43008
    v_mfma_f32_16x16x32_bf16 v[180:183], v[128:131], v[92:95], v[180:183]
    buffer_load_dwordx4 v[80:83], v1, s[24:27], s50 offen offset:0 sc1
    v_permlane16_swap_b32 v160, v161
    v_mfma_f32_16x16x32_bf16 v[188:191], v[132:135], v[92:95], v[188:191]
    ds_read_b64_tr_b16 v[120:121], v218 offset:40960
    ds_read_b64_tr_b16 v[122:123], v218 offset:43008
    v_mfma_f32_16x16x32_bf16 v[184:187], v[132:135], v[88:91], v[184:187]
    buffer_load_dwordx4 v[84:87], v1, s[24:27], s50 offen offset:1024 sc1
    v_permlane16_swap_b32 v162, v163
    s_waitcnt lgkmcnt(6)
    v_mfma_f32_16x16x32_bf16 v[192:195], v[136:139], v[88:91], v[192:195]
    ds_read_b64_tr_b16 v[124:125], v219 offset:40960
    ds_read_b64_tr_b16 v[126:127], v219 offset:43008
    v_mfma_f32_16x16x32_bf16 v[196:199], v[136:139], v[92:95], v[196:199]
    s_add_u32 s50, s50, 8192
    v_add_f32 v160, v160, v161
    v_mfma_f32_16x16x32_bf16 v[204:207], v[140:143], v[92:95], v[204:207]
    ds_read_b64_tr_b16 v[128:129], v216 offset:45056
    ds_read_b64_tr_b16 v[130:131], v216 offset:47104
    v_mfma_f32_16x16x32_bf16 v[200:203], v[140:143], v[88:91], v[200:203]
    v_add_f32 v162, v162, v163
    s_waitcnt vmcnt(12) lgkmcnt(6)
    v_mfma_f32_16x16x32_bf16 v[176:179], v[112:115], v[96:99], v[176:179]
    ds_read_b64_tr_b16 v[132:133], v217 offset:45056
    ds_read_b64_tr_b16 v[134:135], v217 offset:47104
    v_mfma_f32_16x16x32_bf16 v[180:183], v[112:115], v[100:103], v[180:183]
    buffer_load_dwordx4 v[88:91], v1, s[24:27], s50 offen offset:0 sc1
    v_mfma_f32_16x16x32_bf16 v[188:191], v[116:119], v[100:103], v[188:191]
    ds_read_b64_tr_b16 v[136:137], v218 offset:45056
    ds_read_b64_tr_b16 v[138:139], v218 offset:47104
    v_mfma_f32_16x16x32_bf16 v[184:187], v[116:119], v[96:99], v[184:187]
    buffer_load_dwordx4 v[92:95], v1, s[24:27], s50 offen offset:1024 sc1
    v_permlane32_swap_b32 v160, v162
    s_waitcnt lgkmcnt(6)
    v_mfma_f32_16x16x32_bf16 v[192:195], v[120:123], v[96:99], v[192:195]
    ds_read_b64_tr_b16 v[140:141], v219 offset:45056
    ds_read_b64_tr_b16 v[142:143], v219 offset:47104
    v_mfma_f32_16x16x32_bf16 v[196:199], v[120:123], v[100:103], v[196:199]
    s_add_u32 s50, s50, 8192
    s_cmp_eq_u32 s50, s79
    s_cselect_b32 s43, 16384, 0
    s_add_u32 s50, s50, s43
    v_add_f32 v160, v160, v162
    s_barrier
    v_mfma_f32_16x16x32_bf16 v[204:207], v[124:127], v[100:103], v[204:207]
    v_add_u32 v216, 49152, v216
    ds_read_b64_tr_b16 v[112:113], v216 offset:0
    ds_read_b64_tr_b16 v[114:115], v216 offset:2048
    v_mfma_f32_16x16x32_bf16 v[200:203], v[124:127], v[96:99], v[200:203]
    v_mov_b32 v161, v160
    s_waitcnt vmcnt(12) lgkmcnt(6)
    v_mfma_f32_16x16x32_bf16 v[176:179], v[128:131], v[104:107], v[176:179]
    v_add_u32 v217, 49152, v217
    ds_read_b64_tr_b16 v[116:117], v217 offset:0
    ds_read_b64_tr_b16 v[118:119], v217 offset:2048
    v_mfma_f32_16x16x32_bf16 v[180:183], v[128:131], v[108:111], v[180:183]
    buffer_load_dwordx4 v[96:99], v1, s[24:27], s50 offen offset:0 sc1
    v_mfma_f32_16x16x32_bf16 v[188:191], v[132:135], v[108:111], v[188:191]
    v_add_u32 v218, 49152, v218
    ds_read_b64_tr_b16 v[120:121], v218 offset:0
    ds_read_b64_tr_b16 v[122:123], v218 offset:2048
    v_mfma_f32_16x16x32_bf16 v[184:187], v[132:135], v[104:107], v[184:187]
    buffer_load_dwordx4 v[100:103], v1, s[24:27], s50 offen offset:1024 sc1
    v_permlane32_swap_b32 v160, v161
    s_waitcnt lgkmcnt(6)
    v_mfma_f32_16x16x32_bf16 v[192:195], v[136:139], v[104:107], v[192:195]
    v_add_u32 v219, 49152, v219
    ds_read_b64_tr_b16 v[124:125], v219 offset:0
    ds_read_b64_tr_b16 v[126:127], v219 offset:2048
    v_mfma_f32_16x16x32_bf16 v[196:199], v[136:139], v[108:111], v[196:199]
    s_add_u32 s50, s50, 8192
    v_mul_f32 v162, 0xba800000, v160
    v_mfma_f32_16x16x32_bf16 v[204:207], v[140:143], v[108:111], v[204:207]
    ds_read_b64_tr_b16 v[128:129], v216 offset:4096
    ds_read_b64_tr_b16 v[130:131], v216 offset:6144
    v_mfma_f32_16x16x32_bf16 v[200:203], v[140:143], v[104:107], v[200:203]
    v_mul_f32 v164, 0x3a800000, v161
    s_waitcnt vmcnt(12) lgkmcnt(6)
    v_mfma_f32_16x16x32_bf16 v[176:179], v[112:115], v[48:51], v[176:179]
    ds_read_b64_tr_b16 v[132:133], v217 offset:4096
    ds_read_b64_tr_b16 v[134:135], v217 offset:6144
    v_mfma_f32_16x16x32_bf16 v[180:183], v[112:115], v[52:55], v[180:183]
    buffer_load_dwordx4 v[104:107], v1, s[24:27], s50 offen offset:0 sc1
    v_fma_f32 v164, -v162, v162, v164
    v_mfma_f32_16x16x32_bf16 v[188:191], v[116:119], v[52:55], v[188:191]
    ds_read_b64_tr_b16 v[136:137], v218 offset:4096
    ds_read_b64_tr_b16 v[138:139], v218 offset:6144
    v_mfma_f32_16x16x32_bf16 v[184:187], v[116:119], v[48:51], v[184:187]
    buffer_load_dwordx4 v[108:111], v1, s[24:27], s50 offen offset:1024 sc1
    v_max_f32 v164, 0, v164
    s_waitcnt lgkmcnt(6)
    v_mfma_f32_16x16x32_bf16 v[192:195], v[120:123], v[48:51], v[192:195]
    ds_read_b64_tr_b16 v[140:141], v219 offset:4096
    ds_read_b64_tr_b16 v[142:143], v219 offset:6144
    v_mfma_f32_16x16x32_bf16 v[196:199], v[120:123], v[52:55], v[196:199]
    s_add_u32 s50, s50, 8192
    s_cmp_eq_u32 s50, s79
    s_cselect_b32 s43, 16384, 0
    s_add_u32 s50, s50, s43
    v_add_f32 v165, 0x3727c5ac, v164
    v_mfma_f32_16x16x32_bf16 v[204:207], v[124:127], v[52:55], v[204:207]
    ds_read_b64_tr_b16 v[112:113], v216 offset:8192
    ds_read_b64_tr_b16 v[114:115], v216 offset:10240
    v_mfma_f32_16x16x32_bf16 v[200:203], v[124:127], v[48:51], v[200:203]
    v_rsq_f32 v163, v165
    s_waitcnt vmcnt(12) lgkmcnt(6)
    v_mfma_f32_16x16x32_bf16 v[176:179], v[128:131], v[56:59], v[176:179]
    ds_read_b64_tr_b16 v[116:117], v217 offset:8192
    ds_read_b64_tr_b16 v[118:119], v217 offset:10240
    v_mfma_f32_16x16x32_bf16 v[180:183], v[128:131], v[60:63], v[180:183]
    v_and_b32 v170, s54, v162
    v_mfma_f32_16x16x32_bf16 v[188:191], v[132:135], v[60:63], v[188:191]
    ds_read_b64_tr_b16 v[120:121], v218 offset:8192
    ds_read_b64_tr_b16 v[122:123], v218 offset:10240
    v_mfma_f32_16x16x32_bf16 v[184:187], v[132:135], v[56:59], v[184:187]
    v_sub_f32 v168, v162, v170
    s_waitcnt lgkmcnt(6)
    v_mfma_f32_16x16x32_bf16 v[192:195], v[136:139], v[56:59], v[192:195]
    ds_read_b64_tr_b16 v[124:125], v219 offset:8192
    ds_read_b64_tr_b16 v[126:127], v219 offset:10240
    v_mfma_f32_16x16x32_bf16 v[196:199], v[136:139], v[60:63], v[196:199]
    v_and_b32 v170, s54, v168
    v_mfma_f32_16x16x32_bf16 v[204:207], v[140:143], v[60:63], v[204:207]
    ds_read_b64_tr_b16 v[128:129], v216 offset:12288
    ds_read_b64_tr_b16 v[130:131], v216 offset:14336
    v_mfma_f32_16x16x32_bf16 v[200:203], v[140:143], v[56:59], v[200:203]
    v_sub_f32 v169, v168, v170
    s_waitcnt vmcnt(10) lgkmcnt(6)
    v_mfma_f32_16x16x32_bf16 v[176:179], v[112:115], v[64:67], v[176:179]
    ds_read_b64_tr_b16 v[132:133], v217 offset:12288
    ds_read_b64_tr_b16 v[134:135], v217 offset:14336
    v_mfma_f32_16x16x32_bf16 v[180:183], v[112:115], v[68:71], v[180:183]
    v_perm_b32 v208, v168, v162, s53
    v_mfma_f32_16x16x32_bf16 v[188:191], v[116:119], v[68:71], v[188:191]
    ds_read_b64_tr_b16 v[136:137], v218 offset:12288
    ds_read_b64_tr_b16 v[138:139], v218 offset:14336
    v_mfma_f32_16x16x32_bf16 v[184:187], v[116:119], v[64:67], v[184:187]
    v_perm_b32 v210, v162, v169, s53
    s_waitcnt lgkmcnt(6)
    v_mfma_f32_16x16x32_bf16 v[192:195], v[120:123], v[64:67], v[192:195]
    ds_read_b64_tr_b16 v[140:141], v219 offset:12288
    ds_read_b64_tr_b16 v[142:143], v219 offset:14336
    v_mfma_f32_16x16x32_bf16 v[196:199], v[120:123], v[68:71], v[196:199]
    v_mov_b32 v212, v208
    v_mfma_f32_16x16x32_bf16 v[204:207], v[124:127], v[68:71], v[204:207]
    ds_read_b64_tr_b16 v[112:113], v216 offset:16384
    ds_read_b64_tr_b16 v[114:115], v216 offset:18432
    v_mfma_f32_16x16x32_bf16 v[200:203], v[124:127], v[64:67], v[200:203]
    v_mov_b32 v214, v210
    s_waitcnt vmcnt(8) lgkmcnt(6)
    v_mfma_f32_16x16x32_bf16 v[176:179], v[128:131], v[72:75], v[176:179]
    ds_read_b64_tr_b16 v[116:117], v217 offset:16384
    ds_read_b64_tr_b16 v[118:119], v217 offset:18432
    v_mfma_f32_16x16x32_bf16 v[180:183], v[128:131], v[76:79], v[180:183]
    v_mfma_f32_16x16x32_bf16 v[188:191], v[132:135], v[76:79], v[188:191]
    ds_read_b64_tr_b16 v[120:121], v218 offset:16384
    ds_read_b64_tr_b16 v[122:123], v218 offset:18432
    v_mfma_f32_16x16x32_bf16 v[184:187], v[132:135], v[72:75], v[184:187]
    v_permlane16_swap_b32 v208, v212
    s_waitcnt lgkmcnt(6)
    v_mfma_f32_16x16x32_bf16 v[192:195], v[136:139], v[72:75], v[192:195]
    ds_read_b64_tr_b16 v[124:125], v219 offset:16384
    ds_read_b64_tr_b16 v[126:127], v219 offset:18432
    v_mfma_f32_16x16x32_bf16 v[196:199], v[136:139], v[76:79], v[196:199]
    v_permlane16_swap_b32 v210, v214
    v_mfma_f32_16x16x32_bf16 v[204:207], v[140:143], v[76:79], v[204:207]
    ds_read_b64_tr_b16 v[128:129], v216 offset:20480
    ds_read_b64_tr_b16 v[130:131], v216 offset:22528
    v_mfma_f32_16x16x32_bf16 v[200:203], v[140:143], v[72:75], v[200:203]
    v_mov_b32 v209, v208
    s_waitcnt vmcnt(6) lgkmcnt(6)
    v_mfma_f32_16x16x32_bf16 v[176:179], v[112:115], v[80:83], v[176:179]
    ds_read_b64_tr_b16 v[132:133], v217 offset:20480
    ds_read_b64_tr_b16 v[134:135], v217 offset:22528
    v_mfma_f32_16x16x32_bf16 v[180:183], v[112:115], v[84:87], v[180:183]
    v_mov_b32 v213, v212
    v_mfma_f32_16x16x32_bf16 v[188:191], v[116:119], v[84:87], v[188:191]
    ds_read_b64_tr_b16 v[136:137], v218 offset:20480
    ds_read_b64_tr_b16 v[138:139], v218 offset:22528
    v_mfma_f32_16x16x32_bf16 v[184:187], v[116:119], v[80:83], v[184:187]
    v_mov_b32 v211, 0
    s_waitcnt lgkmcnt(6)
    v_mfma_f32_16x16x32_bf16 v[192:195], v[120:123], v[80:83], v[192:195]
    ds_read_b64_tr_b16 v[140:141], v219 offset:20480
    ds_read_b64_tr_b16 v[142:143], v219 offset:22528
    v_mfma_f32_16x16x32_bf16 v[196:199], v[120:123], v[84:87], v[196:199]
    v_mov_b32 v215, 0
    v_mfma_f32_16x16x32_bf16 v[204:207], v[124:127], v[84:87], v[204:207]
    ds_read_b64_tr_b16 v[112:113], v216 offset:24576
    ds_read_b64_tr_b16 v[114:115], v216 offset:26624
    v_mfma_f32_16x16x32_bf16 v[200:203], v[124:127], v[80:83], v[200:203]
    v_mul_f32 v220, 0x3e8293ee, v163
    s_waitcnt vmcnt(4) lgkmcnt(6)
    v_mfma_f32_16x16x32_bf16 v[176:179], v[128:131], v[88:91], v[176:179]
    ds_read_b64_tr_b16 v[116:117], v217 offset:24576
    ds_read_b64_tr_b16 v[118:119], v217 offset:26624
    v_mfma_f32_16x16x32_bf16 v[180:183], v[128:131], v[92:95], v[180:183]
    v_mov_b32 v221, v220
    v_mfma_f32_16x16x32_bf16 v[188:191], v[132:135], v[92:95], v[188:191]
    ds_read_b64_tr_b16 v[120:121], v218 offset:24576
    ds_read_b64_tr_b16 v[122:123], v218 offset:26624
    v_mfma_f32_16x16x32_bf16 v[184:187], v[132:135], v[88:91], v[184:187]
    s_waitcnt lgkmcnt(6)
    v_mfma_f32_16x16x32_bf16 v[192:195], v[136:139], v[88:91], v[192:195]
    ds_read_b64_tr_b16 v[124:125], v219 offset:24576
    ds_read_b64_tr_b16 v[126:127], v219 offset:26624
    v_mfma_f32_16x16x32_bf16 v[196:199], v[136:139], v[92:95], v[196:199]
    v_permlane16_swap_b32 v220, v221
    v_mfma_f32_16x16x32_bf16 v[204:207], v[140:143], v[92:95], v[204:207]
    ds_read_b64_tr_b16 v[128:129], v216 offset:28672
    ds_read_b64_tr_b16 v[130:131], v216 offset:30720
    v_mfma_f32_16x16x32_bf16 v[200:203], v[140:143], v[88:91], v[200:203]
    s_waitcnt vmcnt(2) lgkmcnt(6)
    v_mfma_f32_16x16x32_bf16 v[176:179], v[112:115], v[96:99], v[176:179]
    ds_read_b64_tr_b16 v[132:133], v217 offset:28672
    ds_read_b64_tr_b16 v[134:135], v217 offset:30720
    v_mfma_f32_16x16x32_bf16 v[180:183], v[112:115], v[100:103], v[180:183]
    v_mfma_f32_16x16x32_bf16 v[188:191], v[116:119], v[100:103], v[188:191]
    ds_read_b64_tr_b16 v[136:137], v218 offset:28672
    ds_read_b64_tr_b16 v[138:139], v218 offset:30720
    v_mfma_f32_16x16x32_bf16 v[184:187], v[116:119], v[96:99], v[184:187]
    s_waitcnt lgkmcnt(6)
    v_mfma_f32_16x16x32_bf16 v[192:195], v[120:123], v[96:99], v[192:195]
    ds_read_b64_tr_b16 v[140:141], v219 offset:28672
    ds_read_b64_tr_b16 v[142:143], v219 offset:30720
    v_mfma_f32_16x16x32_bf16 v[196:199], v[120:123], v[100:103], v[196:199]
    v_mfma_f32_16x16x32_bf16 v[204:207], v[124:127], v[100:103], v[204:207]
    ds_read_b128 v[112:115], v13 offset:0
    v_mfma_f32_16x16x32_bf16 v[200:203], v[124:127], v[96:99], v[200:203]
    s_waitcnt vmcnt(0) lgkmcnt(5)
    v_mfma_f32_16x16x32_bf16 v[176:179], v[128:131], v[104:107], v[176:179]
    ds_read_b128 v[116:119], v13 offset:1024
    v_mfma_f32_16x16x32_bf16 v[180:183], v[128:131], v[108:111], v[180:183]
    v_mfma_f32_16x16x32_bf16 v[188:191], v[132:135], v[108:111], v[188:191]
    ds_read_b128 v[120:123], v13 offset:2048
    v_mfma_f32_16x16x32_bf16 v[184:187], v[132:135], v[104:107], v[184:187]
    s_waitcnt lgkmcnt(3)
    v_mfma_f32_16x16x32_bf16 v[192:195], v[136:139], v[104:107], v[192:195]
    ds_read_b128 v[124:127], v13 offset:3072
    v_mfma_f32_16x16x32_bf16 v[196:199], v[136:139], v[108:111], v[196:199]
    v_mfma_f32_16x16x32_bf16 v[204:207], v[140:143], v[108:111], v[204:207]
    v_mfma_f32_16x16x32_bf16 v[200:203], v[140:143], v[104:107], v[200:203]
    s_waitcnt lgkmcnt(2)
    v_mfma_f32_16x16x32_bf16 v[176:179], v[112:115], v[208:211], v[176:179]
    v_mfma_f32_16x16x32_bf16 v[180:183], v[112:115], v[212:215], v[180:183]
    v_mfma_f32_16x16x32_bf16 v[188:191], v[116:119], v[212:215], v[188:191]
    v_mfma_f32_16x16x32_bf16 v[184:187], v[116:119], v[208:211], v[184:187]
    s_waitcnt lgkmcnt(0)
    v_mfma_f32_16x16x32_bf16 v[192:195], v[120:123], v[208:211], v[192:195]
    v_mfma_f32_16x16x32_bf16 v[196:199], v[120:123], v[212:215], v[196:199]
    v_mfma_f32_16x16x32_bf16 v[204:207], v[124:127], v[212:215], v[204:207]
    v_mfma_f32_16x16x32_bf16 v[200:203], v[124:127], v[208:211], v[200:203]
    v_pk_mul_f32 v[176:177], v[176:177], v[220:221] op_sel:[0,0] op_sel_hi:[1,0]
    v_pk_mul_f32 v[178:179], v[178:179], v[220:221] op_sel:[0,0] op_sel_hi:[1,0]
    v_pk_mul_f32 v[180:181], v[180:181], v[220:221] op_sel:[0,1] op_sel_hi:[1,1]
    v_pk_mul_f32 v[182:183], v[182:183], v[220:221] op_sel:[0,1] op_sel_hi:[1,1]
    v_pk_mul_f32 v[188:189], v[188:189], v[220:221] op_sel:[0,1] op_sel_hi:[1,1]
    v_pk_mul_f32 v[190:191], v[190:191], v[220:221] op_sel:[0,1] op_sel_hi:[1,1]
    v_pk_mul_f32 v[184:185], v[184:185], v[220:221] op_sel:[0,0] op_sel_hi:[1,0]
    v_pk_mul_f32 v[186:187], v[186:187], v[220:221] op_sel:[0,0] op_sel_hi:[1,0]
    v_pk_mul_f32 v[192:193], v[192:193], v[220:221] op_sel:[0,0] op_sel_hi:[1,0]
    v_pk_mul_f32 v[194:195], v[194:195], v[220:221] op_sel:[0,0] op_sel_hi:[1,0]
    v_pk_mul_f32 v[196:197], v[196:197], v[220:221] op_sel:[0,1] op_sel_hi:[1,1]
    v_pk_mul_f32 v[198:199], v[198:199], v[220:221] op_sel:[0,1] op_sel_hi:[1,1]
    v_pk_mul_f32 v[204:205], v[204:205], v[220:221] op_sel:[0,1] op_sel_hi:[1,1]
    v_pk_mul_f32 v[206:207], v[206:207], v[220:221] op_sel:[0,1] op_sel_hi:[1,1]
    v_pk_mul_f32 v[200:201], v[200:201], v[220:221] op_sel:[0,0] op_sel_hi:[1,0]
    v_pk_mul_f32 v[202:203], v[202:203], v[220:221] op_sel:[0,0] op_sel_hi:[1,0]
    v_cvt_pk_bf16_f32 v48, v176, v177
    v_cvt_pk_bf16_f32 v49, v178, v179
    v_cvt_pk_bf16_f32 v50, v184, v185
    v_cvt_pk_bf16_f32 v51, v186, v187
    v_cvt_pk_bf16_f32 v52, v180, v181
    v_cvt_pk_bf16_f32 v53, v182, v183
    v_cvt_pk_bf16_f32 v54, v188, v189
    v_cvt_pk_bf16_f32 v55, v190, v191
    v_cvt_pk_bf16_f32 v56, v192, v193
    v_cvt_pk_bf16_f32 v57, v194, v195
    v_cvt_pk_bf16_f32 v58, v200, v201
    v_cvt_pk_bf16_f32 v59, v202, v203
    v_cvt_pk_bf16_f32 v60, v196, v197
    v_cvt_pk_bf16_f32 v61, v198, v199
    v_cvt_pk_bf16_f32 v62, v204, v205
    v_cvt_pk_bf16_f32 v63, v206, v207
    s_barrier
    ds_read_b128 v[64:67], v8 offset:32768
    ds_read_b128 v[68:71], v8 offset:33792
    ds_read_b128 v[88:91], v8 offset:34816
    ds_read_b128 v[92:95], v8 offset:35840
    ds_read_b128 v[72:75], v8 offset:36864
    ds_read_b128 v[76:79], v8 offset:37888
    ds_read_b128 v[80:83], v8 offset:34816
    ds_read_b128 v[84:87], v8 offset:35840
    v_permlane16_swap_b32 v48, v52
    v_permlane16_swap_b32 v49, v53
    v_permlane16_swap_b32 v50, v54
    v_permlane16_swap_b32 v51, v55
    v_permlane16_swap_b32 v56, v60
    v_permlane16_swap_b32 v57, v61
    v_permlane16_swap_b32 v58, v62
    v_permlane16_swap_b32 v59, v63
    s_movk_i32 s48, 4
    s_waitcnt lgkmcnt(4)
    v_mfma_f32_32x32x16_bf16 v[96:111], v[64:67], v[48:51], 0
    v_mfma_f32_32x32x16_bf16 v[96:111], v[68:71], v[52:55], v[96:111]
    v_mov_b32 v160, 0
    v_mov_b32 v161, 0
    v_mov_b32 v162, 0
    v_mov_b32 v163, 0
    v_mov_b32 v164, 0
    v_mov_b32 v165, 0
    v_mov_b32 v166, 0
    v_mov_b32 v167, 0
    v_mov_b32 v168, 0
    v_mov_b32 v169, 0
    v_mov_b32 v170, 0
    v_mov_b32 v171, 0
    v_mov_b32 v172, 0
    v_mov_b32 v173, 0
    v_mov_b32 v174, 0
    v_mov_b32 v175, 0
.p2align 3
.Latt_14:
    v_mfma_f32_32x32x16_bf16 v[112:127], v[64:67], v[56:59], 0
    ds_read_b128 v[64:67], v8 offset:40960
    v_exp_f32 v96, v96
    v_exp_f32 v97, v97
    v_exp_f32 v98, v98
    v_mfma_f32_32x32x16_bf16 v[112:127], v[68:71], v[60:63], v[112:127]
    ds_read_b128 v[68:71], v8 offset:41984
    v_exp_f32 v99, v99
    v_exp_f32 v100, v100
    v_exp_f32 v101, v101
    v_smfmac_f32_16x16x64_bf16 v[148:151], v[152:155], v[160:167], v7
    v_exp_f32 v102, v102
    v_exp_f32 v103, v103
    v_smfmac_f32_32x32x32_bf16 v[32:47], v[88:91], v[160:167], v7
    v_exp_f32 v104, v104
    v_exp_f32 v105, v105
    v_exp_f32 v106, v106
    v_smfmac_f32_32x32x32_bf16 v[32:47], v[92:95], v[168:175], v7
    v_exp_f32 v107, v107
    v_exp_f32 v108, v108
    v_exp_f32 v109, v109
    v_smfmac_f32_16x16x64_bf16 v[148:151], v[152:155], v[168:175], v7
    v_exp_f32 v110, v110
    v_exp_f32 v111, v111
    s_waitcnt lgkmcnt(2)
    v_mfma_f32_32x32x16_bf16 v[128:143], v[72:75], v[48:51], 0
    ds_read_b128 v[88:91], v8 offset:38912
    v_exp_f32 v112, v112
    v_exp_f32 v113, v113
    v_exp_f32 v114, v114
    v_mfma_f32_32x32x16_bf16 v[128:143], v[76:79], v[52:55], v[128:143]
    ds_read_b128 v[92:95], v8 offset:39936
    v_exp_f32 v115, v115
    v_exp_f32 v116, v116
    v_exp_f32 v117, v117
    v_smfmac_f32_16x16x64_bf16 v[144:147], v[152:155], v[96:103], v7
    v_exp_f32 v118, v118
    v_exp_f32 v119, v119
    v_smfmac_f32_32x32x32_bf16 v[16:31], v[80:83], v[96:103], v7
    v_exp_f32 v120, v120
    v_exp_f32 v121, v121
    v_exp_f32 v122, v122
    v_smfmac_f32_32x32x32_bf16 v[16:31], v[84:87], v[104:111], v7
    v_exp_f32 v123, v123
    v_exp_f32 v124, v124
    v_exp_f32 v125, v125
    v_smfmac_f32_16x16x64_bf16 v[144:147], v[152:155], v[104:111], v7
    v_exp_f32 v126, v126
    v_exp_f32 v127, v127
    v_mfma_f32_32x32x16_bf16 v[160:175], v[72:75], v[56:59], 0
    ds_read_b128 v[72:75], v8 offset:45056
    v_exp_f32 v128, v128
    v_exp_f32 v129, v129
    v_exp_f32 v130, v130
    v_mfma_f32_32x32x16_bf16 v[160:175], v[76:79], v[60:63], v[160:175]
    ds_read_b128 v[76:79], v8 offset:46080
    v_exp_f32 v131, v131
    v_exp_f32 v132, v132
    v_exp_f32 v133, v133
    v_smfmac_f32_16x16x64_bf16 v[148:151], v[152:155], v[112:119], v7
    v_exp_f32 v134, v134
    v_exp_f32 v135, v135
    v_smfmac_f32_32x32x32_bf16 v[32:47], v[80:83], v[112:119], v7
    v_exp_f32 v136, v136
    v_exp_f32 v137, v137
    v_exp_f32 v138, v138
    v_smfmac_f32_32x32x32_bf16 v[32:47], v[84:87], v[120:127], v7
    v_exp_f32 v139, v139
    v_exp_f32 v140, v140
    v_exp_f32 v141, v141
    v_smfmac_f32_16x16x64_bf16 v[148:151], v[152:155], v[120:127], v7
    v_exp_f32 v142, v142
    v_exp_f32 v143, v143
    s_waitcnt lgkmcnt(2)
    v_mfma_f32_32x32x16_bf16 v[96:111], v[64:67], v[48:51], 0
    ds_read_b128 v[80:83], v8 offset:43008
    v_exp_f32 v160, v160
    v_exp_f32 v161, v161
    v_exp_f32 v162, v162
    v_mfma_f32_32x32x16_bf16 v[96:111], v[68:71], v[52:55], v[96:111]
    ds_read_b128 v[84:87], v8 offset:44032
    v_exp_f32 v163, v163
    v_exp_f32 v164, v164
    v_exp_f32 v165, v165
    v_smfmac_f32_16x16x64_bf16 v[144:147], v[152:155], v[128:135], v7
    v_exp_f32 v166, v166
    v_exp_f32 v167, v167
    v_smfmac_f32_32x32x32_bf16 v[16:31], v[88:91], v[128:135], v7
    v_exp_f32 v168, v168
    v_exp_f32 v169, v169
    v_exp_f32 v170, v170
    v_smfmac_f32_32x32x32_bf16 v[16:31], v[92:95], v[136:143], v7
    v_exp_f32 v171, v171
    v_exp_f32 v172, v172
    v_exp_f32 v173, v173
    v_smfmac_f32_16x16x64_bf16 v[144:147], v[152:155], v[136:143], v7
    v_exp_f32 v174, v174
    v_exp_f32 v175, v175
    v_mfma_f32_32x32x16_bf16 v[112:127], v[64:67], v[56:59], 0
    s_barrier
    ds_read_b128 v[64:67], v8 offset:49152
    v_exp_f32 v96, v96
    v_exp_f32 v97, v97
    v_exp_f32 v98, v98
    v_mfma_f32_32x32x16_bf16 v[112:127], v[68:71], v[60:63], v[112:127]
    ds_read_b128 v[68:71], v8 offset:50176
    v_exp_f32 v99, v99
    v_exp_f32 v100, v100
    v_exp_f32 v101, v101
    v_smfmac_f32_16x16x64_bf16 v[148:151], v[152:155], v[160:167], v7
    v_exp_f32 v102, v102
    v_exp_f32 v103, v103
    v_smfmac_f32_32x32x32_bf16 v[32:47], v[88:91], v[160:167], v7
    v_exp_f32 v104, v104
    v_exp_f32 v105, v105
    v_exp_f32 v106, v106
    v_smfmac_f32_32x32x32_bf16 v[32:47], v[92:95], v[168:175], v7
    v_exp_f32 v107, v107
    v_exp_f32 v108, v108
    v_exp_f32 v109, v109
    v_smfmac_f32_16x16x64_bf16 v[148:151], v[152:155], v[168:175], v7
    v_exp_f32 v110, v110
    v_exp_f32 v111, v111
    s_waitcnt lgkmcnt(2)
    v_mfma_f32_32x32x16_bf16 v[128:143], v[72:75], v[48:51], 0
    ds_read_b128 v[88:91], v8 offset:47104
    v_exp_f32 v112, v112
    v_exp_f32 v113, v113
    v_exp_f32 v114, v114
    v_mfma_f32_32x32x16_bf16 v[128:143], v[76:79], v[52:55], v[128:143]
    ds_read_b128 v[92:95], v8 offset:48128
    v_exp_f32 v115, v115
    v_exp_f32 v116, v116
    v_exp_f32 v117, v117
    v_smfmac_f32_16x16x64_bf16 v[144:147], v[152:155], v[96:103], v7
    v_exp_f32 v118, v118
    v_exp_f32 v119, v119
    v_smfmac_f32_32x32x32_bf16 v[16:31], v[80:83], v[96:103], v7
    v_exp_f32 v120, v120
    v_exp_f32 v121, v121
    v_exp_f32 v122, v122
    v_smfmac_f32_32x32x32_bf16 v[16:31], v[84:87], v[104:111], v7
    v_exp_f32 v123, v123
    v_exp_f32 v124, v124
    v_exp_f32 v125, v125
    v_smfmac_f32_16x16x64_bf16 v[144:147], v[152:155], v[104:111], v7
    v_exp_f32 v126, v126
    v_exp_f32 v127, v127
    v_mfma_f32_32x32x16_bf16 v[160:175], v[72:75], v[56:59], 0
    ds_read_b128 v[72:75], v8 offset:53248
    v_exp_f32 v128, v128
    v_exp_f32 v129, v129
    v_exp_f32 v130, v130
    v_mfma_f32_32x32x16_bf16 v[160:175], v[76:79], v[60:63], v[160:175]
    ds_read_b128 v[76:79], v8 offset:54272
    v_exp_f32 v131, v131
    v_exp_f32 v132, v132
    v_exp_f32 v133, v133
    v_smfmac_f32_16x16x64_bf16 v[148:151], v[152:155], v[112:119], v7
    v_exp_f32 v134, v134
    v_exp_f32 v135, v135
    v_smfmac_f32_32x32x32_bf16 v[32:47], v[80:83], v[112:119], v7
    v_exp_f32 v136, v136
    v_exp_f32 v137, v137
    v_exp_f32 v138, v138
    v_smfmac_f32_32x32x32_bf16 v[32:47], v[84:87], v[120:127], v7
    v_exp_f32 v139, v139
    v_exp_f32 v140, v140
    v_exp_f32 v141, v141
    v_smfmac_f32_16x16x64_bf16 v[148:151], v[152:155], v[120:127], v7
    v_exp_f32 v142, v142
    v_exp_f32 v143, v143
    s_waitcnt lgkmcnt(2)
    v_mfma_f32_32x32x16_bf16 v[96:111], v[64:67], v[48:51], 0
    ds_read_b128 v[80:83], v8 offset:51200
    v_exp_f32 v160, v160
    v_exp_f32 v161, v161
    v_exp_f32 v162, v162
    v_mfma_f32_32x32x16_bf16 v[96:111], v[68:71], v[52:55], v[96:111]
    ds_read_b128 v[84:87], v8 offset:52224
    v_exp_f32 v163, v163
    v_exp_f32 v164, v164
    v_exp_f32 v165, v165
    v_smfmac_f32_16x16x64_bf16 v[144:147], v[152:155], v[128:135], v7
    v_exp_f32 v166, v166
    v_exp_f32 v167, v167
    v_smfmac_f32_32x32x32_bf16 v[16:31], v[88:91], v[128:135], v7
    v_exp_f32 v168, v168
    v_exp_f32 v169, v169
    v_exp_f32 v170, v170
    v_smfmac_f32_32x32x32_bf16 v[16:31], v[92:95], v[136:143], v7
    v_exp_f32 v171, v171
    v_exp_f32 v172, v172
    v_exp_f32 v173, v173
    v_smfmac_f32_16x16x64_bf16 v[144:147], v[152:155], v[136:143], v7
    v_exp_f32 v174, v174
    v_exp_f32 v175, v175
    v_mfma_f32_32x32x16_bf16 v[112:127], v[64:67], v[56:59], 0
    ds_read_b128 v[64:67], v8 offset:57344
    v_exp_f32 v96, v96
    v_exp_f32 v97, v97
    v_exp_f32 v98, v98
    v_mfma_f32_32x32x16_bf16 v[112:127], v[68:71], v[60:63], v[112:127]
    ds_read_b128 v[68:71], v8 offset:58368
    v_exp_f32 v99, v99
    v_exp_f32 v100, v100
    v_exp_f32 v101, v101
    v_smfmac_f32_16x16x64_bf16 v[148:151], v[152:155], v[160:167], v7
    v_exp_f32 v102, v102
    v_exp_f32 v103, v103
    v_smfmac_f32_32x32x32_bf16 v[32:47], v[88:91], v[160:167], v7
    v_exp_f32 v104, v104
    v_exp_f32 v105, v105
    v_exp_f32 v106, v106
    v_smfmac_f32_32x32x32_bf16 v[32:47], v[92:95], v[168:175], v7
    v_exp_f32 v107, v107
    v_exp_f32 v108, v108
    v_exp_f32 v109, v109
    v_smfmac_f32_16x16x64_bf16 v[148:151], v[152:155], v[168:175], v7
    v_exp_f32 v110, v110
    v_exp_f32 v111, v111
    s_waitcnt lgkmcnt(2)
    v_mfma_f32_32x32x16_bf16 v[128:143], v[72:75], v[48:51], 0
    ds_read_b128 v[88:91], v8 offset:55296
    v_exp_f32 v112, v112
    v_exp_f32 v113, v113
    v_exp_f32 v114, v114
    v_mfma_f32_32x32x16_bf16 v[128:143], v[76:79], v[52:55], v[128:143]
    ds_read_b128 v[92:95], v8 offset:56320
    v_exp_f32 v115, v115
    v_exp_f32 v116, v116
    v_exp_f32 v117, v117
    v_smfmac_f32_16x16x64_bf16 v[144:147], v[152:155], v[96:103], v7
    v_exp_f32 v118, v118
    v_exp_f32 v119, v119
    v_smfmac_f32_32x32x32_bf16 v[16:31], v[80:83], v[96:103], v7
    v_exp_f32 v120, v120
    v_exp_f32 v121, v121
    v_exp_f32 v122, v122
    v_smfmac_f32_32x32x32_bf16 v[16:31], v[84:87], v[104:111], v7
    v_exp_f32 v123, v123
    v_exp_f32 v124, v124
    v_exp_f32 v125, v125
    v_smfmac_f32_16x16x64_bf16 v[144:147], v[152:155], v[104:111], v7
    v_exp_f32 v126, v126
    v_exp_f32 v127, v127
    v_mfma_f32_32x32x16_bf16 v[160:175], v[72:75], v[56:59], 0
    ds_read_b128 v[72:75], v8 offset:61440
    v_exp_f32 v128, v128
    v_exp_f32 v129, v129
    v_exp_f32 v130, v130
    v_mfma_f32_32x32x16_bf16 v[160:175], v[76:79], v[60:63], v[160:175]
    ds_read_b128 v[76:79], v8 offset:62464
    v_exp_f32 v131, v131
    v_exp_f32 v132, v132
    v_exp_f32 v133, v133
    v_smfmac_f32_16x16x64_bf16 v[148:151], v[152:155], v[112:119], v7
    v_exp_f32 v134, v134
    v_exp_f32 v135, v135
    v_smfmac_f32_32x32x32_bf16 v[32:47], v[80:83], v[112:119], v7
    v_exp_f32 v136, v136
    v_exp_f32 v137, v137
    v_exp_f32 v138, v138
    v_smfmac_f32_32x32x32_bf16 v[32:47], v[84:87], v[120:127], v7
    v_exp_f32 v139, v139
    v_exp_f32 v140, v140
    v_exp_f32 v141, v141
    v_smfmac_f32_16x16x64_bf16 v[148:151], v[152:155], v[120:127], v7
    v_exp_f32 v142, v142
    v_exp_f32 v143, v143
    s_waitcnt lgkmcnt(2)
    v_mfma_f32_32x32x16_bf16 v[96:111], v[64:67], v[48:51], 0
    ds_read_b128 v[80:83], v8 offset:59392
    v_exp_f32 v160, v160
    v_exp_f32 v161, v161
    v_exp_f32 v162, v162
    v_mfma_f32_32x32x16_bf16 v[96:111], v[68:71], v[52:55], v[96:111]
    ds_read_b128 v[84:87], v8 offset:60416
    v_exp_f32 v163, v163
    v_exp_f32 v164, v164
    v_exp_f32 v165, v165
    v_smfmac_f32_16x16x64_bf16 v[144:147], v[152:155], v[128:135], v7
    v_exp_f32 v166, v166
    v_exp_f32 v167, v167
    v_smfmac_f32_32x32x32_bf16 v[16:31], v[88:91], v[128:135], v7
    v_exp_f32 v168, v168
    v_exp_f32 v169, v169
    v_exp_f32 v170, v170
    v_smfmac_f32_32x32x32_bf16 v[16:31], v[92:95], v[136:143], v7
    v_exp_f32 v171, v171
    v_exp_f32 v172, v172
    v_exp_f32 v173, v173
    v_smfmac_f32_16x16x64_bf16 v[144:147], v[152:155], v[136:143], v7
    v_exp_f32 v174, v174
    v_exp_f32 v175, v175
    v_mfma_f32_32x32x16_bf16 v[112:127], v[64:67], v[56:59], 0
    s_barrier
    ds_read_b128 v[64:67], v8 offset:0
    v_exp_f32 v96, v96
    v_exp_f32 v97, v97
    v_exp_f32 v98, v98
    v_mfma_f32_32x32x16_bf16 v[112:127], v[68:71], v[60:63], v[112:127]
    ds_read_b128 v[68:71], v8 offset:1024
    v_exp_f32 v99, v99
    v_exp_f32 v100, v100
    v_exp_f32 v101, v101
    v_smfmac_f32_16x16x64_bf16 v[148:151], v[152:155], v[160:167], v7
    v_exp_f32 v102, v102
    v_exp_f32 v103, v103
    v_smfmac_f32_32x32x32_bf16 v[32:47], v[88:91], v[160:167], v7
    v_exp_f32 v104, v104
    v_exp_f32 v105, v105
    v_exp_f32 v106, v106
    v_smfmac_f32_32x32x32_bf16 v[32:47], v[92:95], v[168:175], v7
    v_exp_f32 v107, v107
    v_exp_f32 v108, v108
    v_exp_f32 v109, v109
    v_smfmac_f32_16x16x64_bf16 v[148:151], v[152:155], v[168:175], v7
    v_exp_f32 v110, v110
    v_exp_f32 v111, v111
    s_waitcnt lgkmcnt(2)
    v_mfma_f32_32x32x16_bf16 v[128:143], v[72:75], v[48:51], 0
    ds_read_b128 v[88:91], v8 offset:63488
    v_exp_f32 v112, v112
    v_exp_f32 v113, v113
    v_exp_f32 v114, v114
    v_mfma_f32_32x32x16_bf16 v[128:143], v[76:79], v[52:55], v[128:143]
    ds_read_b128 v[92:95], v8 offset:64512
    v_exp_f32 v115, v115
    v_exp_f32 v116, v116
    v_exp_f32 v117, v117
    v_smfmac_f32_16x16x64_bf16 v[144:147], v[152:155], v[96:103], v7
    v_exp_f32 v118, v118
    v_exp_f32 v119, v119
    v_smfmac_f32_32x32x32_bf16 v[16:31], v[80:83], v[96:103], v7
    v_exp_f32 v120, v120
    v_exp_f32 v121, v121
    v_exp_f32 v122, v122
    v_smfmac_f32_32x32x32_bf16 v[16:31], v[84:87], v[104:111], v7
    v_exp_f32 v123, v123
    v_exp_f32 v124, v124
    v_exp_f32 v125, v125
    v_smfmac_f32_16x16x64_bf16 v[144:147], v[152:155], v[104:111], v7
    v_exp_f32 v126, v126
    v_exp_f32 v127, v127
    v_mfma_f32_32x32x16_bf16 v[160:175], v[72:75], v[56:59], 0
    ds_read_b128 v[72:75], v8 offset:4096
    v_exp_f32 v128, v128
    v_exp_f32 v129, v129
    v_exp_f32 v130, v130
    v_mfma_f32_32x32x16_bf16 v[160:175], v[76:79], v[60:63], v[160:175]
    ds_read_b128 v[76:79], v8 offset:5120
    v_exp_f32 v131, v131
    v_exp_f32 v132, v132
    v_exp_f32 v133, v133
    v_smfmac_f32_16x16x64_bf16 v[148:151], v[152:155], v[112:119], v7
    v_exp_f32 v134, v134
    v_exp_f32 v135, v135
    v_smfmac_f32_32x32x32_bf16 v[32:47], v[80:83], v[112:119], v7
    v_exp_f32 v136, v136
    v_exp_f32 v137, v137
    v_exp_f32 v138, v138
    v_smfmac_f32_32x32x32_bf16 v[32:47], v[84:87], v[120:127], v7
    v_exp_f32 v139, v139
    v_exp_f32 v140, v140
    v_exp_f32 v141, v141
    v_smfmac_f32_16x16x64_bf16 v[148:151], v[152:155], v[120:127], v7
    v_exp_f32 v142, v142
    v_exp_f32 v143, v143
    s_waitcnt lgkmcnt(2)
    v_mfma_f32_32x32x16_bf16 v[96:111], v[64:67], v[48:51], 0
    ds_read_b128 v[80:83], v8 offset:2048
    v_exp_f32 v160, v160
    v_exp_f32 v161, v161
    v_exp_f32 v162, v162
    v_mfma_f32_32x32x16_bf16 v[96:111], v[68:71], v[52:55], v[96:111]
    ds_read_b128 v[84:87], v8 offset:3072
    v_exp_f32 v163, v163
    v_exp_f32 v164, v164
    v_exp_f32 v165, v165
    v_smfmac_f32_16x16x64_bf16 v[144:147], v[152:155], v[128:135], v7
    v_exp_f32 v166, v166
    v_exp_f32 v167, v167
    v_smfmac_f32_32x32x32_bf16 v[16:31], v[88:91], v[128:135], v7
    v_exp_f32 v168, v168
    v_exp_f32 v169, v169
    v_exp_f32 v170, v170
    v_smfmac_f32_32x32x32_bf16 v[16:31], v[92:95], v[136:143], v7
    v_exp_f32 v171, v171
    v_exp_f32 v172, v172
    v_exp_f32 v173, v173
    v_smfmac_f32_16x16x64_bf16 v[144:147], v[152:155], v[136:143], v7
    v_exp_f32 v174, v174
    v_exp_f32 v175, v175
    v_mfma_f32_32x32x16_bf16 v[112:127], v[64:67], v[56:59], 0
    ds_read_b128 v[64:67], v8 offset:8192
    v_exp_f32 v96, v96
    v_exp_f32 v97, v97
    v_exp_f32 v98, v98
    v_mfma_f32_32x32x16_bf16 v[112:127], v[68:71], v[60:63], v[112:127]
    ds_read_b128 v[68:71], v8 offset:9216
    v_exp_f32 v99, v99
    v_exp_f32 v100, v100
    v_exp_f32 v101, v101
    v_smfmac_f32_16x16x64_bf16 v[148:151], v[152:155], v[160:167], v7
    v_exp_f32 v102, v102
    v_exp_f32 v103, v103
    v_smfmac_f32_32x32x32_bf16 v[32:47], v[88:91], v[160:167], v7
    v_exp_f32 v104, v104
    v_exp_f32 v105, v105
    v_exp_f32 v106, v106
    v_smfmac_f32_32x32x32_bf16 v[32:47], v[92:95], v[168:175], v7
    v_exp_f32 v107, v107
    v_exp_f32 v108, v108
    v_exp_f32 v109, v109
    v_smfmac_f32_16x16x64_bf16 v[148:151], v[152:155], v[168:175], v7
    v_exp_f32 v110, v110
    v_exp_f32 v111, v111
    s_waitcnt lgkmcnt(2)
    v_mfma_f32_32x32x16_bf16 v[128:143], v[72:75], v[48:51], 0
    ds_read_b128 v[88:91], v8 offset:6144
    v_exp_f32 v112, v112
    v_exp_f32 v113, v113
    v_exp_f32 v114, v114
    v_mfma_f32_32x32x16_bf16 v[128:143], v[76:79], v[52:55], v[128:143]
    ds_read_b128 v[92:95], v8 offset:7168
    v_exp_f32 v115, v115
    v_exp_f32 v116, v116
    v_exp_f32 v117, v117
    v_smfmac_f32_16x16x64_bf16 v[144:147], v[152:155], v[96:103], v7
    v_exp_f32 v118, v118
    v_exp_f32 v119, v119
    v_smfmac_f32_32x32x32_bf16 v[16:31], v[80:83], v[96:103], v7
    v_exp_f32 v120, v120
    v_exp_f32 v121, v121
    v_exp_f32 v122, v122
    v_smfmac_f32_32x32x32_bf16 v[16:31], v[84:87], v[104:111], v7
    v_exp_f32 v123, v123
    v_exp_f32 v124, v124
    v_exp_f32 v125, v125
    v_smfmac_f32_16x16x64_bf16 v[144:147], v[152:155], v[104:111], v7
    v_exp_f32 v126, v126
    v_exp_f32 v127, v127
    v_mfma_f32_32x32x16_bf16 v[160:175], v[72:75], v[56:59], 0
    ds_read_b128 v[72:75], v8 offset:12288
    v_exp_f32 v128, v128
    v_exp_f32 v129, v129
    v_exp_f32 v130, v130
    v_mfma_f32_32x32x16_bf16 v[160:175], v[76:79], v[60:63], v[160:175]
    ds_read_b128 v[76:79], v8 offset:13312
    v_exp_f32 v131, v131
    v_exp_f32 v132, v132
    v_exp_f32 v133, v133
    v_smfmac_f32_16x16x64_bf16 v[148:151], v[152:155], v[112:119], v7
    v_exp_f32 v134, v134
    v_exp_f32 v135, v135
    v_smfmac_f32_32x32x32_bf16 v[32:47], v[80:83], v[112:119], v7
    v_exp_f32 v136, v136
    v_exp_f32 v137, v137
    v_exp_f32 v138, v138
    v_smfmac_f32_32x32x32_bf16 v[32:47], v[84:87], v[120:127], v7
    v_exp_f32 v139, v139
    v_exp_f32 v140, v140
    v_exp_f32 v141, v141
    v_smfmac_f32_16x16x64_bf16 v[148:151], v[152:155], v[120:127], v7
    v_exp_f32 v142, v142
    v_exp_f32 v143, v143
    s_waitcnt lgkmcnt(2)
    v_mfma_f32_32x32x16_bf16 v[96:111], v[64:67], v[48:51], 0
    ds_read_b128 v[80:83], v8 offset:10240
    v_exp_f32 v160, v160
    v_exp_f32 v161, v161
    v_exp_f32 v162, v162
    v_mfma_f32_32x32x16_bf16 v[96:111], v[68:71], v[52:55], v[96:111]
    ds_read_b128 v[84:87], v8 offset:11264
    v_exp_f32 v163, v163
    v_exp_f32 v164, v164
    v_exp_f32 v165, v165
    v_smfmac_f32_16x16x64_bf16 v[144:147], v[152:155], v[128:135], v7
    v_exp_f32 v166, v166
    v_exp_f32 v167, v167
    v_smfmac_f32_32x32x32_bf16 v[16:31], v[88:91], v[128:135], v7
    v_exp_f32 v168, v168
    v_exp_f32 v169, v169
    v_exp_f32 v170, v170
    v_smfmac_f32_32x32x32_bf16 v[16:31], v[92:95], v[136:143], v7
    v_exp_f32 v171, v171
    v_exp_f32 v172, v172
    v_exp_f32 v173, v173
    v_smfmac_f32_16x16x64_bf16 v[144:147], v[152:155], v[136:143], v7
    v_exp_f32 v174, v174
    v_exp_f32 v175, v175
    v_mfma_f32_32x32x16_bf16 v[112:127], v[64:67], v[56:59], 0
    s_barrier
    ds_read_b128 v[64:67], v8 offset:16384
    v_exp_f32 v96, v96
    v_exp_f32 v97, v97
    v_exp_f32 v98, v98
    v_mfma_f32_32x32x16_bf16 v[112:127], v[68:71], v[60:63], v[112:127]
    ds_read_b128 v[68:71], v8 offset:17408
    v_exp_f32 v99, v99
    v_exp_f32 v100, v100
    v_exp_f32 v101, v101
    v_smfmac_f32_16x16x64_bf16 v[148:151], v[152:155], v[160:167], v7
    v_exp_f32 v102, v102
    v_exp_f32 v103, v103
    v_smfmac_f32_32x32x32_bf16 v[32:47], v[88:91], v[160:167], v7
    v_exp_f32 v104, v104
    v_exp_f32 v105, v105
    v_exp_f32 v106, v106
    v_smfmac_f32_32x32x32_bf16 v[32:47], v[92:95], v[168:175], v7
    v_exp_f32 v107, v107
    v_exp_f32 v108, v108
    v_exp_f32 v109, v109
    v_smfmac_f32_16x16x64_bf16 v[148:151], v[152:155], v[168:175], v7
    v_exp_f32 v110, v110
    v_exp_f32 v111, v111
    s_waitcnt lgkmcnt(2)
    v_mfma_f32_32x32x16_bf16 v[128:143], v[72:75], v[48:51], 0
    ds_read_b128 v[88:91], v8 offset:14336
    v_exp_f32 v112, v112
    v_exp_f32 v113, v113
    v_exp_f32 v114, v114
    v_mfma_f32_32x32x16_bf16 v[128:143], v[76:79], v[52:55], v[128:143]
    ds_read_b128 v[92:95], v8 offset:15360
    v_exp_f32 v115, v115
    v_exp_f32 v116, v116
    v_exp_f32 v117, v117
    v_smfmac_f32_16x16x64_bf16 v[144:147], v[152:155], v[96:103], v7
    v_exp_f32 v118, v118
    v_exp_f32 v119, v119
    v_smfmac_f32_32x32x32_bf16 v[16:31], v[80:83], v[96:103], v7
    v_exp_f32 v120, v120
    v_exp_f32 v121, v121
    v_exp_f32 v122, v122
    v_smfmac_f32_32x32x32_bf16 v[16:31], v[84:87], v[104:111], v7
    v_exp_f32 v123, v123
    v_exp_f32 v124, v124
    v_exp_f32 v125, v125
    v_smfmac_f32_16x16x64_bf16 v[144:147], v[152:155], v[104:111], v7
    v_exp_f32 v126, v126
    v_exp_f32 v127, v127
    v_mfma_f32_32x32x16_bf16 v[160:175], v[72:75], v[56:59], 0
    ds_read_b128 v[72:75], v8 offset:20480
    v_exp_f32 v128, v128
    v_exp_f32 v129, v129
    v_exp_f32 v130, v130
    v_mfma_f32_32x32x16_bf16 v[160:175], v[76:79], v[60:63], v[160:175]
    ds_read_b128 v[76:79], v8 offset:21504
    v_exp_f32 v131, v131
    v_exp_f32 v132, v132
    v_exp_f32 v133, v133
    v_smfmac_f32_16x16x64_bf16 v[148:151], v[152:155], v[112:119], v7
    v_exp_f32 v134, v134
    v_exp_f32 v135, v135
    v_smfmac_f32_32x32x32_bf16 v[32:47], v[80:83], v[112:119], v7
    v_exp_f32 v136, v136
    v_exp_f32 v137, v137
    v_exp_f32 v138, v138
    v_smfmac_f32_32x32x32_bf16 v[32:47], v[84:87], v[120:127], v7
    v_exp_f32 v139, v139
    v_exp_f32 v140, v140
    v_exp_f32 v141, v141
    v_smfmac_f32_16x16x64_bf16 v[148:151], v[152:155], v[120:127], v7
    v_exp_f32 v142, v142
    v_exp_f32 v143, v143
    s_waitcnt lgkmcnt(2)
    v_mfma_f32_32x32x16_bf16 v[96:111], v[64:67], v[48:51], 0
    ds_read_b128 v[80:83], v8 offset:18432
    v_exp_f32 v160, v160
    v_exp_f32 v161, v161
    v_exp_f32 v162, v162
    v_mfma_f32_32x32x16_bf16 v[96:111], v[68:71], v[52:55], v[96:111]
    ds_read_b128 v[84:87], v8 offset:19456
    v_exp_f32 v163, v163
    v_exp_f32 v164, v164
    v_exp_f32 v165, v165
    v_smfmac_f32_16x16x64_bf16 v[144:147], v[152:155], v[128:135], v7
    v_exp_f32 v166, v166
    v_exp_f32 v167, v167
    v_smfmac_f32_32x32x32_bf16 v[16:31], v[88:91], v[128:135], v7
    v_exp_f32 v168, v168
    v_exp_f32 v169, v169
    v_exp_f32 v170, v170
    v_smfmac_f32_32x32x32_bf16 v[16:31], v[92:95], v[136:143], v7
    v_exp_f32 v171, v171
    v_exp_f32 v172, v172
    v_exp_f32 v173, v173
    v_smfmac_f32_16x16x64_bf16 v[144:147], v[152:155], v[136:143], v7
    v_exp_f32 v174, v174
    v_exp_f32 v175, v175
    v_mfma_f32_32x32x16_bf16 v[112:127], v[64:67], v[56:59], 0
    ds_read_b128 v[64:67], v8 offset:24576
    v_exp_f32 v96, v96
    v_exp_f32 v97, v97
    v_exp_f32 v98, v98
    v_mfma_f32_32x32x16_bf16 v[112:127], v[68:71], v[60:63], v[112:127]
    ds_read_b128 v[68:71], v8 offset:25600
    v_exp_f32 v99, v99
    v_exp_f32 v100, v100
    v_exp_f32 v101, v101
    v_smfmac_f32_16x16x64_bf16 v[148:151], v[152:155], v[160:167], v7
    v_exp_f32 v102, v102
    v_exp_f32 v103, v103
    v_smfmac_f32_32x32x32_bf16 v[32:47], v[88:91], v[160:167], v7
    v_exp_f32 v104, v104
    v_exp_f32 v105, v105
    v_exp_f32 v106, v106
    v_smfmac_f32_32x32x32_bf16 v[32:47], v[92:95], v[168:175], v7
    v_exp_f32 v107, v107
    v_exp_f32 v108, v108
    v_exp_f32 v109, v109
    v_smfmac_f32_16x16x64_bf16 v[148:151], v[152:155], v[168:175], v7
    v_exp_f32 v110, v110
    v_exp_f32 v111, v111
    s_waitcnt lgkmcnt(2)
    v_mfma_f32_32x32x16_bf16 v[128:143], v[72:75], v[48:51], 0
    ds_read_b128 v[88:91], v8 offset:22528
    v_exp_f32 v112, v112
    v_exp_f32 v113, v113
    v_exp_f32 v114, v114
    v_mfma_f32_32x32x16_bf16 v[128:143], v[76:79], v[52:55], v[128:143]
    ds_read_b128 v[92:95], v8 offset:23552
    v_exp_f32 v115, v115
    v_exp_f32 v116, v116
    v_exp_f32 v117, v117
    v_smfmac_f32_16x16x64_bf16 v[144:147], v[152:155], v[96:103], v7
    v_exp_f32 v118, v118
    v_exp_f32 v119, v119
    v_smfmac_f32_32x32x32_bf16 v[16:31], v[80:83], v[96:103], v7
    v_exp_f32 v120, v120
    v_exp_f32 v121, v121
    v_exp_f32 v122, v122
    v_smfmac_f32_32x32x32_bf16 v[16:31], v[84:87], v[104:111], v7
    v_exp_f32 v123, v123
    v_exp_f32 v124, v124
    v_exp_f32 v125, v125
    v_smfmac_f32_16x16x64_bf16 v[144:147], v[152:155], v[104:111], v7
    v_exp_f32 v126, v126
    v_exp_f32 v127, v127
    v_mfma_f32_32x32x16_bf16 v[160:175], v[72:75], v[56:59], 0
    ds_read_b128 v[72:75], v8 offset:28672
    v_exp_f32 v128, v128
    v_exp_f32 v129, v129
    v_exp_f32 v130, v130
    v_mfma_f32_32x32x16_bf16 v[160:175], v[76:79], v[60:63], v[160:175]
    ds_read_b128 v[76:79], v8 offset:29696
    v_exp_f32 v131, v131
    v_exp_f32 v132, v132
    v_exp_f32 v133, v133
    v_smfmac_f32_16x16x64_bf16 v[148:151], v[152:155], v[112:119], v7
    v_exp_f32 v134, v134
    v_exp_f32 v135, v135
    v_smfmac_f32_32x32x32_bf16 v[32:47], v[80:83], v[112:119], v7
    v_exp_f32 v136, v136
    v_exp_f32 v137, v137
    v_exp_f32 v138, v138
    v_smfmac_f32_32x32x32_bf16 v[32:47], v[84:87], v[120:127], v7
    v_exp_f32 v139, v139
    v_exp_f32 v140, v140
    v_exp_f32 v141, v141
    v_smfmac_f32_16x16x64_bf16 v[148:151], v[152:155], v[120:127], v7
    v_exp_f32 v142, v142
    v_exp_f32 v143, v143
    s_waitcnt lgkmcnt(2)
    v_mfma_f32_32x32x16_bf16 v[96:111], v[64:67], v[48:51], 0
    ds_read_b128 v[80:83], v8 offset:26624
    v_exp_f32 v160, v160
    v_exp_f32 v161, v161
    v_exp_f32 v162, v162
    v_mfma_f32_32x32x16_bf16 v[96:111], v[68:71], v[52:55], v[96:111]
    ds_read_b128 v[84:87], v8 offset:27648
    v_exp_f32 v163, v163
    v_exp_f32 v164, v164
    v_exp_f32 v165, v165
    v_smfmac_f32_16x16x64_bf16 v[144:147], v[152:155], v[128:135], v7
    v_exp_f32 v166, v166
    v_exp_f32 v167, v167
    v_smfmac_f32_32x32x32_bf16 v[16:31], v[88:91], v[128:135], v7
    v_exp_f32 v168, v168
    v_exp_f32 v169, v169
    v_exp_f32 v170, v170
    v_smfmac_f32_32x32x32_bf16 v[16:31], v[92:95], v[136:143], v7
    v_exp_f32 v171, v171
    v_exp_f32 v172, v172
    v_exp_f32 v173, v173
    v_smfmac_f32_16x16x64_bf16 v[144:147], v[152:155], v[136:143], v7
    v_exp_f32 v174, v174
    v_exp_f32 v175, v175
    v_mfma_f32_32x32x16_bf16 v[112:127], v[64:67], v[56:59], 0
    s_barrier
    ds_read_b128 v[64:67], v8 offset:32768
    v_exp_f32 v96, v96
    v_exp_f32 v97, v97
    v_exp_f32 v98, v98
    v_mfma_f32_32x32x16_bf16 v[112:127], v[68:71], v[60:63], v[112:127]
    ds_read_b128 v[68:71], v8 offset:33792
    v_exp_f32 v99, v99
    v_exp_f32 v100, v100
    v_exp_f32 v101, v101
    v_smfmac_f32_16x16x64_bf16 v[148:151], v[152:155], v[160:167], v7
    v_exp_f32 v102, v102
    v_exp_f32 v103, v103
    v_smfmac_f32_32x32x32_bf16 v[32:47], v[88:91], v[160:167], v7
    v_exp_f32 v104, v104
    v_exp_f32 v105, v105
    v_exp_f32 v106, v106
    v_smfmac_f32_32x32x32_bf16 v[32:47], v[92:95], v[168:175], v7
    v_exp_f32 v107, v107
    v_exp_f32 v108, v108
    v_exp_f32 v109, v109
    v_smfmac_f32_16x16x64_bf16 v[148:151], v[152:155], v[168:175], v7
    v_exp_f32 v110, v110
    v_exp_f32 v111, v111
    s_waitcnt lgkmcnt(2)
    v_mfma_f32_32x32x16_bf16 v[128:143], v[72:75], v[48:51], 0
    ds_read_b128 v[88:91], v8 offset:30720
    v_exp_f32 v112, v112
    v_exp_f32 v113, v113
    v_exp_f32 v114, v114
    v_mfma_f32_32x32x16_bf16 v[128:143], v[76:79], v[52:55], v[128:143]
    ds_read_b128 v[92:95], v8 offset:31744
    v_exp_f32 v115, v115
    v_exp_f32 v116, v116
    v_exp_f32 v117, v117
    v_smfmac_f32_16x16x64_bf16 v[144:147], v[152:155], v[96:103], v7
    v_exp_f32 v118, v118
    v_exp_f32 v119, v119
    v_smfmac_f32_32x32x32_bf16 v[16:31], v[80:83], v[96:103], v7
    v_exp_f32 v120, v120
    v_exp_f32 v121, v121
    v_exp_f32 v122, v122
    v_smfmac_f32_32x32x32_bf16 v[16:31], v[84:87], v[104:111], v7
    v_exp_f32 v123, v123
    v_exp_f32 v124, v124
    v_exp_f32 v125, v125
    v_smfmac_f32_16x16x64_bf16 v[144:147], v[152:155], v[104:111], v7
    v_exp_f32 v126, v126
    v_exp_f32 v127, v127
    v_mfma_f32_32x32x16_bf16 v[160:175], v[72:75], v[56:59], 0
    ds_read_b128 v[72:75], v8 offset:36864
    v_exp_f32 v128, v128
    v_exp_f32 v129, v129
    v_exp_f32 v130, v130
    v_mfma_f32_32x32x16_bf16 v[160:175], v[76:79], v[60:63], v[160:175]
    ds_read_b128 v[76:79], v8 offset:37888
    v_exp_f32 v131, v131
    v_exp_f32 v132, v132
    v_exp_f32 v133, v133
    v_smfmac_f32_16x16x64_bf16 v[148:151], v[152:155], v[112:119], v7
    v_exp_f32 v134, v134
    v_exp_f32 v135, v135
    v_smfmac_f32_32x32x32_bf16 v[32:47], v[80:83], v[112:119], v7
    v_exp_f32 v136, v136
    v_exp_f32 v137, v137
    v_exp_f32 v138, v138
    v_smfmac_f32_32x32x32_bf16 v[32:47], v[84:87], v[120:127], v7
    v_exp_f32 v139, v139
    v_exp_f32 v140, v140
    v_exp_f32 v141, v141
    v_smfmac_f32_16x16x64_bf16 v[148:151], v[152:155], v[120:127], v7
    v_exp_f32 v142, v142
    v_exp_f32 v143, v143
    s_waitcnt lgkmcnt(2)
    v_mfma_f32_32x32x16_bf16 v[96:111], v[64:67], v[48:51], 0
    ds_read_b128 v[80:83], v8 offset:34816
    v_exp_f32 v160, v160
    v_exp_f32 v161, v161
    v_exp_f32 v162, v162
    v_mfma_f32_32x32x16_bf16 v[96:111], v[68:71], v[52:55], v[96:111]
    ds_read_b128 v[84:87], v8 offset:35840
    v_exp_f32 v163, v163
    v_exp_f32 v164, v164
    v_exp_f32 v165, v165
    v_smfmac_f32_16x16x64_bf16 v[144:147], v[152:155], v[128:135], v7
    v_exp_f32 v166, v166
    v_exp_f32 v167, v167
    v_smfmac_f32_32x32x32_bf16 v[16:31], v[88:91], v[128:135], v7
    v_exp_f32 v168, v168
    v_exp_f32 v169, v169
    v_exp_f32 v170, v170
    v_smfmac_f32_32x32x32_bf16 v[16:31], v[92:95], v[136:143], v7
    v_exp_f32 v171, v171
    v_exp_f32 v172, v172
    v_exp_f32 v173, v173
    v_smfmac_f32_16x16x64_bf16 v[144:147], v[152:155], v[136:143], v7
    v_exp_f32 v174, v174
    v_exp_f32 v175, v175
    s_sub_u32 s48, s48, 1
    s_cmp_lg_u32 s48, 0
    s_cbranch_scc1 .Latt_14
    v_smfmac_f32_32x32x32_bf16 v[32:47], v[88:91], v[160:167], v7
    v_smfmac_f32_16x16x64_bf16 v[148:151], v[152:155], v[160:167], v7
    v_smfmac_f32_32x32x32_bf16 v[32:47], v[92:95], v[168:175], v7
    v_smfmac_f32_16x16x64_bf16 v[148:151], v[152:155], v[168:175], v7
    s_add_u32 s44, s5, 0x480000
    s_add_u32 s45, s44, 8192
    s_nop 0
    v_pk_mul_f32 v[10:11], v[16:17], 0 op_sel_hi:[1,0]
    v_pk_fma_f32 v[10:11], v[18:19], 0, v[10:11] op_sel_hi:[1,0,1]
    v_pk_fma_f32 v[10:11], v[20:21], 0, v[10:11] op_sel_hi:[1,0,1]
    v_pk_fma_f32 v[10:11], v[22:23], 0, v[10:11] op_sel_hi:[1,0,1]
    v_pk_fma_f32 v[10:11], v[24:25], 0, v[10:11] op_sel_hi:[1,0,1]
    v_pk_fma_f32 v[10:11], v[26:27], 0, v[10:11] op_sel_hi:[1,0,1]
    v_pk_fma_f32 v[10:11], v[28:29], 0, v[10:11] op_sel_hi:[1,0,1]
    v_pk_fma_f32 v[10:11], v[30:31], 0, v[10:11] op_sel_hi:[1,0,1]
    v_pk_fma_f32 v[10:11], v[32:33], 0, v[10:11] op_sel_hi:[1,0,1]
    v_pk_fma_f32 v[10:11], v[34:35], 0, v[10:11] op_sel_hi:[1,0,1]
    v_pk_fma_f32 v[10:11], v[36:37], 0, v[10:11] op_sel_hi:[1,0,1]
    v_pk_fma_f32 v[10:11], v[38:39], 0, v[10:11] op_sel_hi:[1,0,1]
    v_pk_fma_f32 v[10:11], v[40:41], 0, v[10:11] op_sel_hi:[1,0,1]
    v_pk_fma_f32 v[10:11], v[42:43], 0, v[10:11] op_sel_hi:[1,0,1]
    v_pk_fma_f32 v[10:11], v[44:45], 0, v[10:11] op_sel_hi:[1,0,1]
    v_pk_fma_f32 v[10:11], v[46:47], 0, v[10:11] op_sel_hi:[1,0,1]
    v_mov_b32 v145, v144
    v_mov_b32 v149, v148
    s_nop 0
    v_permlane32_swap_b32 v144, v145
    v_permlane32_swap_b32 v148, v149
    v_add_f32 v10, v10, v11
    v_add_f32 v10, v10, v144
    s_mov_b32 s42, 0x2f800000
    s_mov_b32 s43, 0x76800000
    v_cmp_nle_f32 s[60:61], s42, v10
    v_cmp_nge_f32 vcc, s43, v10
    s_or_b64 s[60:61], vcc, s[60:61]
    v_cmp_nle_f32 vcc, s42, v148
    s_or_b64 s[60:61], vcc, s[60:61]
    v_cmp_nge_f32 vcc, s43, v148
    s_waitcnt lgkmcnt(0)
    s_or_b64 s[60:61], vcc, s[60:61]
    s_cbranch_scc1 .Lslow_15
.Lback_16:
    v_rcp_f32 v144, v144
    v_rcp_f32 v148, v148
    v_pk_mul_f32 v[16:17], v[16:17], v[144:145] op_sel_hi:[1,0]
    v_pk_mul_f32 v[18:19], v[18:19], v[144:145] op_sel_hi:[1,0]
    v_pk_mul_f32 v[20:21], v[20:21], v[144:145] op_sel_hi:[1,0]
    v_pk_mul_f32 v[22:23], v[22:23], v[144:145] op_sel_hi:[1,0]
    v_pk_mul_f32 v[24:25], v[24:25], v[144:145] op_sel_hi:[1,0]
    v_pk_mul_f32 v[26:27], v[26:27], v[144:145] op_sel_hi:[1,0]
    v_pk_mul_f32 v[28:29], v[28:29], v[144:145] op_sel_hi:[1,0]
    v_pk_mul_f32 v[30:31], v[30:31], v[144:145] op_sel_hi:[1,0]
    v_cvt_pk_bf16_f32 v48, v16, v17
    v_cvt_pk_bf16_f32 v49, v18, v19
    v_cvt_pk_bf16_f32 v50, v20, v21
    v_cvt_pk_bf16_f32 v51, v22, v23
    v_cvt_pk_bf16_f32 v52, v24, v25
    v_cvt_pk_bf16_f32 v53, v26, v27
    v_cvt_pk_bf16_f32 v54, v28, v29
    v_cvt_pk_bf16_f32 v55, v30, v31
    buffer_store_dwordx4 v[48:51], v9, s[24:27], s44 offen offset:0 sc1
    buffer_store_dwordx4 v[52:55], v9, s[24:27], s44 offen offset:512 sc1
    v_pk_mul_f32 v[32:33], v[32:33], v[148:149] op_sel_hi:[1,0]
    v_pk_mul_f32 v[34:35], v[34:35], v[148:149] op_sel_hi:[1,0]
    v_pk_mul_f32 v[36:37], v[36:37], v[148:149] op_sel_hi:[1,0]
    v_pk_mul_f32 v[38:39], v[38:39], v[148:149] op_sel_hi:[1,0]
    v_pk_mul_f32 v[40:41], v[40:41], v[148:149] op_sel_hi:[1,0]
    v_pk_mul_f32 v[42:43], v[42:43], v[148:149] op_sel_hi:[1,0]
    v_pk_mul_f32 v[44:45], v[44:45], v[148:149] op_sel_hi:[1,0]
    v_pk_mul_f32 v[46:47], v[46:47], v[148:149] op_sel_hi:[1,0]
    v_cvt_pk_bf16_f32 v56, v32, v33
    v_cvt_pk_bf16_f32 v57, v34, v35
    v_cvt_pk_bf16_f32 v58, v36, v37
    v_cvt_pk_bf16_f32 v59, v38, v39
    v_cvt_pk_bf16_f32 v60, v40, v41
    v_cvt_pk_bf16_f32 v61, v42, v43
    v_cvt_pk_bf16_f32 v62, v44, v45
    v_cvt_pk_bf16_f32 v63, v46, v47
    buffer_store_dwordx4 v[56:59], v9, s[24:27], s45 offen offset:0 sc1
    buffer_store_dwordx4 v[60:63], v9, s[24:27], s45 offen offset:512 sc1
    s_add_u32 s47, s9, 0x78000
    v_mov_b32 v15, 1
    s_waitcnt vmcnt(0)
    s_mov_b64 exec, 1
    buffer_atomic_add v15, v2, s[24:27], s47 offen sc0 sc1
    s_mov_b64 exec, -1
    s_barrier
    s_lshl_b32 s43, s23, 7
    v_and_b32 v4, 15, v0
    v_lshlrev_b32 v5, 1, v4
    buffer_load_ushort v196, v5, s[36:39], s43 offen offset:0
    v_mov_b32 v197, 0
    v_mov_b32 v198, 0
    v_mov_b32 v199, 0
    buffer_load_ushort v200, v5, s[36:39], s43 offen offset:32
    v_mov_b32 v201, 0
    v_mov_b32 v202, 0
    v_mov_b32 v203, 0
    buffer_load_ushort v204, v5, s[36:39], s43 offen offset:64
    v_mov_b32 v205, 0
    v_mov_b32 v206, 0
    v_mov_b32 v207, 0
    buffer_load_ushort v208, v5, s[36:39], s43 offen offset:96
    v_mov_b32 v209, 0
    v_mov_b32 v210, 0
    v_mov_b32 v211, 0
    v_cmp_gt_u32 vcc, 16, v0
    v_mov_b32 v6, 0x3f80
    v_mov_b32 v213, 0
    v_mov_b32 v214, 0
    v_mov_b32 v215, 0
    v_cndmask_b32 v212, 0, v6, vcc
    s_add_u32 s50, s4, 0x480000
    s_add_u32 s79, s5, 0x480000
    s_cmp_eq_u32 s50, s79
    s_cselect_b32 s43, 16384, 0
    s_add_u32 s50, s50, s43
    v_permlane32_swap_b32 v48, v52
    v_permlane32_swap_b32 v49, v53
    v_permlane32_swap_b32 v50, v54
    v_permlane32_swap_b32 v51, v55
    v_permlane32_swap_b32 v56, v60
    v_permlane32_swap_b32 v57, v61
    v_permlane32_swap_b32 v58, v62
    v_permlane32_swap_b32 v59, v63
    v_permlane16_swap_b32 v48, v52
    v_permlane16_swap_b32 v49, v53
    v_permlane16_swap_b32 v50, v54
    v_permlane16_swap_b32 v51, v55
    v_permlane16_swap_b32 v56, v60
    v_permlane16_swap_b32 v57, v61
    v_permlane16_swap_b32 v58, v62
    v_permlane16_swap_b32 v59, v63
    v_bfe_u32 v4, v0, 2, 3
    v_lshrrev_b32 v5, 5, v0
    v_lshl_add_u32 v5, v5, 4, v4
    v_lshlrev_b32 v216, 7, v5
    v_lshrrev_b32 v4, 1, v4
    v_lshl_add_u32 v216, v4, 5, v216
    v_and_b32 v4, 3, v0
    v_lshl_add_u32 v216, v4, 3, v216
    v_xor_b32 v217, 32, v216
    v_xor_b32 v218, 64, v216
    v_xor_b32 v219, 96, v216
    s_mov_b32 s58, 0x40000
    s_mov_b64 exec, 1
    s_waitcnt vmcnt(0)
    v_cmp_gt_u32 vcc, 15, v15
    s_cbranch_vccz .Lpollok_18
.Lpoll_17:
    v_mov_b32 v15, 0
    buffer_atomic_add v15, v2, s[24:27], s47 offen sc0 sc1
    s_waitcnt vmcnt(0)
    v_cmp_gt_u32 vcc, 16, v15
    s_cbranch_vccz .Lpollok_18
    s_sub_u32 s58, s58, 1
    s_cbranch_scc0 .Lpoll_17
.Lpollok_18:
    s_mov_b64 exec, -1
    buffer_load_dwordx4 v[64:67], v1, s[24:27], s50 offen offset:0 sc1
    buffer_load_dwordx4 v[68:71], v1, s[24:27], s50 offen offset:1024 sc1
    s_add_u32 s50, s50, 8192
    buffer_load_dwordx4 v[72:75], v1, s[24:27], s50 offen offset:0 sc1
    buffer_load_dwordx4 v[76:79], v1, s[24:27], s50 offen offset:1024 sc1
    s_add_u32 s50, s50, 8192
    s_cmp_eq_u32 s50, s79
    s_cselect_b32 s43, 16384, 0
    s_add_u32 s50, s50, s43
    buffer_load_dwordx4 v[80:83], v1, s[24:27], s50 offen offset:0 sc1
    buffer_load_dwordx4 v[84:87], v1, s[24:27], s50 offen offset:1024 sc1
    s_add_u32 s50, s50, 8192
    buffer_load_dwordx4 v[88:91], v1, s[24:27], s50 offen offset:0 sc1
    buffer_load_dwordx4 v[92:95], v1, s[24:27], s50 offen offset:1024 sc1
    s_add_u32 s50, s50, 8192
    s_cmp_eq_u32 s50, s79
    s_cselect_b32 s43, 16384, 0
    s_add_u32 s50, s50, s43
    buffer_load_dwordx4 v[96:99], v1, s[24:27], s50 offen offset:0 sc1
    buffer_load_dwordx4 v[100:103], v1, s[24:27], s50 offen offset:1024 sc1
    s_add_u32 s50, s50, 8192
    buffer_load_dwordx4 v[104:107], v1, s[24:27], s50 offen offset:0 sc1
    buffer_load_dwordx4 v[108:111], v1, s[24:27], s50 offen offset:1024 sc1
    s_add_u32 s50, s50, 8192
    s_cmp_eq_u32 s50, s79
    s_cselect_b32 s43, 16384, 0
    s_add_u32 s50, s50, s43
    ds_read_b64_tr_b16 v[112:113], v216 offset:0
    ds_read_b64_tr_b16 v[114:115], v216 offset:1024
    ds_read_b64_tr_b16 v[116:117], v217 offset:0
    ds_read_b64_tr_b16 v[118:119], v217 offset:1024
    ds_read_b64_tr_b16 v[120:121], v218 offset:0
    ds_read_b64_tr_b16 v[122:123], v218 offset:1024
    ds_read_b64_tr_b16 v[124:125], v219 offset:0
    ds_read_b64_tr_b16 v[126:127], v219 offset:1024
    ds_read_b64_tr_b16 v[128:129], v216 offset:4096
    ds_read_b64_tr_b16 v[130:131], v216 offset:5120
    s_waitcnt lgkmcnt(6)
    v_mfma_f32_16x16x32_bf16 v[224:227], v[112:115], v[48:51], v[224:227]
    ds_read_b64_tr_b16 v[132:133], v217 offset:4096
    ds_read_b64_tr_b16 v[134:135], v217 offset:5120
    v_mfma_f32_16x16x32_bf16 v[228:231], v[112:115], v[52:55], v[228:231]
    v_mfma_f32_16x16x32_bf16 v[236:239], v[116:119], v[52:55], v[236:239]
    ds_read_b64_tr_b16 v[136:137], v218 offset:4096
    ds_read_b64_tr_b16 v[138:139], v218 offset:5120
    v_mfma_f32_16x16x32_bf16 v[232:235], v[116:119], v[48:51], v[232:235]
    s_waitcnt lgkmcnt(6)
    v_mfma_f32_16x16x32_bf16 v[240:243], v[120:123], v[48:51], v[240:243]
    ds_read_b64_tr_b16 v[140:141], v219 offset:4096
    ds_read_b64_tr_b16 v[142:143], v219 offset:5120
    v_mfma_f32_16x16x32_bf16 v[244:247], v[120:123], v[52:55], v[244:247]
    v_mfma_f32_16x16x32_bf16 v[252:255], v[124:127], v[52:55], v[252:255]
    ds_read_b64_tr_b16 v[112:113], v216 offset:8192
    ds_read_b64_tr_b16 v[114:115], v216 offset:9216
    v_mfma_f32_16x16x32_bf16 v[248:251], v[124:127], v[48:51], v[248:251]
    s_waitcnt lgkmcnt(6)
    v_mfma_f32_16x16x32_bf16 v[224:227], v[128:131], v[56:59], v[224:227]
    ds_read_b64_tr_b16 v[116:117], v217 offset:8192
    ds_read_b64_tr_b16 v[118:119], v217 offset:9216
    v_mfma_f32_16x16x32_bf16 v[228:231], v[128:131], v[60:63], v[228:231]
    buffer_load_dwordx4 v[48:51], v1, s[24:27], s50 offen offset:0 sc1
    v_mfma_f32_16x16x32_bf16 v[236:239], v[132:135], v[60:63], v[236:239]
    ds_read_b64_tr_b16 v[120:121], v218 offset:8192
    ds_read_b64_tr_b16 v[122:123], v218 offset:9216
    v_mfma_f32_16x16x32_bf16 v[232:235], v[132:135], v[56:59], v[232:235]
    buffer_load_dwordx4 v[52:55], v1, s[24:27], s50 offen offset:1024 sc1
    s_waitcnt lgkmcnt(6)
    v_mfma_f32_16x16x32_bf16 v[240:243], v[136:139], v[56:59], v[240:243]
    ds_read_b64_tr_b16 v[124:125], v219 offset:8192
    ds_read_b64_tr_b16 v[126:127], v219 offset:9216
    v_mfma_f32_16x16x32_bf16 v[244:247], v[136:139], v[60:63], v[244:247]
    s_add_u32 s50, s50, 8192
    v_mfma_f32_16x16x32_bf16 v[252:255], v[140:143], v[60:63], v[252:255]
    ds_read_b64_tr_b16 v[128:129], v216 offset:12288
    ds_read_b64_tr_b16 v[130:131], v216 offset:13312
    v_mfma_f32_16x16x32_bf16 v[248:251], v[140:143], v[56:59], v[248:251]
    s_waitcnt vmcnt(12) lgkmcnt(6)
    v_mfma_f32_16x16x32_bf16 v[224:227], v[112:115], v[64:67], v[224:227]
    ds_read_b64_tr_b16 v[132:133], v217 offset:12288
    ds_read_b64_tr_b16 v[134:135], v217 offset:13312
    v_mfma_f32_16x16x32_bf16 v[228:231], v[112:115], v[68:71], v[228:231]
    buffer_load_dwordx4 v[56:59], v1, s[24:27], s50 offen offset:0 sc1
    v_mfma_f32_16x16x32_bf16 v[236:239], v[116:119], v[68:71], v[236:239]
    ds_read_b64_tr_b16 v[136:137], v218 offset:12288
    ds_read_b64_tr_b16 v[138:139], v218 offset:13312
    v_mfma_f32_16x16x32_bf16 v[232:235], v[116:119], v[64:67], v[232:235]
    buffer_load_dwordx4 v[60:63], v1, s[24:27], s50 offen offset:1024 sc1
    s_waitcnt lgkmcnt(6)
    v_mfma_f32_16x16x32_bf16 v[240:243], v[120:123], v[64:67], v[240:243]
    ds_read_b64_tr_b16 v[140:141], v219 offset:12288
    ds_read_b64_tr_b16 v[142:143], v219 offset:13312
    v_mfma_f32_16x16x32_bf16 v[244:247], v[120:123], v[68:71], v[244:247]
    s_add_u32 s50, s50, 8192
    s_cmp_eq_u32 s50, s79
    s_cselect_b32 s43, 16384, 0
    s_add_u32 s50, s50, s43
    v_mfma_f32_16x16x32_bf16 v[252:255], v[124:127], v[68:71], v[252:255]
    ds_read_b64_tr_b16 v[112:113], v216 offset:16384
    ds_read_b64_tr_b16 v[114:115], v216 offset:17408
    v_mfma_f32_16x16x32_bf16 v[248:251], v[124:127], v[64:67], v[248:251]
    s_waitcnt vmcnt(12) lgkmcnt(6)
    v_mfma_f32_16x16x32_bf16 v[224:227], v[128:131], v[72:75], v[224:227]
    ds_read_b64_tr_b16 v[116:117], v217 offset:16384
    ds_read_b64_tr_b16 v[118:119], v217 offset:17408
    v_mfma_f32_16x16x32_bf16 v[228:231], v[128:131], v[76:79], v[228:231]
    buffer_load_dwordx4 v[64:67], v1, s[24:27], s50 offen offset:0 sc1
    v_mfma_f32_16x16x32_bf16 v[236:239], v[132:135], v[76:79], v[236:239]
    ds_read_b64_tr_b16 v[120:121], v218 offset:16384
    ds_read_b64_tr_b16 v[122:123], v218 offset:17408
    v_mfma_f32_16x16x32_bf16 v[232:235], v[132:135], v[72:75], v[232:235]
    buffer_load_dwordx4 v[68:71], v1, s[24:27], s50 offen offset:1024 sc1
    s_waitcnt lgkmcnt(6)
    v_mfma_f32_16x16x32_bf16 v[240:243], v[136:139], v[72:75], v[240:243]
    ds_read_b64_tr_b16 v[124:125], v219 offset:16384
    ds_read_b64_tr_b16 v[126:127], v219 offset:17408
    v_mfma_f32_16x16x32_bf16 v[244:247], v[136:139], v[76:79], v[244:247]
    s_add_u32 s50, s50, 8192
    v_mfma_f32_16x16x32_bf16 v[252:255], v[140:143], v[76:79], v[252:255]
    ds_read_b64_tr_b16 v[128:129], v216 offset:20480
    ds_read_b64_tr_b16 v[130:131], v216 offset:21504
    v_mfma_f32_16x16x32_bf16 v[248:251], v[140:143], v[72:75], v[248:251]
    s_waitcnt vmcnt(12) lgkmcnt(6)
    v_mfma_f32_16x16x32_bf16 v[224:227], v[112:115], v[80:83], v[224:227]
    ds_read_b64_tr_b16 v[132:133], v217 offset:20480
    ds_read_b64_tr_b16 v[134:135], v217 offset:21504
    v_mfma_f32_16x16x32_bf16 v[228:231], v[112:115], v[84:87], v[228:231]
    buffer_load_dwordx4 v[72:75], v1, s[24:27], s50 offen offset:0 sc1
    v_mfma_f32_16x16x32_bf16 v[236:239], v[116:119], v[84:87], v[236:239]
    ds_read_b64_tr_b16 v[136:137], v218 offset:20480
    ds_read_b64_tr_b16 v[138:139], v218 offset:21504
    v_mfma_f32_16x16x32_bf16 v[232:235], v[116:119], v[80:83], v[232:235]
    buffer_load_dwordx4 v[76:79], v1, s[24:27], s50 offen offset:1024 sc1
    s_waitcnt lgkmcnt(6)
    v_mfma_f32_16x16x32_bf16 v[240:243], v[120:123], v[80:83], v[240:243]
    ds_read_b64_tr_b16 v[140:141], v219 offset:20480
    ds_read_b64_tr_b16 v[142:143], v219 offset:21504
    v_mfma_f32_16x16x32_bf16 v[244:247], v[120:123], v[84:87], v[244:247]
    s_add_u32 s50, s50, 8192
    s_cmp_eq_u32 s50, s79
    s_cselect_b32 s43, 16384, 0
    s_add_u32 s50, s50, s43
    v_mfma_f32_16x16x32_bf16 v[252:255], v[124:127], v[84:87], v[252:255]
    ds_read_b64_tr_b16 v[112:113], v216 offset:24576
    ds_read_b64_tr_b16 v[114:115], v216 offset:25600
    v_mfma_f32_16x16x32_bf16 v[248:251], v[124:127], v[80:83], v[248:251]
    s_waitcnt vmcnt(12) lgkmcnt(6)
    v_mfma_f32_16x16x32_bf16 v[224:227], v[128:131], v[88:91], v[224:227]
    ds_read_b64_tr_b16 v[116:117], v217 offset:24576
    ds_read_b64_tr_b16 v[118:119], v217 offset:25600
    v_mfma_f32_16x16x32_bf16 v[228:231], v[128:131], v[92:95], v[228:231]
    buffer_load_dwordx4 v[80:83], v1, s[24:27], s50 offen offset:0 sc1
    v_mfma_f32_16x16x32_bf16 v[236:239], v[132:135], v[92:95], v[236:239]
    ds_read_b64_tr_b16 v[120:121], v218 offset:24576
    ds_read_b64_tr_b16 v[122:123], v218 offset:25600
    v_mfma_f32_16x16x32_bf16 v[232:235], v[132:135], v[88:91], v[232:235]
    buffer_load_dwordx4 v[84:87], v1, s[24:27], s50 offen offset:1024 sc1
    s_waitcnt lgkmcnt(6)
    v_mfma_f32_16x16x32_bf16 v[240:243], v[136:139], v[88:91], v[240:243]
    ds_read_b64_tr_b16 v[124:125], v219 offset:24576
    ds_read_b64_tr_b16 v[126:127], v219 offset:25600
    v_mfma_f32_16x16x32_bf16 v[244:247], v[136:139], v[92:95], v[244:247]
    s_add_u32 s50, s50, 8192
    v_mfma_f32_16x16x32_bf16 v[252:255], v[140:143], v[92:95], v[252:255]
    ds_read_b64_tr_b16 v[128:129], v216 offset:28672
    ds_read_b64_tr_b16 v[130:131], v216 offset:29696
    v_mfma_f32_16x16x32_bf16 v[248:251], v[140:143], v[88:91], v[248:251]
    s_waitcnt vmcnt(12) lgkmcnt(6)
    v_mfma_f32_16x16x32_bf16 v[224:227], v[112:115], v[96:99], v[224:227]
    ds_read_b64_tr_b16 v[132:133], v217 offset:28672
    ds_read_b64_tr_b16 v[134:135], v217 offset:29696
    v_mfma_f32_16x16x32_bf16 v[228:231], v[112:115], v[100:103], v[228:231]
    buffer_load_dwordx4 v[88:91], v1, s[24:27], s50 offen offset:0 sc1
    v_mfma_f32_16x16x32_bf16 v[236:239], v[116:119], v[100:103], v[236:239]
    ds_read_b64_tr_b16 v[136:137], v218 offset:28672
    ds_read_b64_tr_b16 v[138:139], v218 offset:29696
    v_mfma_f32_16x16x32_bf16 v[232:235], v[116:119], v[96:99], v[232:235]
    buffer_load_dwordx4 v[92:95], v1, s[24:27], s50 offen offset:1024 sc1
    s_waitcnt lgkmcnt(6)
    v_mfma_f32_16x16x32_bf16 v[240:243], v[120:123], v[96:99], v[240:243]
    ds_read_b64_tr_b16 v[140:141], v219 offset:28672
    ds_read_b64_tr_b16 v[142:143], v219 offset:29696
    v_mfma_f32_16x16x32_bf16 v[244:247], v[120:123], v[100:103], v[244:247]
    s_add_u32 s50, s50, 8192
    s_cmp_eq_u32 s50, s79
    s_cselect_b32 s43, 16384, 0
    s_add_u32 s50, s50, s43
    v_mfma_f32_16x16x32_bf16 v[252:255], v[124:127], v[100:103], v[252:255]
    ds_read_b64_tr_b16 v[112:113], v216 offset:32768
    ds_read_b64_tr_b16 v[114:115], v216 offset:33792
    v_mfma_f32_16x16x32_bf16 v[248:251], v[124:127], v[96:99], v[248:251]
    s_waitcnt vmcnt(12) lgkmcnt(6)
    v_mfma_f32_16x16x32_bf16 v[224:227], v[128:131], v[104:107], v[224:227]
    ds_read_b64_tr_b16 v[116:117], v217 offset:32768
    ds_read_b64_tr_b16 v[118:119], v217 offset:33792
    v_mfma_f32_16x16x32_bf16 v[228:231], v[128:131], v[108:111], v[228:231]
    buffer_load_dwordx4 v[96:99], v1, s[24:27], s50 offen offset:0 sc1
    v_mfma_f32_16x16x32_bf16 v[236:239], v[132:135], v[108:111], v[236:239]
    ds_read_b64_tr_b16 v[120:121], v218 offset:32768
    ds_read_b64_tr_b16 v[122:123], v218 offset:33792
    v_mfma_f32_16x16x32_bf16 v[232:235], v[132:135], v[104:107], v[232:235]
    buffer_load_dwordx4 v[100:103], v1, s[24:27], s50 offen offset:1024 sc1
    s_waitcnt lgkmcnt(6)
    v_mfma_f32_16x16x32_bf16 v[240:243], v[136:139], v[104:107], v[240:243]
    ds_read_b64_tr_b16 v[124:125], v219 offset:32768
    ds_read_b64_tr_b16 v[126:127], v219 offset:33792
    v_mfma_f32_16x16x32_bf16 v[244:247], v[136:139], v[108:111], v[244:247]
    s_add_u32 s50, s50, 8192
    v_mfma_f32_16x16x32_bf16 v[252:255], v[140:143], v[108:111], v[252:255]
    ds_read_b64_tr_b16 v[128:129], v216 offset:36864
    ds_read_b64_tr_b16 v[130:131], v216 offset:37888
    v_mfma_f32_16x16x32_bf16 v[248:251], v[140:143], v[104:107], v[248:251]
    s_waitcnt vmcnt(12) lgkmcnt(6)
    v_mfma_f32_16x16x32_bf16 v[224:227], v[112:115], v[48:51], v[224:227]
    ds_read_b64_tr_b16 v[132:133], v217 offset:36864
    ds_read_b64_tr_b16 v[134:135], v217 offset:37888
    v_mfma_f32_16x16x32_bf16 v[228:231], v[112:115], v[52:55], v[228:231]
    buffer_load_dwordx4 v[104:107], v1, s[24:27], s50 offen offset:0 sc1
    v_mfma_f32_16x16x32_bf16 v[236:239], v[116:119], v[52:55], v[236:239]
    ds_read_b64_tr_b16 v[136:137], v218 offset:36864
    ds_read_b64_tr_b16 v[138:139], v218 offset:37888
    v_mfma_f32_16x16x32_bf16 v[232:235], v[116:119], v[48:51], v[232:235]
    buffer_load_dwordx4 v[108:111], v1, s[24:27], s50 offen offset:1024 sc1
    s_waitcnt lgkmcnt(6)
    v_mfma_f32_16x16x32_bf16 v[240:243], v[120:123], v[48:51], v[240:243]
    ds_read_b64_tr_b16 v[140:141], v219 offset:36864
    ds_read_b64_tr_b16 v[142:143], v219 offset:37888
    v_mfma_f32_16x16x32_bf16 v[244:247], v[120:123], v[52:55], v[244:247]
    s_add_u32 s50, s50, 8192
    s_cmp_eq_u32 s50, s79
    s_cselect_b32 s43, 16384, 0
    s_add_u32 s50, s50, s43
    v_mfma_f32_16x16x32_bf16 v[252:255], v[124:127], v[52:55], v[252:255]
    ds_read_b64_tr_b16 v[112:113], v216 offset:40960
    ds_read_b64_tr_b16 v[114:115], v216 offset:41984
    v_mfma_f32_16x16x32_bf16 v[248:251], v[124:127], v[48:51], v[248:251]
    s_waitcnt vmcnt(12) lgkmcnt(6)
    v_mfma_f32_16x16x32_bf16 v[224:227], v[128:131], v[56:59], v[224:227]
    ds_read_b64_tr_b16 v[116:117], v217 offset:40960
    ds_read_b64_tr_b16 v[118:119], v217 offset:41984
    v_mfma_f32_16x16x32_bf16 v[228:231], v[128:131], v[60:63], v[228:231]
    buffer_load_dwordx4 v[48:51], v1, s[24:27], s50 offen offset:0 sc1
    v_mfma_f32_16x16x32_bf16 v[236:239], v[132:135], v[60:63], v[236:239]
    ds_read_b64_tr_b16 v[120:121], v218 offset:40960
    ds_read_b64_tr_b16 v[122:123], v218 offset:41984
    v_mfma_f32_16x16x32_bf16 v[232:235], v[132:135], v[56:59], v[232:235]
    buffer_load_dwordx4 v[52:55], v1, s[24:27], s50 offen offset:1024 sc1
    s_waitcnt lgkmcnt(6)
    v_mfma_f32_16x16x32_bf16 v[240:243], v[136:139], v[56:59], v[240:243]
    ds_read_b64_tr_b16 v[124:125], v219 offset:40960
    ds_read_b64_tr_b16 v[126:127], v219 offset:41984
    v_mfma_f32_16x16x32_bf16 v[244:247], v[136:139], v[60:63], v[244:247]
    s_add_u32 s50, s50, 8192
    v_mfma_f32_16x16x32_bf16 v[252:255], v[140:143], v[60:63], v[252:255]
    ds_read_b64_tr_b16 v[128:129], v216 offset:45056
    ds_read_b64_tr_b16 v[130:131], v216 offset:46080
    v_mfma_f32_16x16x32_bf16 v[248:251], v[140:143], v[56:59], v[248:251]
    s_waitcnt vmcnt(12) lgkmcnt(6)
    v_mfma_f32_16x16x32_bf16 v[224:227], v[112:115], v[64:67], v[224:227]
    ds_read_b64_tr_b16 v[132:133], v217 offset:45056
    ds_read_b64_tr_b16 v[134:135], v217 offset:46080
    v_mfma_f32_16x16x32_bf16 v[228:231], v[112:115], v[68:71], v[228:231]
    buffer_load_dwordx4 v[56:59], v1, s[24:27], s50 offen offset:0 sc1
    v_mfma_f32_16x16x32_bf16 v[236:239], v[116:119], v[68:71], v[236:239]
    ds_read_b64_tr_b16 v[136:137], v218 offset:45056
    ds_read_b64_tr_b16 v[138:139], v218 offset:46080
    v_mfma_f32_16x16x32_bf16 v[232:235], v[116:119], v[64:67], v[232:235]
    buffer_load_dwordx4 v[60:63], v1, s[24:27], s50 offen offset:1024 sc1
    s_waitcnt lgkmcnt(6)
    v_mfma_f32_16x16x32_bf16 v[240:243], v[120:123], v[64:67], v[240:243]
    ds_read_b64_tr_b16 v[140:141], v219 offset:45056
    ds_read_b64_tr_b16 v[142:143], v219 offset:46080
    v_mfma_f32_16x16x32_bf16 v[244:247], v[120:123], v[68:71], v[244:247]
    s_add_u32 s50, s50, 8192
    s_cmp_eq_u32 s50, s79
    s_cselect_b32 s43, 16384, 0
    s_add_u32 s50, s50, s43
    v_mfma_f32_16x16x32_bf16 v[252:255], v[124:127], v[68:71], v[252:255]
    v_add_u32 v216, 49152, v216
    ds_read_b64_tr_b16 v[112:113], v216 offset:0
    ds_read_b64_tr_b16 v[114:115], v216 offset:1024
    v_mfma_f32_16x16x32_bf16 v[248:251], v[124:127], v[64:67], v[248:251]
    s_waitcnt vmcnt(12) lgkmcnt(6)
    v_mfma_f32_16x16x32_bf16 v[224:227], v[128:131], v[72:75], v[224:227]
    v_add_u32 v217, 49152, v217
    ds_read_b64_tr_b16 v[116:117], v217 offset:0
    ds_read_b64_tr_b16 v[118:119], v217 offset:1024
    v_mfma_f32_16x16x32_bf16 v[228:231], v[128:131], v[76:79], v[228:231]
    buffer_load_dwordx4 v[64:67], v1, s[24:27], s50 offen offset:0 sc1
    v_mfma_f32_16x16x32_bf16 v[236:239], v[132:135], v[76:79], v[236:239]
    v_add_u32 v218, 49152, v218
    ds_read_b64_tr_b16 v[120:121], v218 offset:0
    ds_read_b64_tr_b16 v[122:123], v218 offset:1024
    v_mfma_f32_16x16x32_bf16 v[232:235], v[132:135], v[72:75], v[232:235]
    buffer_load_dwordx4 v[68:71], v1, s[24:27], s50 offen offset:1024 sc1
    s_waitcnt lgkmcnt(6)
    v_mfma_f32_16x16x32_bf16 v[240:243], v[136:139], v[72:75], v[240:243]
    v_add_u32 v219, 49152, v219
    ds_read_b64_tr_b16 v[124:125], v219 offset:0
    ds_read_b64_tr_b16 v[126:127], v219 offset:1024
    v_mfma_f32_16x16x32_bf16 v[244:247], v[136:139], v[76:79], v[244:247]
    s_add_u32 s50, s50, 8192
    v_mfma_f32_16x16x32_bf16 v[252:255], v[140:143], v[76:79], v[252:255]
    ds_read_b64_tr_b16 v[128:129], v216 offset:4096
    ds_read_b64_tr_b16 v[130:131], v216 offset:5120
    v_mfma_f32_16x16x32_bf16 v[248:251], v[140:143], v[72:75], v[248:251]
    s_waitcnt vmcnt(12) lgkmcnt(6)
    v_mfma_f32_16x16x32_bf16 v[224:227], v[112:115], v[80:83], v[224:227]
    ds_read_b64_tr_b16 v[132:133], v217 offset:4096
    ds_read_b64_tr_b16 v[134:135], v217 offset:5120
    v_mfma_f32_16x16x32_bf16 v[228:231], v[112:115], v[84:87], v[228:231]
    buffer_load_dwordx4 v[72:75], v1, s[24:27], s50 offen offset:0 sc1
    v_mfma_f32_16x16x32_bf16 v[236:239], v[116:119], v[84:87], v[236:239]
    ds_read_b64_tr_b16 v[136:137], v218 offset:4096
    ds_read_b64_tr_b16 v[138:139], v218 offset:5120
    v_mfma_f32_16x16x32_bf16 v[232:235], v[116:119], v[80:83], v[232:235]
    buffer_load_dwordx4 v[76:79], v1, s[24:27], s50 offen offset:1024 sc1
    s_waitcnt lgkmcnt(6)
    v_mfma_f32_16x16x32_bf16 v[240:243], v[120:123], v[80:83], v[240:243]
    ds_read_b64_tr_b16 v[140:141], v219 offset:4096
    ds_read_b64_tr_b16 v[142:143], v219 offset:5120
    v_mfma_f32_16x16x32_bf16 v[244:247], v[120:123], v[84:87], v[244:247]
    s_add_u32 s50, s50, 8192
    s_cmp_eq_u32 s50, s79
    s_cselect_b32 s43, 16384, 0
    s_add_u32 s50, s50, s43
    v_mfma_f32_16x16x32_bf16 v[252:255], v[124:127], v[84:87], v[252:255]
    ds_read_b64_tr_b16 v[112:113], v216 offset:8192
    ds_read_b64_tr_b16 v[114:115], v216 offset:9216
    v_mfma_f32_16x16x32_bf16 v[248:251], v[124:127], v[80:83], v[248:251]
    s_waitcnt vmcnt(12) lgkmcnt(6)
    v_mfma_f32_16x16x32_bf16 v[224:227], v[128:131], v[88:91], v[224:227]
    ds_read_b64_tr_b16 v[116:117], v217 offset:8192
    ds_read_b64_tr_b16 v[118:119], v217 offset:9216
    v_mfma_f32_16x16x32_bf16 v[228:231], v[128:131], v[92:95], v[228:231]
    buffer_load_dwordx4 v[80:83], v1, s[24:27], s50 offen offset:0 sc1
    v_mfma_f32_16x16x32_bf16 v[236:239], v[132:135], v[92:95], v[236:239]
    ds_read_b64_tr_b16 v[120:121], v218 offset:8192
    ds_read_b64_tr_b16 v[122:123], v218 offset:9216
    v_mfma_f32_16x16x32_bf16 v[232:235], v[132:135], v[88:91], v[232:235]
    buffer_load_dwordx4 v[84:87], v1, s[24:27], s50 offen offset:1024 sc1
    s_waitcnt lgkmcnt(6)
    v_mfma_f32_16x16x32_bf16 v[240:243], v[136:139], v[88:91], v[240:243]
    ds_read_b64_tr_b16 v[124:125], v219 offset:8192
    ds_read_b64_tr_b16 v[126:127], v219 offset:9216
    v_mfma_f32_16x16x32_bf16 v[244:247], v[136:139], v[92:95], v[244:247]
    s_add_u32 s50, s50, 8192
    v_mfma_f32_16x16x32_bf16 v[252:255], v[140:143], v[92:95], v[252:255]
    ds_read_b64_tr_b16 v[128:129], v216 offset:12288
    ds_read_b64_tr_b16 v[130:131], v216 offset:13312
    v_mfma_f32_16x16x32_bf16 v[248:251], v[140:143], v[88:91], v[248:251]
    s_waitcnt vmcnt(12) lgkmcnt(6)
    v_mfma_f32_16x16x32_bf16 v[224:227], v[112:115], v[96:99], v[224:227]
    ds_read_b64_tr_b16 v[132:133], v217 offset:12288
    ds_read_b64_tr_b16 v[134:135], v217 offset:13312
    v_mfma_f32_16x16x32_bf16 v[228:231], v[112:115], v[100:103], v[228:231]
    buffer_load_dwordx4 v[88:91], v1, s[24:27], s50 offen offset:0 sc1
    v_mfma_f32_16x16x32_bf16 v[236:239], v[116:119], v[100:103], v[236:239]
    ds_read_b64_tr_b16 v[136:137], v218 offset:12288
    ds_read_b64_tr_b16 v[138:139], v218 offset:13312
    v_mfma_f32_16x16x32_bf16 v[232:235], v[116:119], v[96:99], v[232:235]
    buffer_load_dwordx4 v[92:95], v1, s[24:27], s50 offen offset:1024 sc1
    s_waitcnt lgkmcnt(6)
    v_mfma_f32_16x16x32_bf16 v[240:243], v[120:123], v[96:99], v[240:243]
    ds_read_b64_tr_b16 v[140:141], v219 offset:12288
    ds_read_b64_tr_b16 v[142:143], v219 offset:13312
    v_mfma_f32_16x16x32_bf16 v[244:247], v[120:123], v[100:103], v[244:247]
    s_add_u32 s50, s50, 8192
    s_cmp_eq_u32 s50, s79
    s_cselect_b32 s43, 16384, 0
    s_add_u32 s50, s50, s43
    v_mfma_f32_16x16x32_bf16 v[252:255], v[124:127], v[100:103], v[252:255]
    ds_read_b64_tr_b16 v[112:113], v216 offset:16384
    ds_read_b64_tr_b16 v[114:115], v216 offset:17408
    v_mfma_f32_16x16x32_bf16 v[248:251], v[124:127], v[96:99], v[248:251]
    s_waitcnt vmcnt(12) lgkmcnt(6)
    v_mfma_f32_16x16x32_bf16 v[224:227], v[128:131], v[104:107], v[224:227]
    ds_read_b64_tr_b16 v[116:117], v217 offset:16384
    ds_read_b64_tr_b16 v[118:119], v217 offset:17408
    v_mfma_f32_16x16x32_bf16 v[228:231], v[128:131], v[108:111], v[228:231]
    buffer_load_dwordx4 v[96:99], v1, s[24:27], s50 offen offset:0 sc1
    v_mfma_f32_16x16x32_bf16 v[236:239], v[132:135], v[108:111], v[236:239]
    ds_read_b64_tr_b16 v[120:121], v218 offset:16384
    ds_read_b64_tr_b16 v[122:123], v218 offset:17408
    v_mfma_f32_16x16x32_bf16 v[232:235], v[132:135], v[104:107], v[232:235]
    buffer_load_dwordx4 v[100:103], v1, s[24:27], s50 offen offset:1024 sc1
    s_waitcnt lgkmcnt(6)
    v_mfma_f32_16x16x32_bf16 v[240:243], v[136:139], v[104:107], v[240:243]
    ds_read_b64_tr_b16 v[124:125], v219 offset:16384
    ds_read_b64_tr_b16 v[126:127], v219 offset:17408
    v_mfma_f32_16x16x32_bf16 v[244:247], v[136:139], v[108:111], v[244:247]
    s_add_u32 s50, s50, 8192
    v_mfma_f32_16x16x32_bf16 v[252:255], v[140:143], v[108:111], v[252:255]
    ds_read_b64_tr_b16 v[128:129], v216 offset:20480
    ds_read_b64_tr_b16 v[130:131], v216 offset:21504
    v_mfma_f32_16x16x32_bf16 v[248:251], v[140:143], v[104:107], v[248:251]
    s_waitcnt vmcnt(12) lgkmcnt(6)
    v_mfma_f32_16x16x32_bf16 v[224:227], v[112:115], v[48:51], v[224:227]
    ds_read_b64_tr_b16 v[132:133], v217 offset:20480
    ds_read_b64_tr_b16 v[134:135], v217 offset:21504
    v_mfma_f32_16x16x32_bf16 v[228:231], v[112:115], v[52:55], v[228:231]
    buffer_load_dwordx4 v[104:107], v1, s[24:27], s50 offen offset:0 sc1
    v_mfma_f32_16x16x32_bf16 v[236:239], v[116:119], v[52:55], v[236:239]
    ds_read_b64_tr_b16 v[136:137], v218 offset:20480
    ds_read_b64_tr_b16 v[138:139], v218 offset:21504
    v_mfma_f32_16x16x32_bf16 v[232:235], v[116:119], v[48:51], v[232:235]
    buffer_load_dwordx4 v[108:111], v1, s[24:27], s50 offen offset:1024 sc1
    s_waitcnt lgkmcnt(6)
    v_mfma_f32_16x16x32_bf16 v[240:243], v[120:123], v[48:51], v[240:243]
    ds_read_b64_tr_b16 v[140:141], v219 offset:20480
    ds_read_b64_tr_b16 v[142:143], v219 offset:21504
    v_mfma_f32_16x16x32_bf16 v[244:247], v[120:123], v[52:55], v[244:247]
    s_add_u32 s50, s50, 8192
    s_cmp_eq_u32 s50, s79
    s_cselect_b32 s43, 16384, 0
    s_add_u32 s50, s50, s43
    v_mfma_f32_16x16x32_bf16 v[252:255], v[124:127], v[52:55], v[252:255]
    ds_read_b64_tr_b16 v[112:113], v216 offset:24576
    ds_read_b64_tr_b16 v[114:115], v216 offset:25600
    v_mfma_f32_16x16x32_bf16 v[248:251], v[124:127], v[48:51], v[248:251]
    s_waitcnt vmcnt(12) lgkmcnt(6)
    v_mfma_f32_16x16x32_bf16 v[224:227], v[128:131], v[56:59], v[224:227]
    ds_read_b64_tr_b16 v[116:117], v217 offset:24576
    ds_read_b64_tr_b16 v[118:119], v217 offset:25600
    v_mfma_f32_16x16x32_bf16 v[228:231], v[128:131], v[60:63], v[228:231]
    buffer_load_dwordx4 v[48:51], v1, s[24:27], s50 offen offset:0 sc1
    v_mfma_f32_16x16x32_bf16 v[236:239], v[132:135], v[60:63], v[236:239]
    ds_read_b64_tr_b16 v[120:121], v218 offset:24576
    ds_read_b64_tr_b16 v[122:123], v218 offset:25600
    v_mfma_f32_16x16x32_bf16 v[232:235], v[132:135], v[56:59], v[232:235]
    buffer_load_dwordx4 v[52:55], v1, s[24:27], s50 offen offset:1024 sc1
    s_waitcnt lgkmcnt(6)
    v_mfma_f32_16x16x32_bf16 v[240:243], v[136:139], v[56:59], v[240:243]
    ds_read_b64_tr_b16 v[124:125], v219 offset:24576
    ds_read_b64_tr_b16 v[126:127], v219 offset:25600
    v_mfma_f32_16x16x32_bf16 v[244:247], v[136:139], v[60:63], v[244:247]
    s_add_u32 s50, s50, 8192
    v_mfma_f32_16x16x32_bf16 v[252:255], v[140:143], v[60:63], v[252:255]
    ds_read_b64_tr_b16 v[128:129], v216 offset:28672
    ds_read_b64_tr_b16 v[130:131], v216 offset:29696
    v_mfma_f32_16x16x32_bf16 v[248:251], v[140:143], v[56:59], v[248:251]
    s_waitcnt vmcnt(12) lgkmcnt(6)
    v_mfma_f32_16x16x32_bf16 v[224:227], v[112:115], v[64:67], v[224:227]
    ds_read_b64_tr_b16 v[132:133], v217 offset:28672
    ds_read_b64_tr_b16 v[134:135], v217 offset:29696
    v_mfma_f32_16x16x32_bf16 v[228:231], v[112:115], v[68:71], v[228:231]
    buffer_load_dwordx4 v[56:59], v1, s[24:27], s50 offen offset:0 sc1
    v_mfma_f32_16x16x32_bf16 v[236:239], v[116:119], v[68:71], v[236:239]
    ds_read_b64_tr_b16 v[136:137], v218 offset:28672
    ds_read_b64_tr_b16 v[138:139], v218 offset:29696
    v_mfma_f32_16x16x32_bf16 v[232:235], v[116:119], v[64:67], v[232:235]
    buffer_load_dwordx4 v[60:63], v1, s[24:27], s50 offen offset:1024 sc1
    s_waitcnt lgkmcnt(6)
    v_mfma_f32_16x16x32_bf16 v[240:243], v[120:123], v[64:67], v[240:243]
    ds_read_b64_tr_b16 v[140:141], v219 offset:28672
    ds_read_b64_tr_b16 v[142:143], v219 offset:29696
    v_mfma_f32_16x16x32_bf16 v[244:247], v[120:123], v[68:71], v[244:247]
    s_add_u32 s50, s50, 8192
    s_cmp_eq_u32 s50, s79
    s_cselect_b32 s43, 16384, 0
    s_add_u32 s50, s50, s43
    v_mfma_f32_16x16x32_bf16 v[252:255], v[124:127], v[68:71], v[252:255]
    ds_read_b64_tr_b16 v[112:113], v216 offset:32768
    ds_read_b64_tr_b16 v[114:115], v216 offset:33792
    v_mfma_f32_16x16x32_bf16 v[248:251], v[124:127], v[64:67], v[248:251]
    s_waitcnt vmcnt(12) lgkmcnt(6)
    v_mfma_f32_16x16x32_bf16 v[224:227], v[128:131], v[72:75], v[224:227]
    ds_read_b64_tr_b16 v[116:117], v217 offset:32768
    ds_read_b64_tr_b16 v[118:119], v217 offset:33792
    v_mfma_f32_16x16x32_bf16 v[228:231], v[128:131], v[76:79], v[228:231]
    buffer_load_dwordx4 v[64:67], v1, s[24:27], s50 offen offset:0 sc1
    v_mfma_f32_16x16x32_bf16 v[236:239], v[132:135], v[76:79], v[236:239]
    ds_read_b64_tr_b16 v[120:121], v218 offset:32768
    ds_read_b64_tr_b16 v[122:123], v218 offset:33792
    v_mfma_f32_16x16x32_bf16 v[232:235], v[132:135], v[72:75], v[232:235]
    buffer_load_dwordx4 v[68:71], v1, s[24:27], s50 offen offset:1024 sc1
    s_waitcnt lgkmcnt(6)
    v_mfma_f32_16x16x32_bf16 v[240:243], v[136:139], v[72:75], v[240:243]
    ds_read_b64_tr_b16 v[124:125], v219 offset:32768
    ds_read_b64_tr_b16 v[126:127], v219 offset:33792
    v_mfma_f32_16x16x32_bf16 v[244:247], v[136:139], v[76:79], v[244:247]
    s_add_u32 s50, s50, 8192
    v_mfma_f32_16x16x32_bf16 v[252:255], v[140:143], v[76:79], v[252:255]
    ds_read_b64_tr_b16 v[128:129], v216 offset:36864
    ds_read_b64_tr_b16 v[130:131], v216 offset:37888
    v_mfma_f32_16x16x32_bf16 v[248:251], v[140:143], v[72:75], v[248:251]
    s_waitcnt vmcnt(12) lgkmcnt(6)
    v_mfma_f32_16x16x32_bf16 v[224:227], v[112:115], v[80:83], v[224:227]
    ds_read_b64_tr_b16 v[132:133], v217 offset:36864
    ds_read_b64_tr_b16 v[134:135], v217 offset:37888
    v_mfma_f32_16x16x32_bf16 v[228:231], v[112:115], v[84:87], v[228:231]
    buffer_load_dwordx4 v[72:75], v1, s[24:27], s50 offen offset:0 sc1
    v_mfma_f32_16x16x32_bf16 v[236:239], v[116:119], v[84:87], v[236:239]
    ds_read_b64_tr_b16 v[136:137], v218 offset:36864
    ds_read_b64_tr_b16 v[138:139], v218 offset:37888
    v_mfma_f32_16x16x32_bf16 v[232:235], v[116:119], v[80:83], v[232:235]
    buffer_load_dwordx4 v[76:79], v1, s[24:27], s50 offen offset:1024 sc1
    s_waitcnt lgkmcnt(6)
    v_mfma_f32_16x16x32_bf16 v[240:243], v[120:123], v[80:83], v[240:243]
    ds_read_b64_tr_b16 v[140:141], v219 offset:36864
    ds_read_b64_tr_b16 v[142:143], v219 offset:37888
    v_mfma_f32_16x16x32_bf16 v[244:247], v[120:123], v[84:87], v[244:247]
    s_add_u32 s50, s50, 8192
    s_cmp_eq_u32 s50, s79
    s_cselect_b32 s43, 16384, 0
    s_add_u32 s50, s50, s43
    v_mfma_f32_16x16x32_bf16 v[252:255], v[124:127], v[84:87], v[252:255]
    ds_read_b64_tr_b16 v[112:113], v216 offset:40960
    ds_read_b64_tr_b16 v[114:115], v216 offset:41984
    v_mfma_f32_16x16x32_bf16 v[248:251], v[124:127], v[80:83], v[248:251]
    s_waitcnt vmcnt(12) lgkmcnt(6)
    v_mfma_f32_16x16x32_bf16 v[224:227], v[128:131], v[88:91], v[224:227]
    ds_read_b64_tr_b16 v[116:117], v217 offset:40960
    ds_read_b64_tr_b16 v[118:119], v217 offset:41984
    v_mfma_f32_16x16x32_bf16 v[228:231], v[128:131], v[92:95], v[228:231]
    buffer_load_dwordx4 v[80:83], v1, s[24:27], s50 offen offset:0 sc1
    v_mfma_f32_16x16x32_bf16 v[236:239], v[132:135], v[92:95], v[236:239]
    ds_read_b64_tr_b16 v[120:121], v218 offset:40960
    ds_read_b64_tr_b16 v[122:123], v218 offset:41984
    v_mfma_f32_16x16x32_bf16 v[232:235], v[132:135], v[88:91], v[232:235]
    buffer_load_dwordx4 v[84:87], v1, s[24:27], s50 offen offset:1024 sc1
    s_waitcnt lgkmcnt(6)
    v_mfma_f32_16x16x32_bf16 v[240:243], v[136:139], v[88:91], v[240:243]
    ds_read_b64_tr_b16 v[124:125], v219 offset:40960
    ds_read_b64_tr_b16 v[126:127], v219 offset:41984
    v_mfma_f32_16x16x32_bf16 v[244:247], v[136:139], v[92:95], v[244:247]
    s_add_u32 s50, s50, 8192
    v_mfma_f32_16x16x32_bf16 v[252:255], v[140:143], v[92:95], v[252:255]
    ds_read_b64_tr_b16 v[128:129], v216 offset:45056
    ds_read_b64_tr_b16 v[130:131], v216 offset:46080
    v_mfma_f32_16x16x32_bf16 v[248:251], v[140:143], v[88:91], v[248:251]
    s_waitcnt vmcnt(12) lgkmcnt(6)
    v_mfma_f32_16x16x32_bf16 v[224:227], v[112:115], v[96:99], v[224:227]
    ds_read_b64_tr_b16 v[132:133], v217 offset:45056
    ds_read_b64_tr_b16 v[134:135], v217 offset:46080
    v_mfma_f32_16x16x32_bf16 v[228:231], v[112:115], v[100:103], v[228:231]
    buffer_load_dwordx4 v[88:91], v1, s[24:27], s50 offen offset:0 sc1
    v_mfma_f32_16x16x32_bf16 v[236:239], v[116:119], v[100:103], v[236:239]
    ds_read_b64_tr_b16 v[136:137], v218 offset:45056
    ds_read_b64_tr_b16 v[138:139], v218 offset:46080
    v_mfma_f32_16x16x32_bf16 v[232:235], v[116:119], v[96:99], v[232:235]
    buffer_load_dwordx4 v[92:95], v1, s[24:27], s50 offen offset:1024 sc1
    s_waitcnt lgkmcnt(6)
    v_mfma_f32_16x16x32_bf16 v[240:243], v[120:123], v[96:99], v[240:243]
    ds_read_b64_tr_b16 v[140:141], v219 offset:45056
    ds_read_b64_tr_b16 v[142:143], v219 offset:46080
    v_mfma_f32_16x16x32_bf16 v[244:247], v[120:123], v[100:103], v[244:247]
    s_add_u32 s50, s50, 8192
    s_cmp_eq_u32 s50, s79
    s_cselect_b32 s43, 16384, 0
    s_add_u32 s50, s50, s43
    v_mfma_f32_16x16x32_bf16 v[252:255], v[124:127], v[100:103], v[252:255]
    v_add_u32 v216, 81920, v216
    ds_read_b64_tr_b16 v[112:113], v216 offset:0
    ds_read_b64_tr_b16 v[114:115], v216 offset:1024
    v_mfma_f32_16x16x32_bf16 v[248:251], v[124:127], v[96:99], v[248:251]
    s_waitcnt vmcnt(12) lgkmcnt(6)
    v_mfma_f32_16x16x32_bf16 v[224:227], v[128:131], v[104:107], v[224:227]
    v_add_u32 v217, 81920, v217
    ds_read_b64_tr_b16 v[116:117], v217 offset:0
    ds_read_b64_tr_b16 v[118:119], v217 offset:1024
    v_mfma_f32_16x16x32_bf16 v[228:231], v[128:131], v[108:111], v[228:231]
    buffer_load_dwordx4 v[96:99], v1, s[24:27], s50 offen offset:0 sc1
    v_mfma_f32_16x16x32_bf16 v[236:239], v[132:135], v[108:111], v[236:239]
    v_add_u32 v218, 81920, v218
    ds_read_b64_tr_b16 v[120:121], v218 offset:0
    ds_read_b64_tr_b16 v[122:123], v218 offset:1024
    v_mfma_f32_16x16x32_bf16 v[232:235], v[132:135], v[104:107], v[232:235]
    buffer_load_dwordx4 v[100:103], v1, s[24:27], s50 offen offset:1024 sc1
    s_waitcnt lgkmcnt(6)
    v_mfma_f32_16x16x32_bf16 v[240:243], v[136:139], v[104:107], v[240:243]
    v_add_u32 v219, 81920, v219
    ds_read_b64_tr_b16 v[124:125], v219 offset:0
    ds_read_b64_tr_b16 v[126:127], v219 offset:1024
    v_mfma_f32_16x16x32_bf16 v[244:247], v[136:139], v[108:111], v[244:247]
    s_add_u32 s50, s50, 8192
    v_mfma_f32_16x16x32_bf16 v[252:255], v[140:143], v[108:111], v[252:255]
    ds_read_b64_tr_b16 v[128:129], v216 offset:4096
    ds_read_b64_tr_b16 v[130:131], v216 offset:5120
    v_mfma_f32_16x16x32_bf16 v[248:251], v[140:143], v[104:107], v[248:251]
    s_waitcnt vmcnt(12) lgkmcnt(6)
    v_mfma_f32_16x16x32_bf16 v[224:227], v[112:115], v[48:51], v[224:227]
    ds_read_b64_tr_b16 v[132:133], v217 offset:4096
    ds_read_b64_tr_b16 v[134:135], v217 offset:5120
    v_mfma_f32_16x16x32_bf16 v[228:231], v[112:115], v[52:55], v[228:231]
    buffer_load_dwordx4 v[104:107], v1, s[24:27], s50 offen offset:0 sc1
    v_mfma_f32_16x16x32_bf16 v[236:239], v[116:119], v[52:55], v[236:239]
    ds_read_b64_tr_b16 v[136:137], v218 offset:4096
    ds_read_b64_tr_b16 v[138:139], v218 offset:5120
    v_mfma_f32_16x16x32_bf16 v[232:235], v[116:119], v[48:51], v[232:235]
    buffer_load_dwordx4 v[108:111], v1, s[24:27], s50 offen offset:1024 sc1
    s_waitcnt lgkmcnt(6)
    v_mfma_f32_16x16x32_bf16 v[240:243], v[120:123], v[48:51], v[240:243]
    ds_read_b64_tr_b16 v[140:141], v219 offset:4096
    ds_read_b64_tr_b16 v[142:143], v219 offset:5120
    v_mfma_f32_16x16x32_bf16 v[244:247], v[120:123], v[52:55], v[244:247]
    s_add_u32 s50, s50, 8192
    s_cmp_eq_u32 s50, s79
    s_cselect_b32 s43, 16384, 0
    s_add_u32 s50, s50, s43
    v_mfma_f32_16x16x32_bf16 v[252:255], v[124:127], v[52:55], v[252:255]
    ds_read_b64_tr_b16 v[112:113], v216 offset:8192
    ds_read_b64_tr_b16 v[114:115], v216 offset:9216
    v_mfma_f32_16x16x32_bf16 v[248:251], v[124:127], v[48:51], v[248:251]
    s_waitcnt vmcnt(12) lgkmcnt(6)
    v_mfma_f32_16x16x32_bf16 v[224:227], v[128:131], v[56:59], v[224:227]
    ds_read_b64_tr_b16 v[116:117], v217 offset:8192
    ds_read_b64_tr_b16 v[118:119], v217 offset:9216
    v_mfma_f32_16x16x32_bf16 v[228:231], v[128:131], v[60:63], v[228:231]
    v_mfma_f32_16x16x32_bf16 v[236:239], v[132:135], v[60:63], v[236:239]
    ds_read_b64_tr_b16 v[120:121], v218 offset:8192
    ds_read_b64_tr_b16 v[122:123], v218 offset:9216
    v_mfma_f32_16x16x32_bf16 v[232:235], v[132:135], v[56:59], v[232:235]
    s_waitcnt lgkmcnt(6)
    v_mfma_f32_16x16x32_bf16 v[240:243], v[136:139], v[56:59], v[240:243]
    ds_read_b64_tr_b16 v[124:125], v219 offset:8192
    ds_read_b64_tr_b16 v[126:127], v219 offset:9216
    v_mfma_f32_16x16x32_bf16 v[244:247], v[136:139], v[60:63], v[244:247]
    v_mfma_f32_16x16x32_bf16 v[252:255], v[140:143], v[60:63], v[252:255]
    ds_read_b64_tr_b16 v[128:129], v216 offset:12288
    ds_read_b64_tr_b16 v[130:131], v216 offset:13312
    v_mfma_f32_16x16x32_bf16 v[248:251], v[140:143], v[56:59], v[248:251]
    s_waitcnt vmcnt(10) lgkmcnt(6)
    v_mfma_f32_16x16x32_bf16 v[224:227], v[112:115], v[64:67], v[224:227]
    ds_read_b64_tr_b16 v[132:133], v217 offset:12288
    ds_read_b64_tr_b16 v[134:135], v217 offset:13312
    v_mfma_f32_16x16x32_bf16 v[228:231], v[112:115], v[68:71], v[228:231]
    v_mfma_f32_16x16x32_bf16 v[236:239], v[116:119], v[68:71], v[236:239]
    ds_read_b64_tr_b16 v[136:137], v218 offset:12288
    ds_read_b64_tr_b16 v[138:139], v218 offset:13312
    v_mfma_f32_16x16x32_bf16 v[232:235], v[116:119], v[64:67], v[232:235]
    s_waitcnt lgkmcnt(6)
    v_mfma_f32_16x16x32_bf16 v[240:243], v[120:123], v[64:67], v[240:243]
    ds_read_b64_tr_b16 v[140:141], v219 offset:12288
    ds_read_b64_tr_b16 v[142:143], v219 offset:13312
    v_mfma_f32_16x16x32_bf16 v[244:247], v[120:123], v[68:71], v[244:247]
    v_mfma_f32_16x16x32_bf16 v[252:255], v[124:127], v[68:71], v[252:255]
    ds_read_b64_tr_b16 v[112:113], v216 offset:16384
    ds_read_b64_tr_b16 v[114:115], v216 offset:17408
    v_mfma_f32_16x16x32_bf16 v[248:251], v[124:127], v[64:67], v[248:251]
    s_waitcnt vmcnt(8) lgkmcnt(6)
    v_mfma_f32_16x16x32_bf16 v[224:227], v[128:131], v[72:75], v[224:227]
    ds_read_b64_tr_b16 v[116:117], v217 offset:16384
    ds_read_b64_tr_b16 v[118:119], v217 offset:17408
    v_mfma_f32_16x16x32_bf16 v[228:231], v[128:131], v[76:79], v[228:231]
    v_mfma_f32_16x16x32_bf16 v[236:239], v[132:135], v[76:79], v[236:239]
    ds_read_b64_tr_b16 v[120:121], v218 offset:16384
    ds_read_b64_tr_b16 v[122:123], v218 offset:17408
    v_mfma_f32_16x16x32_bf16 v[232:235], v[132:135], v[72:75], v[232:235]
    s_waitcnt lgkmcnt(6)
    v_mfma_f32_16x16x32_bf16 v[240:243], v[136:139], v[72:75], v[240:243]
    ds_read_b64_tr_b16 v[124:125], v219 offset:16384
    ds_read_b64_tr_b16 v[126:127], v219 offset:17408
    v_mfma_f32_16x16x32_bf16 v[244:247], v[136:139], v[76:79], v[244:247]
    v_mfma_f32_16x16x32_bf16 v[252:255], v[140:143], v[76:79], v[252:255]
    ds_read_b64_tr_b16 v[128:129], v216 offset:20480
    ds_read_b64_tr_b16 v[130:131], v216 offset:21504
    v_mfma_f32_16x16x32_bf16 v[248:251], v[140:143], v[72:75], v[248:251]
    s_waitcnt vmcnt(6) lgkmcnt(6)
    v_mfma_f32_16x16x32_bf16 v[224:227], v[112:115], v[80:83], v[224:227]
    ds_read_b64_tr_b16 v[132:133], v217 offset:20480
    ds_read_b64_tr_b16 v[134:135], v217 offset:21504
    v_mfma_f32_16x16x32_bf16 v[228:231], v[112:115], v[84:87], v[228:231]
    v_mfma_f32_16x16x32_bf16 v[236:239], v[116:119], v[84:87], v[236:239]
    ds_read_b64_tr_b16 v[136:137], v218 offset:20480
    ds_read_b64_tr_b16 v[138:139], v218 offset:21504
    v_mfma_f32_16x16x32_bf16 v[232:235], v[116:119], v[80:83], v[232:235]
    s_waitcnt lgkmcnt(6)
    v_mfma_f32_16x16x32_bf16 v[240:243], v[120:123], v[80:83], v[240:243]
    ds_read_b64_tr_b16 v[140:141], v219 offset:20480
    ds_read_b64_tr_b16 v[142:143], v219 offset:21504
    v_mfma_f32_16x16x32_bf16 v[244:247], v[120:123], v[84:87], v[244:247]
    v_mfma_f32_16x16x32_bf16 v[252:255], v[124:127], v[84:87], v[252:255]
    ds_read_b64_tr_b16 v[112:113], v216 offset:24576
    ds_read_b64_tr_b16 v[114:115], v216 offset:25600
    v_mfma_f32_16x16x32_bf16 v[248:251], v[124:127], v[80:83], v[248:251]
    s_waitcnt vmcnt(4) lgkmcnt(6)
    v_mfma_f32_16x16x32_bf16 v[224:227], v[128:131], v[88:91], v[224:227]
    ds_read_b64_tr_b16 v[116:117], v217 offset:24576
    ds_read_b64_tr_b16 v[118:119], v217 offset:25600
    v_mfma_f32_16x16x32_bf16 v[228:231], v[128:131], v[92:95], v[228:231]
    v_mfma_f32_16x16x32_bf16 v[236:239], v[132:135], v[92:95], v[236:239]
    ds_read_b64_tr_b16 v[120:121], v218 offset:24576
    ds_read_b64_tr_b16 v[122:123], v218 offset:25600
    v_mfma_f32_16x16x32_bf16 v[232:235], v[132:135], v[88:91], v[232:235]
    s_waitcnt lgkmcnt(6)
    v_mfma_f32_16x16x32_bf16 v[240:243], v[136:139], v[88:91], v[240:243]
    ds_read_b64_tr_b16 v[124:125], v219 offset:24576
    ds_read_b64_tr_b16 v[126:127], v219 offset:25600
    v_mfma_f32_16x16x32_bf16 v[244:247], v[136:139], v[92:95], v[244:247]
    v_mfma_f32_16x16x32_bf16 v[252:255], v[140:143], v[92:95], v[252:255]
    ds_read_b64_tr_b16 v[128:129], v216 offset:28672
    ds_read_b64_tr_b16 v[130:131], v216 offset:29696
    v_mfma_f32_16x16x32_bf16 v[248:251], v[140:143], v[88:91], v[248:251]
    s_waitcnt vmcnt(2) lgkmcnt(6)
    v_mfma_f32_16x16x32_bf16 v[224:227], v[112:115], v[96:99], v[224:227]
    ds_read_b64_tr_b16 v[132:133], v217 offset:28672
    ds_read_b64_tr_b16 v[134:135], v217 offset:29696
    v_mfma_f32_16x16x32_bf16 v[228:231], v[112:115], v[100:103], v[228:231]
    v_mfma_f32_16x16x32_bf16 v[236:239], v[116:119], v[100:103], v[236:239]
    ds_read_b64_tr_b16 v[136:137], v218 offset:28672
    ds_read_b64_tr_b16 v[138:139], v218 offset:29696
    v_mfma_f32_16x16x32_bf16 v[232:235], v[116:119], v[96:99], v[232:235]
    s_waitcnt lgkmcnt(6)
    v_mfma_f32_16x16x32_bf16 v[240:243], v[120:123], v[96:99], v[240:243]
    ds_read_b64_tr_b16 v[140:141], v219 offset:28672
    ds_read_b64_tr_b16 v[142:143], v219 offset:29696
    v_mfma_f32_16x16x32_bf16 v[244:247], v[120:123], v[100:103], v[244:247]
    v_mfma_f32_16x16x32_bf16 v[252:255], v[124:127], v[100:103], v[252:255]
    v_mfma_f32_16x16x32_bf16 v[248:251], v[124:127], v[96:99], v[248:251]
    s_waitcnt vmcnt(0) lgkmcnt(4)
    v_mfma_f32_16x16x32_bf16 v[224:227], v[128:131], v[104:107], v[224:227]
    v_mfma_f32_16x16x32_bf16 v[228:231], v[128:131], v[108:111], v[228:231]
    v_mfma_f32_16x16x32_bf16 v[236:239], v[132:135], v[108:111], v[236:239]
    v_mfma_f32_16x16x32_bf16 v[232:235], v[132:135], v[104:107], v[232:235]
    s_waitcnt lgkmcnt(0)
    v_mfma_f32_16x16x32_bf16 v[240:243], v[136:139], v[104:107], v[240:243]
    v_mfma_f32_16x16x32_bf16 v[244:247], v[136:139], v[108:111], v[244:247]
    v_mfma_f32_16x16x32_bf16 v[252:255], v[140:143], v[108:111], v[252:255]
    v_mfma_f32_16x16x32_bf16 v[248:251], v[140:143], v[104:107], v[248:251]
    s_add_u32 s79, s5, 0x900000
    s_add_u32 s44, s79, 8192
    s_nop 1
    v_cvt_pk_bf16_f32 v128, v224, v225
    v_cvt_pk_bf16_f32 v129, v226, v227
    v_cvt_pk_bf16_f32 v130, v232, v233
    v_cvt_pk_bf16_f32 v131, v234, v235
    v_cvt_pk_bf16_f32 v132, v228, v229
    v_cvt_pk_bf16_f32 v133, v230, v231
    v_cvt_pk_bf16_f32 v134, v236, v237
    v_cvt_pk_bf16_f32 v135, v238, v239
    buffer_store_dwordx4 v[128:131], v1, s[24:27], s79 offen offset:0 sc1
    buffer_store_dwordx4 v[132:135], v1, s[24:27], s79 offen offset:1024 sc1
    v_cvt_pk_bf16_f32 v136, v240, v241
    v_cvt_pk_bf16_f32 v137, v242, v243
    v_cvt_pk_bf16_f32 v138, v248, v249
    v_cvt_pk_bf16_f32 v139, v250, v251
    v_cvt_pk_bf16_f32 v140, v244, v245
    v_cvt_pk_bf16_f32 v141, v246, v247
    v_cvt_pk_bf16_f32 v142, v252, v253
    v_cvt_pk_bf16_f32 v143, v254, v255
    buffer_store_dwordx4 v[136:139], v1, s[24:27], s44 offen offset:0 sc1
    buffer_store_dwordx4 v[140:143], v1, s[24:27], s44 offen offset:1024 sc1
    v_pk_add_f32 v[144:145], v[224:225], v[226:227]
    v_pk_mul_f32 v[146:147], v[224:225], v[224:225]
    v_pk_fma_f32 v[146:147], v[226:227], v[226:227], v[146:147]
    v_pk_add_f32 v[144:145], v[144:145], v[232:233]
    v_pk_fma_f32 v[146:147], v[232:233], v[232:233], v[146:147]
    v_pk_add_f32 v[144:145], v[144:145], v[234:235]
    v_pk_fma_f32 v[146:147], v[234:235], v[234:235], v[146:147]
    v_pk_add_f32 v[144:145], v[144:145], v[240:241]
    v_pk_fma_f32 v[146:147], v[240:241], v[240:241], v[146:147]
    v_pk_add_f32 v[144:145], v[144:145], v[242:243]
    v_pk_fma_f32 v[146:147], v[242:243], v[242:243], v[146:147]
    v_pk_add_f32 v[144:145], v[144:145], v[248:249]
    v_pk_fma_f32 v[146:147], v[248:249], v[248:249], v[146:147]
    v_pk_add_f32 v[144:145], v[144:145], v[250:251]
    v_pk_fma_f32 v[146:147], v[250:251], v[250:251], v[146:147]
    v_pk_add_f32 v[148:149], v[228:229], v[230:231]
    v_pk_mul_f32 v[150:151], v[228:229], v[228:229]
    v_pk_fma_f32 v[150:151], v[230:231], v[230:231], v[150:151]
    v_pk_add_f32 v[148:149], v[148:149], v[236:237]
    v_pk_fma_f32 v[150:151], v[236:237], v[236:237], v[150:151]
    v_pk_add_f32 v[148:149], v[148:149], v[238:239]
    v_pk_fma_f32 v[150:151], v[238:239], v[238:239], v[150:151]
    v_pk_add_f32 v[148:149], v[148:149], v[244:245]
    v_pk_fma_f32 v[150:151], v[244:245], v[244:245], v[150:151]
    v_pk_add_f32 v[148:149], v[148:149], v[246:247]
    v_pk_fma_f32 v[150:151], v[246:247], v[246:247], v[150:151]
    v_pk_add_f32 v[148:149], v[148:149], v[252:253]
    v_pk_fma_f32 v[150:151], v[252:253], v[252:253], v[150:151]
    v_pk_add_f32 v[148:149], v[148:149], v[254:255]
    v_pk_fma_f32 v[150:151], v[254:255], v[254:255], v[150:151]
    v_add_f32 v144, v144, v145
    v_add_f32 v146, v146, v147
    v_add_f32 v148, v148, v149
    v_add_f32 v150, v150, v151
    s_add_u32 s46, s10, 0x1c80000
    s_nop 0
    v_permlane16_swap_b32 v144, v148
    v_permlane16_swap_b32 v146, v150
    v_add_f32 v144, v144, v148
    v_add_f32 v146, v146, v150
    s_nop 1
    v_permlane32_swap_b32 v144, v146
    v_add_f32 v144, v144, v146
    buffer_store_dword v144, v14, s[24:27], s46 offen sc1
    v_add_u32 v6, 98304, v1
    s_mov_b32 s49, 86016
    s_mov_b32 s56, 0xfffe4000
    s_mov_b32 s57, 28672
    s_movk_i32 s48, 6
    s_barrier
    ds_read_b128 v[160:163], v6 offset:0
    ds_read_b128 v[164:167], v6 offset:1024
    ds_read_b128 v[168:171], v6 offset:2048
    ds_read_b128 v[172:175], v6 offset:3072
    ds_read_b128 v[176:179], v6 offset:4096
    s_waitcnt lgkmcnt(3)
    v_mfma_f32_16x16x32_bf16 v[16:19], v[160:163], v[128:131], 0
    ds_read_b128 v[180:183], v6 offset:5120
    v_mfma_f32_16x16x32_bf16 v[20:23], v[160:163], v[132:135], 0
    s_add_u32 s50, s4, 0x900000
    v_mfma_f32_16x16x32_bf16 v[28:31], v[164:167], v[132:135], 0
    ds_read_b128 v[184:187], v6 offset:6144
    v_mfma_f32_16x16x32_bf16 v[24:27], v[164:167], v[128:131], 0
    s_waitcnt lgkmcnt(3)
    v_mfma_f32_16x16x32_bf16 v[32:35], v[168:171], v[128:131], 0
    ds_read_b128 v[160:163], v6 offset:7168
    v_mfma_f32_16x16x32_bf16 v[36:39], v[168:171], v[132:135], 0
    s_cmp_eq_u32 s50, s79
    s_cselect_b32 s43, 16384, 0
    s_add_u32 s50, s50, s43
    v_mfma_f32_16x16x32_bf16 v[44:47], v[172:175], v[132:135], 0
    ds_read_b128 v[164:167], v6 offset:8192
    v_mfma_f32_16x16x32_bf16 v[40:43], v[172:175], v[128:131], 0
    s_waitcnt lgkmcnt(3)
    v_mfma_f32_16x16x32_bf16 v[48:51], v[176:179], v[128:131], 0
    ds_read_b128 v[168:171], v6 offset:9216
    v_mfma_f32_16x16x32_bf16 v[52:55], v[176:179], v[132:135], 0
    s_add_u32 s49, s49, 28672
    v_mfma_f32_16x16x32_bf16 v[60:63], v[180:183], v[132:135], 0
    ds_read_b128 v[172:175], v6 offset:10240
    v_mfma_f32_16x16x32_bf16 v[56:59], v[180:183], v[128:131], 0
    s_waitcnt lgkmcnt(3)
    v_mfma_f32_16x16x32_bf16 v[64:67], v[184:187], v[128:131], 0
    ds_read_b128 v[176:179], v6 offset:11264
    v_mfma_f32_16x16x32_bf16 v[68:71], v[184:187], v[132:135], 0
    s_cmp_eq_u32 s49, 143360
    s_cselect_b32 s52, s56, s57
    v_mfma_f32_16x16x32_bf16 v[76:79], v[160:163], v[132:135], 0
    ds_read_b128 v[180:183], v6 offset:12288
    v_mfma_f32_16x16x32_bf16 v[72:75], v[160:163], v[128:131], 0
    s_waitcnt lgkmcnt(3)
    v_mfma_f32_16x16x32_bf16 v[80:83], v[164:167], v[128:131], 0
    ds_read_b128 v[184:187], v6 offset:13312
    v_mfma_f32_16x16x32_bf16 v[84:87], v[164:167], v[132:135], 0
    s_cselect_b32 s49, 0, s49
    v_mfma_f32_16x16x32_bf16 v[92:95], v[168:171], v[132:135], 0
    ds_read_b128 v[160:163], v6 offset:14336
    v_mfma_f32_16x16x32_bf16 v[88:91], v[168:171], v[128:131], 0
    s_waitcnt lgkmcnt(3)
    v_mfma_f32_16x16x32_bf16 v[96:99], v[172:175], v[128:131], 0
    ds_read_b128 v[164:167], v6 offset:15360
    v_mfma_f32_16x16x32_bf16 v[100:103], v[172:175], v[132:135], 0
    v_mfma_f32_16x16x32_bf16 v[108:111], v[176:179], v[132:135], 0
    ds_read_b128 v[168:171], v6 offset:16384
    v_mfma_f32_16x16x32_bf16 v[104:107], v[176:179], v[128:131], 0
    s_waitcnt lgkmcnt(3)
    v_mfma_f32_16x16x32_bf16 v[112:115], v[180:183], v[128:131], 0
    ds_read_b128 v[172:175], v6 offset:17408
    v_mfma_f32_16x16x32_bf16 v[116:119], v[180:183], v[132:135], 0
    v_mfma_f32_16x16x32_bf16 v[124:127], v[184:187], v[132:135], 0
    ds_read_b128 v[176:179], v6 offset:18432
    v_mfma_f32_16x16x32_bf16 v[120:123], v[184:187], v[128:131], 0
    s_add_u32 s47, s9, 0x8c000
    v_mov_b32 v15, 1
    s_waitcnt vmcnt(0)
    s_mov_b64 exec, 1
    buffer_atomic_add v15, v2, s[24:27], s47 offen sc0 sc1
    s_mov_b64 exec, -1
    s_waitcnt lgkmcnt(3)
    v_mfma_f32_16x16x32_bf16 v[16:19], v[160:163], v[136:139], v[16:19]
    ds_read_b128 v[180:183], v6 offset:19456
    v_mfma_f32_16x16x32_bf16 v[20:23], v[160:163], v[140:143], v[20:23]
    v_mfma_f32_16x16x32_bf16 v[28:31], v[164:167], v[140:143], v[28:31]
    ds_read_b128 v[184:187], v6 offset:20480
    v_mfma_f32_16x16x32_bf16 v[24:27], v[164:167], v[136:139], v[24:27]
    s_waitcnt lgkmcnt(3)
    v_mfma_f32_16x16x32_bf16 v[32:35], v[168:171], v[136:139], v[32:35]
    ds_read_b128 v[160:163], v6 offset:21504
    v_mfma_f32_16x16x32_bf16 v[36:39], v[168:171], v[140:143], v[36:39]
    v_mfma_f32_16x16x32_bf16 v[44:47], v[172:175], v[140:143], v[44:47]
    ds_read_b128 v[164:167], v6 offset:22528
    v_mfma_f32_16x16x32_bf16 v[40:43], v[172:175], v[136:139], v[40:43]
    s_waitcnt lgkmcnt(3)
    v_mfma_f32_16x16x32_bf16 v[48:51], v[176:179], v[136:139], v[48:51]
    ds_read_b128 v[168:171], v6 offset:23552
    v_mfma_f32_16x16x32_bf16 v[52:55], v[176:179], v[140:143], v[52:55]
    v_mfma_f32_16x16x32_bf16 v[60:63], v[180:183], v[140:143], v[60:63]
    ds_read_b128 v[172:175], v6 offset:24576
    v_mfma_f32_16x16x32_bf16 v[56:59], v[180:183], v[136:139], v[56:59]
    s_waitcnt lgkmcnt(3)
    v_mfma_f32_16x16x32_bf16 v[64:67], v[184:187], v[136:139], v[64:67]
    ds_read_b128 v[176:179], v6 offset:25600
    v_mfma_f32_16x16x32_bf16 v[68:71], v[184:187], v[140:143], v[68:71]
    v_mfma_f32_16x16x32_bf16 v[76:79], v[160:163], v[140:143], v[76:79]
    ds_read_b128 v[180:183], v6 offset:26624
    v_mfma_f32_16x16x32_bf16 v[72:75], v[160:163], v[136:139], v[72:75]
    s_waitcnt lgkmcnt(3)
    v_mfma_f32_16x16x32_bf16 v[80:83], v[164:167], v[136:139], v[80:83]
    ds_read_b128 v[184:187], v6 offset:27648
    v_mfma_f32_16x16x32_bf16 v[84:87], v[164:167], v[140:143], v[84:87]
    v_mfma_f32_16x16x32_bf16 v[224:227], v[196:199], v[212:215], v[224:227]
    v_mfma_f32_16x16x32_bf16 v[228:231], v[196:199], v[212:215], v[228:231]
    v_mfma_f32_16x16x32_bf16 v[232:235], v[200:203], v[212:215], v[232:235]
    v_mfma_f32_16x16x32_bf16 v[236:239], v[200:203], v[212:215], v[236:239]
    v_mfma_f32_16x16x32_bf16 v[240:243], v[204:207], v[212:215], v[240:243]
    v_mfma_f32_16x16x32_bf16 v[244:247], v[204:207], v[212:215], v[244:247]
    v_mfma_f32_16x16x32_bf16 v[248:251], v[208:211], v[212:215], v[248:251]
    v_mfma_f32_16x16x32_bf16 v[252:255], v[208:211], v[212:215], v[252:255]
    s_mov_b32 s58, 0x40000
    s_mov_b64 exec, 1
    s_waitcnt vmcnt(0)
    v_cmp_gt_u32 vcc, 15, v15
    s_cbranch_vccz .Lpollok_20
.Lpoll_19:
    v_mov_b32 v15, 0
    buffer_atomic_add v15, v2, s[24:27], s47 offen sc0 sc1
    s_waitcnt vmcnt(0)
    v_cmp_gt_u32 vcc, 16, v15
    s_cbranch_vccz .Lpollok_20
    s_sub_u32 s58, s58, 1
    s_cbranch_scc0 .Lpoll_19
.Lpollok_20:
    s_mov_b64 exec, -1
    buffer_load_dwordx4 v[144:147], v1, s[24:27], s50 offen offset:0 sc1
    buffer_load_dwordx4 v[148:151], v1, s[24:27], s50 offen offset:1024 sc1
    s_add_u32 s50, s50, 8192
    buffer_load_dwordx4 v[152:155], v1, s[24:27], s50 offen offset:0 sc1
    buffer_load_dwordx4 v[156:159], v1, s[24:27], s50 offen offset:1024 sc1
    s_add_u32 s50, s50, 8192
    s_cmp_eq_u32 s50, s79
    s_cselect_b32 s43, 16384, 0
    s_add_u32 s50, s50, s43
    buffer_load_dwordx4 v[128:131], v1, s[24:27], s50 offen offset:0 sc1
    buffer_load_dwordx4 v[132:135], v1, s[24:27], s50 offen offset:1024 sc1
    s_add_u32 s50, s50, 8192
    s_lshl_b32 s46, s59, 12
    s_add_u32 s46, s46, s40
    s_add_u32 s46, s46, 0x1c80000
    buffer_load_dwordx4 v[188:191], v1, s[24:27], s46 offen offset:0 sc1
    buffer_load_dwordx4 v[192:195], v1, s[24:27], s46 offen offset:1024 sc1
    buffer_load_dwordx4 v[196:199], v1, s[24:27], s46 offen offset:2048 sc1
    buffer_load_dwordx4 v[200:203], v1, s[24:27], s46 offen offset:3072 sc1
    v_add_u32 v6, s52, v6
    s_barrier
    v_mfma_f32_16x16x32_bf16 v[92:95], v[168:171], v[140:143], v[92:95]
    ds_read_b128 v[160:163], v6 offset:0
    v_mfma_f32_16x16x32_bf16 v[88:91], v[168:171], v[136:139], v[88:91]
    s_waitcnt lgkmcnt(3)
    v_mfma_f32_16x16x32_bf16 v[96:99], v[172:175], v[136:139], v[96:99]
    ds_read_b128 v[164:167], v6 offset:1024
    v_mfma_f32_16x16x32_bf16 v[100:103], v[172:175], v[140:143], v[100:103]
    v_mfma_f32_16x16x32_bf16 v[108:111], v[176:179], v[140:143], v[108:111]
    ds_read_b128 v[168:171], v6 offset:2048
    v_mfma_f32_16x16x32_bf16 v[104:107], v[176:179], v[136:139], v[104:107]
    s_waitcnt lgkmcnt(3)
    v_mfma_f32_16x16x32_bf16 v[112:115], v[180:183], v[136:139], v[112:115]
    ds_read_b128 v[172:175], v6 offset:3072
    v_mfma_f32_16x16x32_bf16 v[116:119], v[180:183], v[140:143], v[116:119]
    v_mfma_f32_16x16x32_bf16 v[124:127], v[184:187], v[140:143], v[124:127]
    ds_read_b128 v[176:179], v6 offset:4096
    v_mfma_f32_16x16x32_bf16 v[120:123], v[184:187], v[136:139], v[120:123]
    s_waitcnt vmcnt(8) lgkmcnt(3)
    v_mfma_f32_16x16x32_bf16 v[16:19], v[160:163], v[144:147], v[16:19]
    ds_read_b128 v[180:183], v6 offset:5120
    v_mfma_f32_16x16x32_bf16 v[20:23], v[160:163], v[148:151], v[20:23]
    buffer_load_dwordx4 v[136:139], v1, s[24:27], s50 offen offset:0 sc1
    v_mfma_f32_16x16x32_bf16 v[28:31], v[164:167], v[148:151], v[28:31]
    ds_read_b128 v[184:187], v6 offset:6144
    v_mfma_f32_16x16x32_bf16 v[24:27], v[164:167], v[144:147], v[24:27]
    s_waitcnt lgkmcnt(3)
    v_mfma_f32_16x16x32_bf16 v[32:35], v[168:171], v[144:147], v[32:35]
    ds_read_b128 v[160:163], v6 offset:7168
    v_mfma_f32_16x16x32_bf16 v[36:39], v[168:171], v[148:151], v[36:39]
    buffer_load_dwordx4 v[140:143], v1, s[24:27], s50 offen offset:1024 sc1
    v_mfma_f32_16x16x32_bf16 v[44:47], v[172:175], v[148:151], v[44:47]
    ds_read_b128 v[164:167], v6 offset:8192
    v_mfma_f32_16x16x32_bf16 v[40:43], v[172:175], v[144:147], v[40:43]
    s_waitcnt lgkmcnt(3)
    v_mfma_f32_16x16x32_bf16 v[48:51], v[176:179], v[144:147], v[48:51]
    ds_read_b128 v[168:171], v6 offset:9216
    v_mfma_f32_16x16x32_bf16 v[52:55], v[176:179], v[148:151], v[52:55]
    s_add_u32 s50, s50, 8192
    s_cmp_eq_u32 s50, s79
    s_cselect_b32 s43, 16384, 0
    s_add_u32 s50, s50, s43
    v_mfma_f32_16x16x32_bf16 v[60:63], v[180:183], v[148:151], v[60:63]
    ds_read_b128 v[172:175], v6 offset:10240
    v_mfma_f32_16x16x32_bf16 v[56:59], v[180:183], v[144:147], v[56:59]
    s_waitcnt lgkmcnt(3)
    v_mfma_f32_16x16x32_bf16 v[64:67], v[184:187], v[144:147], v[64:67]
    ds_read_b128 v[176:179], v6 offset:11264
    v_mfma_f32_16x16x32_bf16 v[68:71], v[184:187], v[148:151], v[68:71]
    s_add_u32 s49, s49, 28672
    v_mfma_f32_16x16x32_bf16 v[76:79], v[160:163], v[148:151], v[76:79]
    ds_read_b128 v[180:183], v6 offset:12288
    v_mfma_f32_16x16x32_bf16 v[72:75], v[160:163], v[144:147], v[72:75]
    s_waitcnt lgkmcnt(3)
    v_mfma_f32_16x16x32_bf16 v[80:83], v[164:167], v[144:147], v[80:83]
    ds_read_b128 v[184:187], v6 offset:13312
    v_mfma_f32_16x16x32_bf16 v[84:87], v[164:167], v[148:151], v[84:87]
    s_cmp_eq_u32 s49, 143360
    s_cselect_b32 s52, s56, s57
    v_mfma_f32_16x16x32_bf16 v[92:95], v[168:171], v[148:151], v[92:95]
    ds_read_b128 v[160:163], v6 offset:14336
    v_mfma_f32_16x16x32_bf16 v[88:91], v[168:171], v[144:147], v[88:91]
    s_waitcnt lgkmcnt(3)
    v_mfma_f32_16x16x32_bf16 v[96:99], v[172:175], v[144:147], v[96:99]
    ds_read_b128 v[164:167], v6 offset:15360
    v_mfma_f32_16x16x32_bf16 v[100:103], v[172:175], v[148:151], v[100:103]
    s_cselect_b32 s49, 0, s49
    v_mfma_f32_16x16x32_bf16 v[108:111], v[176:179], v[148:151], v[108:111]
    ds_read_b128 v[168:171], v6 offset:16384
    v_mfma_f32_16x16x32_bf16 v[104:107], v[176:179], v[144:147], v[104:107]
    s_waitcnt lgkmcnt(3)
    v_mfma_f32_16x16x32_bf16 v[112:115], v[180:183], v[144:147], v[112:115]
    ds_read_b128 v[172:175], v6 offset:17408
    v_mfma_f32_16x16x32_bf16 v[116:119], v[180:183], v[148:151], v[116:119]
    v_mfma_f32_16x16x32_bf16 v[124:127], v[184:187], v[148:151], v[124:127]
    ds_read_b128 v[176:179], v6 offset:18432
    v_mfma_f32_16x16x32_bf16 v[120:123], v[184:187], v[144:147], v[120:123]
    s_waitcnt vmcnt(8) lgkmcnt(3)
    v_mfma_f32_16x16x32_bf16 v[16:19], v[160:163], v[152:155], v[16:19]
    ds_read_b128 v[180:183], v6 offset:19456
    v_mfma_f32_16x16x32_bf16 v[20:23], v[160:163], v[156:159], v[20:23]
    buffer_load_dwordx4 v[144:147], v1, s[24:27], s50 offen offset:0 sc1
    v_mfma_f32_16x16x32_bf16 v[28:31], v[164:167], v[156:159], v[28:31]
    ds_read_b128 v[184:187], v6 offset:20480
    v_mfma_f32_16x16x32_bf16 v[24:27], v[164:167], v[152:155], v[24:27]
    s_waitcnt lgkmcnt(3)
    v_mfma_f32_16x16x32_bf16 v[32:35], v[168:171], v[152:155], v[32:35]
    ds_read_b128 v[160:163], v6 offset:21504
    v_mfma_f32_16x16x32_bf16 v[36:39], v[168:171], v[156:159], v[36:39]
    buffer_load_dwordx4 v[148:151], v1, s[24:27], s50 offen offset:1024 sc1
    v_mfma_f32_16x16x32_bf16 v[44:47], v[172:175], v[156:159], v[44:47]
    ds_read_b128 v[164:167], v6 offset:22528
    v_mfma_f32_16x16x32_bf16 v[40:43], v[172:175], v[152:155], v[40:43]
    s_waitcnt lgkmcnt(3)
    v_mfma_f32_16x16x32_bf16 v[48:51], v[176:179], v[152:155], v[48:51]
    ds_read_b128 v[168:171], v6 offset:23552
    v_mfma_f32_16x16x32_bf16 v[52:55], v[176:179], v[156:159], v[52:55]
    s_add_u32 s50, s50, 8192
    v_mfma_f32_16x16x32_bf16 v[60:63], v[180:183], v[156:159], v[60:63]
    ds_read_b128 v[172:175], v6 offset:24576
    v_mfma_f32_16x16x32_bf16 v[56:59], v[180:183], v[152:155], v[56:59]
    s_waitcnt lgkmcnt(3)
    v_mfma_f32_16x16x32_bf16 v[64:67], v[184:187], v[152:155], v[64:67]
    ds_read_b128 v[176:179], v6 offset:25600
    v_mfma_f32_16x16x32_bf16 v[68:71], v[184:187], v[156:159], v[68:71]
    v_mfma_f32_16x16x32_bf16 v[76:79], v[160:163], v[156:159], v[76:79]
    ds_read_b128 v[180:183], v6 offset:26624
    v_mfma_f32_16x16x32_bf16 v[72:75], v[160:163], v[152:155], v[72:75]
    s_waitcnt lgkmcnt(3)
    v_mfma_f32_16x16x32_bf16 v[80:83], v[164:167], v[152:155], v[80:83]
    ds_read_b128 v[184:187], v6 offset:27648
    v_mfma_f32_16x16x32_bf16 v[84:87], v[164:167], v[156:159], v[84:87]
    v_add_u32 v6, s52, v6
    s_barrier
    v_mfma_f32_16x16x32_bf16 v[92:95], v[168:171], v[156:159], v[92:95]
    ds_read_b128 v[160:163], v6 offset:0
    v_mfma_f32_16x16x32_bf16 v[88:91], v[168:171], v[152:155], v[88:91]
    s_waitcnt lgkmcnt(3)
    v_mfma_f32_16x16x32_bf16 v[96:99], v[172:175], v[152:155], v[96:99]
    ds_read_b128 v[164:167], v6 offset:1024
    v_mfma_f32_16x16x32_bf16 v[100:103], v[172:175], v[156:159], v[100:103]
    v_mfma_f32_16x16x32_bf16 v[108:111], v[176:179], v[156:159], v[108:111]
    ds_read_b128 v[168:171], v6 offset:2048
    v_mfma_f32_16x16x32_bf16 v[104:107], v[176:179], v[152:155], v[104:107]
    s_waitcnt lgkmcnt(3)
    v_mfma_f32_16x16x32_bf16 v[112:115], v[180:183], v[152:155], v[112:115]
    ds_read_b128 v[172:175], v6 offset:3072
    v_mfma_f32_16x16x32_bf16 v[116:119], v[180:183], v[156:159], v[116:119]
    v_mfma_f32_16x16x32_bf16 v[124:127], v[184:187], v[156:159], v[124:127]
    ds_read_b128 v[176:179], v6 offset:4096
    v_mfma_f32_16x16x32_bf16 v[120:123], v[184:187], v[152:155], v[120:123]
.p2align 3
.Lring_21:
    s_waitcnt vmcnt(4) lgkmcnt(3)
    v_mfma_f32_16x16x32_bf16 v[16:19], v[160:163], v[128:131], v[16:19]
    ds_read_b128 v[180:183], v6 offset:5120
    v_mfma_f32_16x16x32_bf16 v[20:23], v[160:163], v[132:135], v[20:23]
    buffer_load_dwordx4 v[152:155], v1, s[24:27], s50 offen offset:0 sc1
    v_mfma_f32_16x16x32_bf16 v[28:31], v[164:167], v[132:135], v[28:31]
    ds_read_b128 v[184:187], v6 offset:6144
    v_mfma_f32_16x16x32_bf16 v[24:27], v[164:167], v[128:131], v[24:27]
    s_waitcnt lgkmcnt(3)
    v_mfma_f32_16x16x32_bf16 v[32:35], v[168:171], v[128:131], v[32:35]
    ds_read_b128 v[160:163], v6 offset:7168
    v_mfma_f32_16x16x32_bf16 v[36:39], v[168:171], v[132:135], v[36:39]
    buffer_load_dwordx4 v[156:159], v1, s[24:27], s50 offen offset:1024 sc1
    v_mfma_f32_16x16x32_bf16 v[44:47], v[172:175], v[132:135], v[44:47]
    ds_read_b128 v[164:167], v6 offset:8192
    v_mfma_f32_16x16x32_bf16 v[40:43], v[172:175], v[128:131], v[40:43]
    s_waitcnt lgkmcnt(3)
    v_mfma_f32_16x16x32_bf16 v[48:51], v[176:179], v[128:131], v[48:51]
    ds_read_b128 v[168:171], v6 offset:9216
    v_mfma_f32_16x16x32_bf16 v[52:55], v[176:179], v[132:135], v[52:55]
    s_add_u32 s50, s50, 8192
    s_cmp_eq_u32 s50, s79
    s_cselect_b32 s43, 16384, 0
    s_add_u32 s50, s50, s43
    v_mfma_f32_16x16x32_bf16 v[60:63], v[180:183], v[132:135], v[60:63]
    ds_read_b128 v[172:175], v6 offset:10240
    v_mfma_f32_16x16x32_bf16 v[56:59], v[180:183], v[128:131], v[56:59]
    s_waitcnt lgkmcnt(3)
    v_mfma_f32_16x16x32_bf16 v[64:67], v[184:187], v[128:131], v[64:67]
    ds_read_b128 v[176:179], v6 offset:11264
    v_mfma_f32_16x16x32_bf16 v[68:71], v[184:187], v[132:135], v[68:71]
    s_add_u32 s49, s49, 28672
    v_mfma_f32_16x16x32_bf16 v[76:79], v[160:163], v[132:135], v[76:79]
    ds_read_b128 v[180:183], v6 offset:12288
    v_mfma_f32_16x16x32_bf16 v[72:75], v[160:163], v[128:131], v[72:75]
    s_waitcnt lgkmcnt(3)
    v_mfma_f32_16x16x32_bf16 v[80:83], v[164:167], v[128:131], v[80:83]
    ds_read_b128 v[184:187], v6 offset:13312
    v_mfma_f32_16x16x32_bf16 v[84:87], v[164:167], v[132:135], v[84:87]
    s_cmp_eq_u32 s49, 143360
    s_cselect_b32 s52, s56, s57
    v_mfma_f32_16x16x32_bf16 v[92:95], v[168:171], v[132:135], v[92:95]
    ds_read_b128 v[160:163], v6 offset:14336
    v_mfma_f32_16x16x32_bf16 v[88:91], v[168:171], v[128:131], v[88:91]
    s_waitcnt lgkmcnt(3)
    v_mfma_f32_16x16x32_bf16 v[96:99], v[172:175], v[128:131], v[96:99]
    ds_read_b128 v[164:167], v6 offset:15360
    v_mfma_f32_16x16x32_bf16 v[100:103], v[172:175], v[132:135], v[100:103]
    s_cselect_b32 s49, 0, s49
    v_mfma_f32_16x16x32_bf16 v[108:111], v[176:179], v[132:135], v[108:111]
    ds_read_b128 v[168:171], v6 offset:16384
    v_mfma_f32_16x16x32_bf16 v[104:107], v[176:179], v[128:131], v[104:107]
    s_waitcnt lgkmcnt(3)
    v_mfma_f32_16x16x32_bf16 v[112:115], v[180:183], v[128:131], v[112:115]
    ds_read_b128 v[172:175], v6 offset:17408
    v_mfma_f32_16x16x32_bf16 v[116:119], v[180:183], v[132:135], v[116:119]
    v_mfma_f32_16x16x32_bf16 v[124:127], v[184:187], v[132:135], v[124:127]
    ds_read_b128 v[176:179], v6 offset:18432
    v_mfma_f32_16x16x32_bf16 v[120:123], v[184:187], v[128:131], v[120:123]
    s_waitcnt vmcnt(4) lgkmcnt(3)
    v_mfma_f32_16x16x32_bf16 v[16:19], v[160:163], v[136:139], v[16:19]
    ds_read_b128 v[180:183], v6 offset:19456
    v_mfma_f32_16x16x32_bf16 v[20:23], v[160:163], v[140:143], v[20:23]
    buffer_load_dwordx4 v[128:131], v1, s[24:27], s50 offen offset:0 sc1
    v_mfma_f32_16x16x32_bf16 v[28:31], v[164:167], v[140:143], v[28:31]
    ds_read_b128 v[184:187], v6 offset:20480
    v_mfma_f32_16x16x32_bf16 v[24:27], v[164:167], v[136:139], v[24:27]
    s_waitcnt lgkmcnt(3)
    v_mfma_f32_16x16x32_bf16 v[32:35], v[168:171], v[136:139], v[32:35]
    ds_read_b128 v[160:163], v6 offset:21504
    v_mfma_f32_16x16x32_bf16 v[36:39], v[168:171], v[140:143], v[36:39]
    buffer_load_dwordx4 v[132:135], v1, s[24:27], s50 offen offset:1024 sc1
    v_mfma_f32_16x16x32_bf16 v[44:47], v[172:175], v[140:143], v[44:47]
    ds_read_b128 v[164:167], v6 offset:22528
    v_mfma_f32_16x16x32_bf16 v[40:43], v[172:175], v[136:139], v[40:43]
    s_waitcnt lgkmcnt(3)
    v_mfma_f32_16x16x32_bf16 v[48:51], v[176:179], v[136:139], v[48:51]
    ds_read_b128 v[168:171], v6 offset:23552
    v_mfma_f32_16x16x32_bf16 v[52:55], v[176:179], v[140:143], v[52:55]
    s_add_u32 s50, s50, 8192
    v_mfma_f32_16x16x32_bf16 v[60:63], v[180:183], v[140:143], v[60:63]
    ds_read_b128 v[172:175], v6 offset:24576
    v_mfma_f32_16x16x32_bf16 v[56:59], v[180:183], v[136:139], v[56:59]
    s_waitcnt lgkmcnt(3)
    v_mfma_f32_16x16x32_bf16 v[64:67], v[184:187], v[136:139], v[64:67]
    ds_read_b128 v[176:179], v6 offset:25600
    v_mfma_f32_16x16x32_bf16 v[68:71], v[184:187], v[140:143], v[68:71]
    v_mfma_f32_16x16x32_bf16 v[76:79], v[160:163], v[140:143], v[76:79]
    ds_read_b128 v[180:183], v6 offset:26624
    v_mfma_f32_16x16x32_bf16 v[72:75], v[160:163], v[136:139], v[72:75]
    s_waitcnt lgkmcnt(3)
    v_mfma_f32_16x16x32_bf16 v[80:83], v[164:167], v[136:139], v[80:83]
    ds_read_b128 v[184:187], v6 offset:27648
    v_mfma_f32_16x16x32_bf16 v[84:87], v[164:167], v[140:143], v[84:87]
    v_add_u32 v6, s52, v6
    s_barrier
    v_mfma_f32_16x16x32_bf16 v[92:95], v[168:171], v[140:143], v[92:95]
    ds_read_b128 v[160:163], v6 offset:0
    v_mfma_f32_16x16x32_bf16 v[88:91], v[168:171], v[136:139], v[88:91]
    s_waitcnt lgkmcnt(3)
    v_mfma_f32_16x16x32_bf16 v[96:99], v[172:175], v[136:139], v[96:99]
    ds_read_b128 v[164:167], v6 offset:1024
    v_mfma_f32_16x16x32_bf16 v[100:103], v[172:175], v[140:143], v[100:103]
    v_mfma_f32_16x16x32_bf16 v[108:111], v[176:179], v[140:143], v[108:111]
    ds_read_b128 v[168:171], v6 offset:2048
    v_mfma_f32_16x16x32_bf16 v[104:107], v[176:179], v[136:139], v[104:107]
    s_waitcnt lgkmcnt(3)
    v_mfma_f32_16x16x32_bf16 v[112:115], v[180:183], v[136:139], v[112:115]
    ds_read_b128 v[172:175], v6 offset:3072
    v_mfma_f32_16x16x32_bf16 v[116:119], v[180:183], v[140:143], v[116:119]
    v_mfma_f32_16x16x32_bf16 v[124:127], v[184:187], v[140:143], v[124:127]
    ds_read_b128 v[176:179], v6 offset:4096
    v_mfma_f32_16x16x32_bf16 v[120:123], v[184:187], v[136:139], v[120:123]
    s_waitcnt vmcnt(4) lgkmcnt(3)
    v_mfma_f32_16x16x32_bf16 v[16:19], v[160:163], v[144:147], v[16:19]
    ds_read_b128 v[180:183], v6 offset:5120
    v_mfma_f32_16x16x32_bf16 v[20:23], v[160:163], v[148:151], v[20:23]
    buffer_load_dwordx4 v[136:139], v1, s[24:27], s50 offen offset:0 sc1
    v_mfma_f32_16x16x32_bf16 v[28:31], v[164:167], v[148:151], v[28:31]
    ds_read_b128 v[184:187], v6 offset:6144
    v_mfma_f32_16x16x32_bf16 v[24:27], v[164:167], v[144:147], v[24:27]
    s_waitcnt lgkmcnt(3)
    v_mfma_f32_16x16x32_bf16 v[32:35], v[168:171], v[144:147], v[32:35]
    ds_read_b128 v[160:163], v6 offset:7168
    v_mfma_f32_16x16x32_bf16 v[36:39], v[168:171], v[148:151], v[36:39]
    buffer_load_dwordx4 v[140:143], v1, s[24:27], s50 offen offset:1024 sc1
    v_mfma_f32_16x16x32_bf16 v[44:47], v[172:175], v[148:151], v[44:47]
    ds_read_b128 v[164:167], v6 offset:8192
    v_mfma_f32_16x16x32_bf16 v[40:43], v[172:175], v[144:147], v[40:43]
    s_waitcnt lgkmcnt(3)
    v_mfma_f32_16x16x32_bf16 v[48:51], v[176:179], v[144:147], v[48:51]
    ds_read_b128 v[168:171], v6 offset:9216
    v_mfma_f32_16x16x32_bf16 v[52:55], v[176:179], v[148:151], v[52:55]
    s_add_u32 s50, s50, 8192
    s_cmp_eq_u32 s50, s79
    s_cselect_b32 s43, 16384, 0
    s_add_u32 s50, s50, s43
    v_mfma_f32_16x16x32_bf16 v[60:63], v[180:183], v[148:151], v[60:63]
    ds_read_b128 v[172:175], v6 offset:10240
    v_mfma_f32_16x16x32_bf16 v[56:59], v[180:183], v[144:147], v[56:59]
    s_waitcnt lgkmcnt(3)
    v_mfma_f32_16x16x32_bf16 v[64:67], v[184:187], v[144:147], v[64:67]
    ds_read_b128 v[176:179], v6 offset:11264
    v_mfma_f32_16x16x32_bf16 v[68:71], v[184:187], v[148:151], v[68:71]
    s_add_u32 s49, s49, 28672
    v_mfma_f32_16x16x32_bf16 v[76:79], v[160:163], v[148:151], v[76:79]
    ds_read_b128 v[180:183], v6 offset:12288
    v_mfma_f32_16x16x32_bf16 v[72:75], v[160:163], v[144:147], v[72:75]
    s_waitcnt lgkmcnt(3)
    v_mfma_f32_16x16x32_bf16 v[80:83], v[164:167], v[144:147], v[80:83]
    ds_read_b128 v[184:187], v6 offset:13312
    v_mfma_f32_16x16x32_bf16 v[84:87], v[164:167], v[148:151], v[84:87]
    s_cmp_eq_u32 s49, 143360
    s_cselect_b32 s52, s56, s57
    v_mfma_f32_16x16x32_bf16 v[92:95], v[168:171], v[148:151], v[92:95]
    ds_read_b128 v[160:163], v6 offset:14336
    v_mfma_f32_16x16x32_bf16 v[88:91], v[168:171], v[144:147], v[88:91]
    s_waitcnt lgkmcnt(3)
    v_mfma_f32_16x16x32_bf16 v[96:99], v[172:175], v[144:147], v[96:99]
    ds_read_b128 v[164:167], v6 offset:15360
    v_mfma_f32_16x16x32_bf16 v[100:103], v[172:175], v[148:151], v[100:103]
    s_cselect_b32 s49, 0, s49
    v_mfma_f32_16x16x32_bf16 v[108:111], v[176:179], v[148:151], v[108:111]
    ds_read_b128 v[168:171], v6 offset:16384
    v_mfma_f32_16x16x32_bf16 v[104:107], v[176:179], v[144:147], v[104:107]
    s_waitcnt lgkmcnt(3)
    v_mfma_f32_16x16x32_bf16 v[112:115], v[180:183], v[144:147], v[112:115]
    ds_read_b128 v[172:175], v6 offset:17408
    v_mfma_f32_16x16x32_bf16 v[116:119], v[180:183], v[148:151], v[116:119]
    v_mfma_f32_16x16x32_bf16 v[124:127], v[184:187], v[148:151], v[124:127]
    ds_read_b128 v[176:179], v6 offset:18432
    v_mfma_f32_16x16x32_bf16 v[120:123], v[184:187], v[144:147], v[120:123]
    s_waitcnt vmcnt(4) lgkmcnt(3)
    v_mfma_f32_16x16x32_bf16 v[16:19], v[160:163], v[152:155], v[16:19]
    ds_read_b128 v[180:183], v6 offset:19456
    v_mfma_f32_16x16x32_bf16 v[20:23], v[160:163], v[156:159], v[20:23]
    buffer_load_dwordx4 v[144:147], v1, s[24:27], s50 offen offset:0 sc1
    v_mfma_f32_16x16x32_bf16 v[28:31], v[164:167], v[156:159], v[28:31]
    ds_read_b128 v[184:187], v6 offset:20480
    v_mfma_f32_16x16x32_bf16 v[24:27], v[164:167], v[152:155], v[24:27]
    s_waitcnt lgkmcnt(3)
    v_mfma_f32_16x16x32_bf16 v[32:35], v[168:171], v[152:155], v[32:35]
    ds_read_b128 v[160:163], v6 offset:21504
    v_mfma_f32_16x16x32_bf16 v[36:39], v[168:171], v[156:159], v[36:39]
    buffer_load_dwordx4 v[148:151], v1, s[24:27], s50 offen offset:1024 sc1
    v_mfma_f32_16x16x32_bf16 v[44:47], v[172:175], v[156:159], v[44:47]
    ds_read_b128 v[164:167], v6 offset:22528
    v_mfma_f32_16x16x32_bf16 v[40:43], v[172:175], v[152:155], v[40:43]
    s_waitcnt lgkmcnt(3)
    v_mfma_f32_16x16x32_bf16 v[48:51], v[176:179], v[152:155], v[48:51]
    ds_read_b128 v[168:171], v6 offset:23552
    v_mfma_f32_16x16x32_bf16 v[52:55], v[176:179], v[156:159], v[52:55]
    s_add_u32 s50, s50, 8192
    v_mfma_f32_16x16x32_bf16 v[60:63], v[180:183], v[156:159], v[60:63]
    ds_read_b128 v[172:175], v6 offset:24576
    v_mfma_f32_16x16x32_bf16 v[56:59], v[180:183], v[152:155], v[56:59]
    s_waitcnt lgkmcnt(3)
    v_mfma_f32_16x16x32_bf16 v[64:67], v[184:187], v[152:155], v[64:67]
    ds_read_b128 v[176:179], v6 offset:25600
    v_mfma_f32_16x16x32_bf16 v[68:71], v[184:187], v[156:159], v[68:71]
    s_sub_u32 s48, s48, 1
    s_cmp_lg_u32 s48, 0
    v_mfma_f32_16x16x32_bf16 v[76:79], v[160:163], v[156:159], v[76:79]
    ds_read_b128 v[180:183], v6 offset:26624
    v_mfma_f32_16x16x32_bf16 v[72:75], v[160:163], v[152:155], v[72:75]
    s_waitcnt lgkmcnt(3)
    v_mfma_f32_16x16x32_bf16 v[80:83], v[164:167], v[152:155], v[80:83]
    ds_read_b128 v[184:187], v6 offset:27648
    v_mfma_f32_16x16x32_bf16 v[84:87], v[164:167], v[156:159], v[84:87]
    v_add_u32 v6, s52, v6
    s_barrier
    v_mfma_f32_16x16x32_bf16 v[92:95], v[168:171], v[156:159], v[92:95]
    ds_read_b128 v[160:163], v6 offset:0
    v_mfma_f32_16x16x32_bf16 v[88:91], v[168:171], v[152:155], v[88:91]
    s_waitcnt lgkmcnt(3)
    v_mfma_f32_16x16x32_bf16 v[96:99], v[172:175], v[152:155], v[96:99]
    ds_read_b128 v[164:167], v6 offset:1024
    v_mfma_f32_16x16x32_bf16 v[100:103], v[172:175], v[156:159], v[100:103]
    v_mfma_f32_16x16x32_bf16 v[108:111], v[176:179], v[156:159], v[108:111]
    ds_read_b128 v[168:171], v6 offset:2048
    v_mfma_f32_16x16x32_bf16 v[104:107], v[176:179], v[152:155], v[104:107]
    s_waitcnt lgkmcnt(3)
    v_mfma_f32_16x16x32_bf16 v[112:115], v[180:183], v[152:155], v[112:115]
    ds_read_b128 v[172:175], v6 offset:3072
    v_mfma_f32_16x16x32_bf16 v[116:119], v[180:183], v[156:159], v[116:119]
    v_mfma_f32_16x16x32_bf16 v[124:127], v[184:187], v[156:159], v[124:127]
    ds_read_b128 v[176:179], v6 offset:4096
    v_mfma_f32_16x16x32_bf16 v[120:123], v[184:187], v[152:155], v[120:123]
    s_cbranch_scc1 .Lring_21
    s_waitcnt vmcnt(4) lgkmcnt(3)
    v_mfma_f32_16x16x32_bf16 v[16:19], v[160:163], v[128:131], v[16:19]
    ds_read_b128 v[180:183], v6 offset:5120
    v_add_f32 v188, v188, v196
    v_mfma_f32_16x16x32_bf16 v[20:23], v[160:163], v[132:135], v[20:23]
    buffer_load_dwordx4 v[152:155], v1, s[24:27], s50 offen offset:0 sc1
    v_add_f32 v189, v189, v197
    v_mfma_f32_16x16x32_bf16 v[28:31], v[164:167], v[132:135], v[28:31]
    ds_read_b128 v[184:187], v6 offset:6144
    v_add_f32 v190, v190, v198
    v_mfma_f32_16x16x32_bf16 v[24:27], v[164:167], v[128:131], v[24:27]
    v_add_f32 v191, v191, v199
    s_waitcnt lgkmcnt(3)
    v_mfma_f32_16x16x32_bf16 v[32:35], v[168:171], v[128:131], v[32:35]
    ds_read_b128 v[160:163], v6 offset:7168
    v_add_f32 v192, v192, v200
    v_mfma_f32_16x16x32_bf16 v[36:39], v[168:171], v[132:135], v[36:39]
    buffer_load_dwordx4 v[156:159], v1, s[24:27], s50 offen offset:1024 sc1
    v_add_f32 v193, v193, v201
    v_mfma_f32_16x16x32_bf16 v[44:47], v[172:175], v[132:135], v[44:47]
    ds_read_b128 v[164:167], v6 offset:8192
    v_add_f32 v194, v194, v202
    v_mfma_f32_16x16x32_bf16 v[40:43], v[172:175], v[128:131], v[40:43]
    v_add_f32 v195, v195, v203
    s_waitcnt lgkmcnt(3)
    v_mfma_f32_16x16x32_bf16 v[48:51], v[176:179], v[128:131], v[48:51]
    ds_read_b128 v[168:171], v6 offset:9216
    v_add_f32 v188, v188, v192
    v_mfma_f32_16x16x32_bf16 v[52:55], v[176:179], v[132:135], v[52:55]
    s_add_u32 s50, s50, 8192
    s_cmp_eq_u32 s50, s79
    s_cselect_b32 s43, 16384, 0
    s_add_u32 s50, s50, s43
    v_add_f32 v189, v189, v193
    v_mfma_f32_16x16x32_bf16 v[60:63], v[180:183], v[132:135], v[60:63]
    ds_read_b128 v[172:175], v6 offset:10240
    v_add_f32 v190, v190, v194
    v_mfma_f32_16x16x32_bf16 v[56:59], v[180:183], v[128:131], v[56:59]
    v_add_f32 v191, v191, v195
    s_waitcnt lgkmcnt(3)
    v_mfma_f32_16x16x32_bf16 v[64:67], v[184:187], v[128:131], v[64:67]
    ds_read_b128 v[176:179], v6 offset:11264
    v_permlane16_swap_b32 v188, v189
    v_mfma_f32_16x16x32_bf16 v[68:71], v[184:187], v[132:135], v[68:71]
    s_add_u32 s49, s49, 28672
    v_permlane16_swap_b32 v190, v191
    v_mfma_f32_16x16x32_bf16 v[76:79], v[160:163], v[132:135], v[76:79]
    ds_read_b128 v[180:183], v6 offset:12288
    v_add_f32 v188, v188, v189
    v_mfma_f32_16x16x32_bf16 v[72:75], v[160:163], v[128:131], v[72:75]
    v_add_f32 v190, v190, v191
    s_waitcnt lgkmcnt(3)
    v_mfma_f32_16x16x32_bf16 v[80:83], v[164:167], v[128:131], v[80:83]
    ds_read_b128 v[184:187], v6 offset:13312
    v_mfma_f32_16x16x32_bf16 v[84:87], v[164:167], v[132:135], v[84:87]
    s_cmp_eq_u32 s49, 143360
    s_cselect_b32 s52, s56, s57
    v_permlane32_swap_b32 v188, v190
    v_mfma_f32_16x16x32_bf16 v[92:95], v[168:171], v[132:135], v[92:95]
    ds_read_b128 v[160:163], v6 offset:14336
    v_add_f32 v188, v188, v190
    v_mfma_f32_16x16x32_bf16 v[88:91], v[168:171], v[128:131], v[88:91]
    v_mov_b32 v189, v188
    s_waitcnt lgkmcnt(3)
    v_mfma_f32_16x16x32_bf16 v[96:99], v[172:175], v[128:131], v[96:99]
    ds_read_b128 v[164:167], v6 offset:15360
    v_mfma_f32_16x16x32_bf16 v[100:103], v[172:175], v[132:135], v[100:103]
    s_cselect_b32 s49, 0, s49
    v_permlane32_swap_b32 v188, v189
    v_mfma_f32_16x16x32_bf16 v[108:111], v[176:179], v[132:135], v[108:111]
    ds_read_b128 v[168:171], v6 offset:16384
    v_mul_f32 v190, 0xba800000, v188
    v_mfma_f32_16x16x32_bf16 v[104:107], v[176:179], v[128:131], v[104:107]
    v_mul_f32 v192, 0x3a800000, v189
    s_waitcnt lgkmcnt(3)
    v_mfma_f32_16x16x32_bf16 v[112:115], v[180:183], v[128:131], v[112:115]
    ds_read_b128 v[172:175], v6 offset:17408
    v_fma_f32 v192, -v190, v190, v192
    v_mfma_f32_16x16x32_bf16 v[116:119], v[180:183], v[132:135], v[116:119]
    v_max_f32 v192, 0, v192
    v_mfma_f32_16x16x32_bf16 v[124:127], v[184:187], v[132:135], v[124:127]
    ds_read_b128 v[176:179], v6 offset:18432
    v_add_f32 v193, 0x3727c5ac, v192
    v_mfma_f32_16x16x32_bf16 v[120:123], v[184:187], v[128:131], v[120:123]
    v_rsq_f32 v191, v193
    s_waitcnt vmcnt(4) lgkmcnt(3)
    v_mfma_f32_16x16x32_bf16 v[16:19], v[160:163], v[136:139], v[16:19]
    ds_read_b128 v[180:183], v6 offset:19456
    v_mul_f32 v193, v191, v191
    v_mfma_f32_16x16x32_bf16 v[20:23], v[160:163], v[140:143], v[20:23]
    s_mov_b32 s50, s6
    v_mul_f32 v193, v193, v192
    v_mfma_f32_16x16x32_bf16 v[28:31], v[164:167], v[140:143], v[28:31]
    ds_read_b128 v[184:187], v6 offset:20480
    v_add_f32 v193, 0x3727c5ac, v193
    v_mfma_f32_16x16x32_bf16 v[24:27], v[164:167], v[136:139], v[24:27]
    v_rsq_f32 v193, v193
    s_waitcnt lgkmcnt(3)
    v_mfma_f32_16x16x32_bf16 v[32:35], v[168:171], v[136:139], v[32:35]
    ds_read_b128 v[160:163], v6 offset:21504
    v_mul_f32 v191, v191, v193
    v_mfma_f32_16x16x32_bf16 v[36:39], v[168:171], v[140:143], v[36:39]
    s_mov_b32 s42, s7
    v_and_b32 v198, s54, v190
    v_mfma_f32_16x16x32_bf16 v[44:47], v[172:175], v[140:143], v[44:47]
    ds_read_b128 v[164:167], v6 offset:22528
    v_sub_f32 v196, v190, v198
    v_mfma_f32_16x16x32_bf16 v[40:43], v[172:175], v[136:139], v[40:43]
    v_and_b32 v198, s54, v196
    s_waitcnt lgkmcnt(3)
    v_mfma_f32_16x16x32_bf16 v[48:51], v[176:179], v[136:139], v[48:51]
    ds_read_b128 v[168:171], v6 offset:23552
    v_sub_f32 v197, v196, v198
    v_mfma_f32_16x16x32_bf16 v[52:55], v[176:179], v[140:143], v[52:55]
    s_add_u32 s47, s11, 737280
    v_perm_b32 v204, v196, v190, s53
    v_mfma_f32_16x16x32_bf16 v[60:63], v[180:183], v[140:143], v[60:63]
    ds_read_b128 v[172:175], v6 offset:24576
    v_perm_b32 v206, v190, v197, s53
    v_mfma_f32_16x16x32_bf16 v[56:59], v[180:183], v[136:139], v[56:59]
    v_rcp_f32 v194, v191
    s_waitcnt lgkmcnt(3)
    v_mfma_f32_16x16x32_bf16 v[64:67], v[184:187], v[136:139], v[64:67]
    ds_read_b128 v[176:179], v6 offset:25600
    v_and_b32 v198, s54, v194
    v_mfma_f32_16x16x32_bf16 v[68:71], v[184:187], v[140:143], v[68:71]
    v_sub_f32 v196, v194, v198
    v_mfma_f32_16x16x32_bf16 v[76:79], v[160:163], v[140:143], v[76:79]
    ds_read_b128 v[180:183], v6 offset:26624
    v_and_b32 v198, s54, v196
    v_mfma_f32_16x16x32_bf16 v[72:75], v[160:163], v[136:139], v[72:75]
    v_sub_f32 v197, v196, v198
    s_waitcnt lgkmcnt(3)
    v_mfma_f32_16x16x32_bf16 v[80:83], v[164:167], v[136:139], v[80:83]
    ds_read_b128 v[184:187], v6 offset:27648
    v_perm_b32 v199, v196, v194, s53
    v_mfma_f32_16x16x32_bf16 v[84:87], v[164:167], v[140:143], v[84:87]
    v_lshrrev_b32 v201, 16, v197
    v_add_u32 v6, s52, v6
    s_barrier
    v_mfma_f32_16x16x32_bf16 v[92:95], v[168:171], v[140:143], v[92:95]
    ds_read_b128 v[160:163], v6 offset:0
    v_mov_b32 v208, v204
    v_mfma_f32_16x16x32_bf16 v[88:91], v[168:171], v[136:139], v[88:91]
    v_mov_b32 v210, v206
    s_waitcnt lgkmcnt(3)
    v_mfma_f32_16x16x32_bf16 v[96:99], v[172:175], v[136:139], v[96:99]
    ds_read_b128 v[164:167], v6 offset:1024
    v_mov_b32 v200, v199
    v_mfma_f32_16x16x32_bf16 v[100:103], v[172:175], v[140:143], v[100:103]
    v_mov_b32 v202, v201
    v_mfma_f32_16x16x32_bf16 v[108:111], v[176:179], v[140:143], v[108:111]
    ds_read_b128 v[168:171], v6 offset:2048
    v_mfma_f32_16x16x32_bf16 v[104:107], v[176:179], v[136:139], v[104:107]
    v_permlane16_swap_b32 v204, v208
    s_waitcnt lgkmcnt(3)
    v_mfma_f32_16x16x32_bf16 v[112:115], v[180:183], v[136:139], v[112:115]
    ds_read_b128 v[172:175], v6 offset:3072
    v_permlane16_swap_b32 v206, v210
    v_mfma_f32_16x16x32_bf16 v[116:119], v[180:183], v[140:143], v[116:119]
    v_permlane16_swap_b32 v199, v200
    v_mfma_f32_16x16x32_bf16 v[124:127], v[184:187], v[140:143], v[124:127]
    ds_read_b128 v[176:179], v6 offset:4096
    v_permlane16_swap_b32 v201, v202
    v_mfma_f32_16x16x32_bf16 v[120:123], v[184:187], v[136:139], v[120:123]
    v_mov_b32 v205, v204
    s_waitcnt vmcnt(2) lgkmcnt(3)
    v_mfma_f32_16x16x32_bf16 v[16:19], v[160:163], v[144:147], v[16:19]
    ds_read_b128 v[180:183], v6 offset:5120
    v_mov_b32 v209, v208
    v_mfma_f32_16x16x32_bf16 v[20:23], v[160:163], v[148:151], v[20:23]
    s_add_u32 s49, s49, 28672
    v_cmp_gt_u32 vcc, 32, v0
    v_mfma_f32_16x16x32_bf16 v[28:31], v[164:167], v[148:151], v[28:31]
    ds_read_b128 v[184:187], v6 offset:6144
    v_mfma_f32_16x16x32_bf16 v[24:27], v[164:167], v[144:147], v[24:27]
    v_cndmask_b32 v207, 0, v201, vcc
    s_waitcnt lgkmcnt(3)
    v_mfma_f32_16x16x32_bf16 v[32:35], v[168:171], v[144:147], v[32:35]
    ds_read_b128 v[160:163], v6 offset:7168
    v_cndmask_b32 v211, 0, v202, vcc
    v_mfma_f32_16x16x32_bf16 v[36:39], v[168:171], v[148:151], v[36:39]
    s_cmp_eq_u32 s49, 143360
    s_cselect_b32 s52, s56, s57
    v_cmp_gt_u32 vcc, 16, v0
    v_mfma_f32_16x16x32_bf16 v[44:47], v[172:175], v[148:151], v[44:47]
    ds_read_b128 v[164:167], v6 offset:8192
    v_mfma_f32_16x16x32_bf16 v[40:43], v[172:175], v[144:147], v[40:43]
    v_cndmask_b32 v207, v207, v199, vcc
    s_waitcnt lgkmcnt(3)
    v_mfma_f32_16x16x32_bf16 v[48:51], v[176:179], v[144:147], v[48:51]
    ds_read_b128 v[168:171], v6 offset:9216
    v_cndmask_b32 v211, v211, v200, vcc
    v_mfma_f32_16x16x32_bf16 v[52:55], v[176:179], v[148:151], v[52:55]
    s_cselect_b32 s49, 0, s49
    v_mul_f32 v212, 0xc0135761, v191
    v_mfma_f32_16x16x32_bf16 v[60:63], v[180:183], v[148:151], v[60:63]
    ds_read_b128 v[172:175], v6 offset:10240
    v_mul_f32 v214, v191, v191
    v_mfma_f32_16x16x32_bf16 v[56:59], v[180:183], v[144:147], v[56:59]
    v_mul_f32 v214, v214, v191
    s_waitcnt lgkmcnt(3)
    v_mfma_f32_16x16x32_bf16 v[64:67], v[184:187], v[144:147], v[64:67]
    ds_read_b128 v[176:179], v6 offset:11264
    v_mul_f32 v214, 0xbdd2d3e8, v214
    v_mfma_f32_16x16x32_bf16 v[68:71], v[184:187], v[148:151], v[68:71]
    v_mov_b32 v216, v194
    v_mfma_f32_16x16x32_bf16 v[76:79], v[160:163], v[148:151], v[76:79]
    ds_read_b128 v[180:183], v6 offset:12288
    v_mov_b32 v213, v212
    v_mfma_f32_16x16x32_bf16 v[72:75], v[160:163], v[144:147], v[72:75]
    v_mov_b32 v215, v214
    s_waitcnt lgkmcnt(3)
    v_mfma_f32_16x16x32_bf16 v[80:83], v[164:167], v[144:147], v[80:83]
    ds_read_b128 v[184:187], v6 offset:13312
    v_mov_b32 v217, v216
    v_mfma_f32_16x16x32_bf16 v[84:87], v[164:167], v[148:151], v[84:87]
    v_mfma_f32_16x16x32_bf16 v[92:95], v[168:171], v[148:151], v[92:95]
    ds_read_b128 v[160:163], v6 offset:14336
    v_permlane16_swap_b32 v212, v213
    v_mfma_f32_16x16x32_bf16 v[88:91], v[168:171], v[144:147], v[88:91]
    v_permlane16_swap_b32 v214, v215
    s_waitcnt lgkmcnt(3)
    v_mfma_f32_16x16x32_bf16 v[96:99], v[172:175], v[144:147], v[96:99]
    ds_read_b128 v[164:167], v6 offset:15360
    v_permlane16_swap_b32 v216, v217
    v_mfma_f32_16x16x32_bf16 v[100:103], v[172:175], v[148:151], v[100:103]
    v_mov_b32 v15, 1
    v_mfma_f32_16x16x32_bf16 v[108:111], v[176:179], v[148:151], v[108:111]
    ds_read_b128 v[168:171], v6 offset:16384
    v_mfma_f32_16x16x32_bf16 v[104:107], v[176:179], v[144:147], v[104:107]
    s_waitcnt lgkmcnt(3)
    v_mfma_f32_16x16x32_bf16 v[112:115], v[180:183], v[144:147], v[112:115]
    ds_read_b128 v[172:175], v6 offset:17408
    v_mfma_f32_16x16x32_bf16 v[116:119], v[180:183], v[148:151], v[116:119]
    v_mfma_f32_16x16x32_bf16 v[124:127], v[184:187], v[148:151], v[124:127]
    ds_read_b128 v[176:179], v6 offset:18432
    v_mfma_f32_16x16x32_bf16 v[120:123], v[184:187], v[144:147], v[120:123]
    s_waitcnt vmcnt(0) lgkmcnt(3)
    v_mfma_f32_16x16x32_bf16 v[16:19], v[160:163], v[152:155], v[16:19]
    ds_read_b128 v[180:183], v6 offset:19456
    v_mfma_f32_16x16x32_bf16 v[20:23], v[160:163], v[156:159], v[20:23]
    v_mfma_f32_16x16x32_bf16 v[28:31], v[164:167], v[156:159], v[28:31]
    ds_read_b128 v[184:187], v6 offset:20480
    v_mfma_f32_16x16x32_bf16 v[24:27], v[164:167], v[152:155], v[24:27]
    s_waitcnt lgkmcnt(3)
    v_mfma_f32_16x16x32_bf16 v[32:35], v[168:171], v[152:155], v[32:35]
    ds_read_b128 v[160:163], v6 offset:21504
    v_mfma_f32_16x16x32_bf16 v[36:39], v[168:171], v[156:159], v[36:39]
    v_mfma_f32_16x16x32_bf16 v[44:47], v[172:175], v[156:159], v[44:47]
    ds_read_b128 v[164:167], v6 offset:22528
    v_mfma_f32_16x16x32_bf16 v[40:43], v[172:175], v[152:155], v[40:43]
    s_waitcnt lgkmcnt(3)
    v_mfma_f32_16x16x32_bf16 v[48:51], v[176:179], v[152:155], v[48:51]
    ds_read_b128 v[168:171], v6 offset:23552
    v_mfma_f32_16x16x32_bf16 v[52:55], v[176:179], v[156:159], v[52:55]
    v_mfma_f32_16x16x32_bf16 v[60:63], v[180:183], v[156:159], v[60:63]
    ds_read_b128 v[172:175], v6 offset:24576
    v_mfma_f32_16x16x32_bf16 v[56:59], v[180:183], v[152:155], v[56:59]
    s_waitcnt lgkmcnt(3)
    v_mfma_f32_16x16x32_bf16 v[64:67], v[184:187], v[152:155], v[64:67]
    ds_read_b128 v[176:179], v6 offset:25600
    v_mfma_f32_16x16x32_bf16 v[68:71], v[184:187], v[156:159], v[68:71]
    v_mfma_f32_16x16x32_bf16 v[76:79], v[160:163], v[156:159], v[76:79]
    ds_read_b128 v[180:183], v6 offset:26624
    v_mfma_f32_16x16x32_bf16 v[72:75], v[160:163], v[152:155], v[72:75]
    s_waitcnt lgkmcnt(3)
    v_mfma_f32_16x16x32_bf16 v[80:83], v[164:167], v[152:155], v[80:83]
    ds_read_b128 v[184:187], v6 offset:27648
    v_mfma_f32_16x16x32_bf16 v[84:87], v[164:167], v[156:159], v[84:87]
    v_add_u32 v6, s52, v6
    s_barrier
    v_mfma_f32_16x16x32_bf16 v[92:95], v[168:171], v[156:159], v[92:95]
    ds_read_b128 v[160:163], v6 offset:0
    v_mfma_f32_16x16x32_bf16 v[88:91], v[168:171], v[152:155], v[88:91]
    s_waitcnt lgkmcnt(3)
    v_mfma_f32_16x16x32_bf16 v[96:99], v[172:175], v[152:155], v[96:99]
    ds_read_b128 v[164:167], v6 offset:1024
    v_mfma_f32_16x16x32_bf16 v[100:103], v[172:175], v[156:159], v[100:103]
    v_mfma_f32_16x16x32_bf16 v[108:111], v[176:179], v[156:159], v[108:111]
    ds_read_b128 v[168:171], v6 offset:2048
    v_mfma_f32_16x16x32_bf16 v[104:107], v[176:179], v[152:155], v[104:107]
    s_waitcnt lgkmcnt(3)
    v_mfma_f32_16x16x32_bf16 v[112:115], v[180:183], v[152:155], v[112:115]
    ds_read_b128 v[172:175], v6 offset:3072
    v_mfma_f32_16x16x32_bf16 v[116:119], v[180:183], v[156:159], v[116:119]
    v_mfma_f32_16x16x32_bf16 v[124:127], v[184:187], v[156:159], v[124:127]
    ds_read_b128 v[176:179], v6 offset:4096
    v_mfma_f32_16x16x32_bf16 v[120:123], v[184:187], v[152:155], v[120:123]
    s_waitcnt lgkmcnt(3)
    v_mfma_f32_16x16x32_bf16 v[16:19], v[160:163], v[204:207], v[16:19]
    ds_read_b128 v[180:183], v6 offset:5120
    v_mfma_f32_16x16x32_bf16 v[20:23], v[160:163], v[208:211], v[20:23]
    v_mfma_f32_16x16x32_bf16 v[28:31], v[164:167], v[208:211], v[28:31]
    ds_read_b128 v[184:187], v6 offset:6144
    v_mfma_f32_16x16x32_bf16 v[24:27], v[164:167], v[204:207], v[24:27]
    s_waitcnt lgkmcnt(3)
    v_mfma_f32_16x16x32_bf16 v[32:35], v[168:171], v[204:207], v[32:35]
    ds_read_b128 v[160:163], v6 offset:7168
    v_mfma_f32_16x16x32_bf16 v[36:39], v[168:171], v[208:211], v[36:39]
    v_mfma_f32_16x16x32_bf16 v[44:47], v[172:175], v[208:211], v[44:47]
    ds_read_b128 v[164:167], v6 offset:8192
    v_mfma_f32_16x16x32_bf16 v[40:43], v[172:175], v[204:207], v[40:43]
    s_waitcnt lgkmcnt(3)
    v_mfma_f32_16x16x32_bf16 v[48:51], v[176:179], v[204:207], v[48:51]
    ds_read_b128 v[168:171], v6 offset:9216
    v_mfma_f32_16x16x32_bf16 v[52:55], v[176:179], v[208:211], v[52:55]
    v_mfma_f32_16x16x32_bf16 v[60:63], v[180:183], v[208:211], v[60:63]
    ds_read_b128 v[172:175], v6 offset:10240
    v_mfma_f32_16x16x32_bf16 v[56:59], v[180:183], v[204:207], v[56:59]
    s_waitcnt lgkmcnt(3)
    v_mfma_f32_16x16x32_bf16 v[64:67], v[184:187], v[204:207], v[64:67]
    ds_read_b128 v[176:179], v6 offset:11264
    v_mfma_f32_16x16x32_bf16 v[68:71], v[184:187], v[208:211], v[68:71]
    v_mfma_f32_16x16x32_bf16 v[76:79], v[160:163], v[208:211], v[76:79]
    ds_read_b128 v[180:183], v6 offset:12288
    v_mfma_f32_16x16x32_bf16 v[72:75], v[160:163], v[204:207], v[72:75]
    s_waitcnt lgkmcnt(3)
    v_mfma_f32_16x16x32_bf16 v[80:83], v[164:167], v[204:207], v[80:83]
    ds_read_b128 v[184:187], v6 offset:13312
    v_mfma_f32_16x16x32_bf16 v[84:87], v[164:167], v[208:211], v[84:87]
    v_mfma_f32_16x16x32_bf16 v[92:95], v[168:171], v[208:211], v[92:95]
    v_mfma_f32_16x16x32_bf16 v[88:91], v[168:171], v[204:207], v[88:91]
    s_waitcnt lgkmcnt(2)
    v_mfma_f32_16x16x32_bf16 v[96:99], v[172:175], v[204:207], v[96:99]
    v_mfma_f32_16x16x32_bf16 v[100:103], v[172:175], v[208:211], v[100:103]
    v_mfma_f32_16x16x32_bf16 v[108:111], v[176:179], v[208:211], v[108:111]
    v_mfma_f32_16x16x32_bf16 v[104:107], v[176:179], v[204:207], v[104:107]
    s_waitcnt lgkmcnt(0)
    v_mfma_f32_16x16x32_bf16 v[112:115], v[180:183], v[204:207], v[112:115]
    v_mfma_f32_16x16x32_bf16 v[116:119], v[180:183], v[208:211], v[116:119]
    v_mfma_f32_16x16x32_bf16 v[124:127], v[184:187], v[208:211], v[124:127]
    v_mfma_f32_16x16x32_bf16 v[120:123], v[184:187], v[204:207], v[120:123]
    s_barrier
    v_pk_mul_f32 v[128:129], v[16:17], v[16:17]
    v_pk_mul_f32 v[130:131], v[18:19], v[18:19]
    v_pk_mul_f32 v[132:133], v[20:21], v[20:21]
    v_pk_mul_f32 v[134:135], v[22:23], v[22:23]
    v_pk_mul_f32 v[136:137], v[24:25], v[24:25]
    v_pk_mul_f32 v[138:139], v[26:27], v[26:27]
    v_pk_mul_f32 v[140:141], v[28:29], v[28:29]
    v_pk_mul_f32 v[142:143], v[30:31], v[30:31]
    v_pk_fma_f32 v[128:129], v[128:129], v[214:215], v[212:213] op_sel:[0,0,0] op_sel_hi:[1,0,0]
    v_pk_fma_f32 v[130:131], v[130:131], v[214:215], v[212:213] op_sel:[0,0,0] op_sel_hi:[1,0,0]
    v_pk_fma_f32 v[132:133], v[132:133], v[214:215], v[212:213] op_sel:[0,1,1] op_sel_hi:[1,1,1]
    v_pk_fma_f32 v[134:135], v[134:135], v[214:215], v[212:213] op_sel:[0,1,1] op_sel_hi:[1,1,1]
    v_pk_fma_f32 v[136:137], v[136:137], v[214:215], v[212:213] op_sel:[0,0,0] op_sel_hi:[1,0,0]
    v_pk_fma_f32 v[138:139], v[138:139], v[214:215], v[212:213] op_sel:[0,0,0] op_sel_hi:[1,0,0]
    v_pk_fma_f32 v[140:141], v[140:141], v[214:215], v[212:213] op_sel:[0,1,1] op_sel_hi:[1,1,1]
    v_pk_fma_f32 v[142:143], v[142:143], v[214:215], v[212:213] op_sel:[0,1,1] op_sel_hi:[1,1,1]
    v_pk_mul_f32 v[128:129], v[128:129], v[16:17]
    v_pk_mul_f32 v[130:131], v[130:131], v[18:19]
    v_pk_mul_f32 v[132:133], v[132:133], v[20:21]
    v_pk_mul_f32 v[134:135], v[134:135], v[22:23]
    v_pk_mul_f32 v[136:137], v[136:137], v[24:25]
    v_pk_mul_f32 v[138:139], v[138:139], v[26:27]
    v_pk_mul_f32 v[140:141], v[140:141], v[28:29]
    v_pk_mul_f32 v[142:143], v[142:143], v[30:31]
    v_exp_f32 v128, v128
    v_exp_f32 v129, v129
    v_exp_f32 v130, v130
    v_exp_f32 v131, v131
    v_exp_f32 v132, v132
    v_exp_f32 v133, v133
    v_exp_f32 v134, v134
    v_exp_f32 v135, v135
    v_exp_f32 v136, v136
    v_exp_f32 v137, v137
    v_exp_f32 v138, v138
    v_exp_f32 v139, v139
    v_exp_f32 v140, v140
    v_exp_f32 v141, v141
    v_exp_f32 v142, v142
    v_exp_f32 v143, v143
    v_pk_fma_f32 v[128:129], v[128:129], v[216:217], v[216:217] op_sel:[0,0,0] op_sel_hi:[1,0,0]
    v_pk_fma_f32 v[130:131], v[130:131], v[216:217], v[216:217] op_sel:[0,0,0] op_sel_hi:[1,0,0]
    v_pk_fma_f32 v[132:133], v[132:133], v[216:217], v[216:217] op_sel:[0,1,1] op_sel_hi:[1,1,1]
    v_pk_fma_f32 v[134:135], v[134:135], v[216:217], v[216:217] op_sel:[0,1,1] op_sel_hi:[1,1,1]
    v_pk_fma_f32 v[136:137], v[136:137], v[216:217], v[216:217] op_sel:[0,0,0] op_sel_hi:[1,0,0]
    v_pk_fma_f32 v[138:139], v[138:139], v[216:217], v[216:217] op_sel:[0,0,0] op_sel_hi:[1,0,0]
    v_pk_fma_f32 v[140:141], v[140:141], v[216:217], v[216:217] op_sel:[0,1,1] op_sel_hi:[1,1,1]
    v_pk_fma_f32 v[142:143], v[142:143], v[216:217], v[216:217] op_sel:[0,1,1] op_sel_hi:[1,1,1]
    v_rcp_f32 v128, v128
    v_rcp_f32 v129, v129
    v_rcp_f32 v130, v130
    v_rcp_f32 v131, v131
    v_rcp_f32 v132, v132
    v_rcp_f32 v133, v133
    v_rcp_f32 v134, v134
    v_rcp_f32 v135, v135
    v_rcp_f32 v136, v136
    v_rcp_f32 v137, v137
    v_rcp_f32 v138, v138
    v_rcp_f32 v139, v139
    v_rcp_f32 v140, v140
    v_rcp_f32 v141, v141
    v_rcp_f32 v142, v142
    v_rcp_f32 v143, v143
    v_pk_mul_f32 v[16:17], v[128:129], v[16:17]
    v_pk_mul_f32 v[18:19], v[130:131], v[18:19]
    v_pk_mul_f32 v[20:21], v[132:133], v[20:21]
    v_pk_mul_f32 v[22:23], v[134:135], v[22:23]
    v_pk_mul_f32 v[24:25], v[136:137], v[24:25]
    v_pk_mul_f32 v[26:27], v[138:139], v[26:27]
    v_pk_mul_f32 v[28:29], v[140:141], v[28:29]
    v_pk_mul_f32 v[30:31], v[142:143], v[30:31]
    v_cvt_pk_bf16_f32 v16, v16, v17
    v_cvt_pk_bf16_f32 v17, v18, v19
    v_cvt_pk_bf16_f32 v18, v24, v25
    v_cvt_pk_bf16_f32 v19, v26, v27
    v_cvt_pk_bf16_f32 v20, v20, v21
    v_cvt_pk_bf16_f32 v21, v22, v23
    v_cvt_pk_bf16_f32 v22, v28, v29
    v_cvt_pk_bf16_f32 v23, v30, v31
    buffer_store_dwordx4 v[16:19], v1, s[24:27], s42 offen offset:0 sc1
    buffer_store_dwordx4 v[20:23], v1, s[24:27], s42 offen offset:1024 sc1
    s_add_u32 s42, s42, 65536
    v_pk_mul_f32 v[128:129], v[32:33], v[32:33]
    v_pk_mul_f32 v[130:131], v[34:35], v[34:35]
    v_pk_mul_f32 v[132:133], v[36:37], v[36:37]
    v_pk_mul_f32 v[134:135], v[38:39], v[38:39]
    v_pk_mul_f32 v[136:137], v[40:41], v[40:41]
    v_pk_mul_f32 v[138:139], v[42:43], v[42:43]
    v_pk_mul_f32 v[140:141], v[44:45], v[44:45]
    v_pk_mul_f32 v[142:143], v[46:47], v[46:47]
    v_pk_fma_f32 v[128:129], v[128:129], v[214:215], v[212:213] op_sel:[0,0,0] op_sel_hi:[1,0,0]
    v_pk_fma_f32 v[130:131], v[130:131], v[214:215], v[212:213] op_sel:[0,0,0] op_sel_hi:[1,0,0]
    v_pk_fma_f32 v[132:133], v[132:133], v[214:215], v[212:213] op_sel:[0,1,1] op_sel_hi:[1,1,1]
    v_pk_fma_f32 v[134:135], v[134:135], v[214:215], v[212:213] op_sel:[0,1,1] op_sel_hi:[1,1,1]
    v_pk_fma_f32 v[136:137], v[136:137], v[214:215], v[212:213] op_sel:[0,0,0] op_sel_hi:[1,0,0]
    v_pk_fma_f32 v[138:139], v[138:139], v[214:215], v[212:213] op_sel:[0,0,0] op_sel_hi:[1,0,0]
    v_pk_fma_f32 v[140:141], v[140:141], v[214:215], v[212:213] op_sel:[0,1,1] op_sel_hi:[1,1,1]
    v_pk_fma_f32 v[142:143], v[142:143], v[214:215], v[212:213] op_sel:[0,1,1] op_sel_hi:[1,1,1]
    v_pk_mul_f32 v[128:129], v[128:129], v[32:33]
    v_pk_mul_f32 v[130:131], v[130:131], v[34:35]
    v_pk_mul_f32 v[132:133], v[132:133], v[36:37]
    v_pk_mul_f32 v[134:135], v[134:135], v[38:39]
    v_pk_mul_f32 v[136:137], v[136:137], v[40:41]
    v_pk_mul_f32 v[138:139], v[138:139], v[42:43]
    v_pk_mul_f32 v[140:141], v[140:141], v[44:45]
    v_pk_mul_f32 v[142:143], v[142:143], v[46:47]
    v_exp_f32 v128, v128
    v_exp_f32 v129, v129
    v_exp_f32 v130, v130
    v_exp_f32 v131, v131
    v_exp_f32 v132, v132
    v_exp_f32 v133, v133
    v_exp_f32 v134, v134
    v_exp_f32 v135, v135
    v_exp_f32 v136, v136
    v_exp_f32 v137, v137
    v_exp_f32 v138, v138
    v_exp_f32 v139, v139
    v_exp_f32 v140, v140
    v_exp_f32 v141, v141
    v_exp_f32 v142, v142
    v_exp_f32 v143, v143
    v_pk_fma_f32 v[128:129], v[128:129], v[216:217], v[216:217] op_sel:[0,0,0] op_sel_hi:[1,0,0]
    v_pk_fma_f32 v[130:131], v[130:131], v[216:217], v[216:217] op_sel:[0,0,0] op_sel_hi:[1,0,0]
    v_pk_fma_f32 v[132:133], v[132:133], v[216:217], v[216:217] op_sel:[0,1,1] op_sel_hi:[1,1,1]
    v_pk_fma_f32 v[134:135], v[134:135], v[216:217], v[216:217] op_sel:[0,1,1] op_sel_hi:[1,1,1]
    v_pk_fma_f32 v[136:137], v[136:137], v[216:217], v[216:217] op_sel:[0,0,0] op_sel_hi:[1,0,0]
    v_pk_fma_f32 v[138:139], v[138:139], v[216:217], v[216:217] op_sel:[0,0,0] op_sel_hi:[1,0,0]
    v_pk_fma_f32 v[140:141], v[140:141], v[216:217], v[216:217] op_sel:[0,1,1] op_sel_hi:[1,1,1]
    v_pk_fma_f32 v[142:143], v[142:143], v[216:217], v[216:217] op_sel:[0,1,1] op_sel_hi:[1,1,1]
    v_rcp_f32 v128, v128
    v_rcp_f32 v129, v129
    v_rcp_f32 v130, v130
    v_rcp_f32 v131, v131
    v_rcp_f32 v132, v132
    v_rcp_f32 v133, v133
    v_rcp_f32 v134, v134
    v_rcp_f32 v135, v135
    v_rcp_f32 v136, v136
    v_rcp_f32 v137, v137
    v_rcp_f32 v138, v138
    v_rcp_f32 v139, v139
    v_rcp_f32 v140, v140
    v_rcp_f32 v141, v141
    v_rcp_f32 v142, v142
    v_rcp_f32 v143, v143
    v_pk_mul_f32 v[32:33], v[128:129], v[32:33]
    v_pk_mul_f32 v[34:35], v[130:131], v[34:35]
    v_pk_mul_f32 v[36:37], v[132:133], v[36:37]
    v_pk_mul_f32 v[38:39], v[134:135], v[38:39]
    v_pk_mul_f32 v[40:41], v[136:137], v[40:41]
    v_pk_mul_f32 v[42:43], v[138:139], v[42:43]
    v_pk_mul_f32 v[44:45], v[140:141], v[44:45]
    v_pk_mul_f32 v[46:47], v[142:143], v[46:47]
    v_cvt_pk_bf16_f32 v24, v32, v33
    v_cvt_pk_bf16_f32 v25, v34, v35
    v_cvt_pk_bf16_f32 v26, v40, v41
    v_cvt_pk_bf16_f32 v27, v42, v43
    v_cvt_pk_bf16_f32 v28, v36, v37
    v_cvt_pk_bf16_f32 v29, v38, v39
    v_cvt_pk_bf16_f32 v30, v44, v45
    v_cvt_pk_bf16_f32 v31, v46, v47
    buffer_store_dwordx4 v[24:27], v1, s[24:27], s42 offen offset:0 sc1
    buffer_store_dwordx4 v[28:31], v1, s[24:27], s42 offen offset:1024 sc1
    s_add_u32 s42, s42, 65536
    v_pk_mul_f32 v[128:129], v[48:49], v[48:49]
    v_pk_mul_f32 v[130:131], v[50:51], v[50:51]
    v_pk_mul_f32 v[132:133], v[52:53], v[52:53]
    v_pk_mul_f32 v[134:135], v[54:55], v[54:55]
    v_pk_mul_f32 v[136:137], v[56:57], v[56:57]
    v_pk_mul_f32 v[138:139], v[58:59], v[58:59]
    v_pk_mul_f32 v[140:141], v[60:61], v[60:61]
    v_pk_mul_f32 v[142:143], v[62:63], v[62:63]
    v_pk_fma_f32 v[128:129], v[128:129], v[214:215], v[212:213] op_sel:[0,0,0] op_sel_hi:[1,0,0]
    v_pk_fma_f32 v[130:131], v[130:131], v[214:215], v[212:213] op_sel:[0,0,0] op_sel_hi:[1,0,0]
    v_pk_fma_f32 v[132:133], v[132:133], v[214:215], v[212:213] op_sel:[0,1,1] op_sel_hi:[1,1,1]
    v_pk_fma_f32 v[134:135], v[134:135], v[214:215], v[212:213] op_sel:[0,1,1] op_sel_hi:[1,1,1]
    v_pk_fma_f32 v[136:137], v[136:137], v[214:215], v[212:213] op_sel:[0,0,0] op_sel_hi:[1,0,0]
    v_pk_fma_f32 v[138:139], v[138:139], v[214:215], v[212:213] op_sel:[0,0,0] op_sel_hi:[1,0,0]
    v_pk_fma_f32 v[140:141], v[140:141], v[214:215], v[212:213] op_sel:[0,1,1] op_sel_hi:[1,1,1]
    v_pk_fma_f32 v[142:143], v[142:143], v[214:215], v[212:213] op_sel:[0,1,1] op_sel_hi:[1,1,1]
    v_pk_mul_f32 v[128:129], v[128:129], v[48:49]
    v_pk_mul_f32 v[130:131], v[130:131], v[50:51]
    v_pk_mul_f32 v[132:133], v[132:133], v[52:53]
    v_pk_mul_f32 v[134:135], v[134:135], v[54:55]
    v_pk_mul_f32 v[136:137], v[136:137], v[56:57]
    v_pk_mul_f32 v[138:139], v[138:139], v[58:59]
    v_pk_mul_f32 v[140:141], v[140:141], v[60:61]
    v_pk_mul_f32 v[142:143], v[142:143], v[62:63]
    v_exp_f32 v128, v128
    v_exp_f32 v129, v129
    v_exp_f32 v130, v130
    v_exp_f32 v131, v131
    v_exp_f32 v132, v132
    v_exp_f32 v133, v133
    v_exp_f32 v134, v134
    v_exp_f32 v135, v135
    v_exp_f32 v136, v136
    v_exp_f32 v137, v137
    v_exp_f32 v138, v138
    v_exp_f32 v139, v139
    v_exp_f32 v140, v140
    v_exp_f32 v141, v141
    v_exp_f32 v142, v142
    v_exp_f32 v143, v143
    v_pk_fma_f32 v[128:129], v[128:129], v[216:217], v[216:217] op_sel:[0,0,0] op_sel_hi:[1,0,0]
    v_pk_fma_f32 v[130:131], v[130:131], v[216:217], v[216:217] op_sel:[0,0,0] op_sel_hi:[1,0,0]
    v_pk_fma_f32 v[132:133], v[132:133], v[216:217], v[216:217] op_sel:[0,1,1] op_sel_hi:[1,1,1]
    v_pk_fma_f32 v[134:135], v[134:135], v[216:217], v[216:217] op_sel:[0,1,1] op_sel_hi:[1,1,1]
    v_pk_fma_f32 v[136:137], v[136:137], v[216:217], v[216:217] op_sel:[0,0,0] op_sel_hi:[1,0,0]
    v_pk_fma_f32 v[138:139], v[138:139], v[216:217], v[216:217] op_sel:[0,0,0] op_sel_hi:[1,0,0]
    v_pk_fma_f32 v[140:141], v[140:141], v[216:217], v[216:217] op_sel:[0,1,1] op_sel_hi:[1,1,1]
    v_pk_fma_f32 v[142:143], v[142:143], v[216:217], v[216:217] op_sel:[0,1,1] op_sel_hi:[1,1,1]
    v_rcp_f32 v128, v128
    v_rcp_f32 v129, v129
    v_rcp_f32 v130, v130
    v_rcp_f32 v131, v131
    v_rcp_f32 v132, v132
    v_rcp_f32 v133, v133
    v_rcp_f32 v134, v134
    v_rcp_f32 v135, v135
    v_rcp_f32 v136, v136
    v_rcp_f32 v137, v137
    v_rcp_f32 v138, v138
    v_rcp_f32 v139, v139
    v_rcp_f32 v140, v140
    v_rcp_f32 v141, v141
    v_rcp_f32 v142, v142
    v_rcp_f32 v143, v143
    v_pk_mul_f32 v[48:49], v[128:129], v[48:49]
    v_pk_mul_f32 v[50:51], v[130:131], v[50:51]
    v_pk_mul_f32 v[52:53], v[132:133], v[52:53]
    v_pk_mul_f32 v[54:55], v[134:135], v[54:55]
    v_pk_mul_f32 v[56:57], v[136:137], v[56:57]
    v_pk_mul_f32 v[58:59], v[138:139], v[58:59]
    v_pk_mul_f32 v[60:61], v[140:141], v[60:61]
    v_pk_mul_f32 v[62:63], v[142:143], v[62:63]
    v_cvt_pk_bf16_f32 v32, v48, v49
    v_cvt_pk_bf16_f32 v33, v50, v51
    v_cvt_pk_bf16_f32 v34, v56, v57
    v_cvt_pk_bf16_f32 v35, v58, v59
    v_cvt_pk_bf16_f32 v36, v52, v53
    v_cvt_pk_bf16_f32 v37, v54, v55
    v_cvt_pk_bf16_f32 v38, v60, v61
    v_cvt_pk_bf16_f32 v39, v62, v63
    buffer_store_dwordx4 v[32:35], v1, s[24:27], s42 offen offset:0 sc1
    buffer_store_dwordx4 v[36:39], v1, s[24:27], s42 offen offset:1024 sc1
    s_add_u32 s42, s42, 65536
    v_pk_mul_f32 v[128:129], v[64:65], v[64:65]
    v_pk_mul_f32 v[130:131], v[66:67], v[66:67]
    v_pk_mul_f32 v[132:133], v[68:69], v[68:69]
    v_pk_mul_f32 v[134:135], v[70:71], v[70:71]
    v_pk_mul_f32 v[136:137], v[72:73], v[72:73]
    v_pk_mul_f32 v[138:139], v[74:75], v[74:75]
    v_pk_mul_f32 v[140:141], v[76:77], v[76:77]
    v_pk_mul_f32 v[142:143], v[78:79], v[78:79]
    v_pk_fma_f32 v[128:129], v[128:129], v[214:215], v[212:213] op_sel:[0,0,0] op_sel_hi:[1,0,0]
    v_pk_fma_f32 v[130:131], v[130:131], v[214:215], v[212:213] op_sel:[0,0,0] op_sel_hi:[1,0,0]
    v_pk_fma_f32 v[132:133], v[132:133], v[214:215], v[212:213] op_sel:[0,1,1] op_sel_hi:[1,1,1]
    v_pk_fma_f32 v[134:135], v[134:135], v[214:215], v[212:213] op_sel:[0,1,1] op_sel_hi:[1,1,1]
    v_pk_fma_f32 v[136:137], v[136:137], v[214:215], v[212:213] op_sel:[0,0,0] op_sel_hi:[1,0,0]
    v_pk_fma_f32 v[138:139], v[138:139], v[214:215], v[212:213] op_sel:[0,0,0] op_sel_hi:[1,0,0]
    v_pk_fma_f32 v[140:141], v[140:141], v[214:215], v[212:213] op_sel:[0,1,1] op_sel_hi:[1,1,1]
    v_pk_fma_f32 v[142:143], v[142:143], v[214:215], v[212:213] op_sel:[0,1,1] op_sel_hi:[1,1,1]
    v_pk_mul_f32 v[128:129], v[128:129], v[64:65]
    v_pk_mul_f32 v[130:131], v[130:131], v[66:67]
    v_pk_mul_f32 v[132:133], v[132:133], v[68:69]
    v_pk_mul_f32 v[134:135], v[134:135], v[70:71]
    v_pk_mul_f32 v[136:137], v[136:137], v[72:73]
    v_pk_mul_f32 v[138:139], v[138:139], v[74:75]
    v_pk_mul_f32 v[140:141], v[140:141], v[76:77]
    v_pk_mul_f32 v[142:143], v[142:143], v[78:79]
    v_exp_f32 v128, v128
    v_exp_f32 v129, v129
    v_exp_f32 v130, v130
    v_exp_f32 v131, v131
    v_exp_f32 v132, v132
    v_exp_f32 v133, v133
    v_exp_f32 v134, v134
    v_exp_f32 v135, v135
    v_exp_f32 v136, v136
    v_exp_f32 v137, v137
    v_exp_f32 v138, v138
    v_exp_f32 v139, v139
    v_exp_f32 v140, v140
    v_exp_f32 v141, v141
    v_exp_f32 v142, v142
    v_exp_f32 v143, v143
    v_pk_fma_f32 v[128:129], v[128:129], v[216:217], v[216:217] op_sel:[0,0,0] op_sel_hi:[1,0,0]
    v_pk_fma_f32 v[130:131], v[130:131], v[216:217], v[216:217] op_sel:[0,0,0] op_sel_hi:[1,0,0]
    v_pk_fma_f32 v[132:133], v[132:133], v[216:217], v[216:217] op_sel:[0,1,1] op_sel_hi:[1,1,1]
    v_pk_fma_f32 v[134:135], v[134:135], v[216:217], v[216:217] op_sel:[0,1,1] op_sel_hi:[1,1,1]
    v_pk_fma_f32 v[136:137], v[136:137], v[216:217], v[216:217] op_sel:[0,0,0] op_sel_hi:[1,0,0]
    v_pk_fma_f32 v[138:139], v[138:139], v[216:217], v[216:217] op_sel:[0,0,0] op_sel_hi:[1,0,0]
    v_pk_fma_f32 v[140:141], v[140:141], v[216:217], v[216:217] op_sel:[0,1,1] op_sel_hi:[1,1,1]
    v_pk_fma_f32 v[142:143], v[142:143], v[216:217], v[216:217] op_sel:[0,1,1] op_sel_hi:[1,1,1]
    v_rcp_f32 v128, v128
    v_rcp_f32 v129, v129
    v_rcp_f32 v130, v130
    v_rcp_f32 v131, v131
    v_rcp_f32 v132, v132
    v_rcp_f32 v133, v133
    v_rcp_f32 v134, v134
    v_rcp_f32 v135, v135
    v_rcp_f32 v136, v136
    v_rcp_f32 v137, v137
    v_rcp_f32 v138, v138
    v_rcp_f32 v139, v139
    v_rcp_f32 v140, v140
    v_rcp_f32 v141, v141
    v_rcp_f32 v142, v142
    v_rcp_f32 v143, v143
    v_pk_mul_f32 v[64:65], v[128:129], v[64:65]
    v_pk_mul_f32 v[66:67], v[130:131], v[66:67]
    v_pk_mul_f32 v[68:69], v[132:133], v[68:69]
    v_pk_mul_f32 v[70:71], v[134:135], v[70:71]
    v_pk_mul_f32 v[72:73], v[136:137], v[72:73]
    v_pk_mul_f32 v[74:75], v[138:139], v[74:75]
    v_pk_mul_f32 v[76:77], v[140:141], v[76:77]
    v_pk_mul_f32 v[78:79], v[142:143], v[78:79]
    v_cvt_pk_bf16_f32 v40, v64, v65
    v_cvt_pk_bf16_f32 v41, v66, v67
    v_cvt_pk_bf16_f32 v42, v72, v73
    v_cvt_pk_bf16_f32 v43, v74, v75
    v_cvt_pk_bf16_f32 v44, v68, v69
    v_cvt_pk_bf16_f32 v45, v70, v71
    v_cvt_pk_bf16_f32 v46, v76, v77
    v_cvt_pk_bf16_f32 v47, v78, v79
    buffer_store_dwordx4 v[40:43], v1, s[24:27], s42 offen offset:0 sc1
    buffer_store_dwordx4 v[44:47], v1, s[24:27], s42 offen offset:1024 sc1
    s_add_u32 s42, s42, 65536
    s_waitcnt vmcnt(4)
    s_mov_b64 exec, 1
    buffer_atomic_add v15, v2, s[24:27], s47 offen sc1
    s_mov_b64 exec, -1
    s_add_u32 s47, s47, 163840
    v_pk_mul_f32 v[128:129], v[80:81], v[80:81]
    v_pk_mul_f32 v[130:131], v[82:83], v[82:83]
    v_pk_mul_f32 v[132:133], v[84:85], v[84:85]
    v_pk_mul_f32 v[134:135], v[86:87], v[86:87]
    v_pk_mul_f32 v[136:137], v[88:89], v[88:89]
    v_pk_mul_f32 v[138:139], v[90:91], v[90:91]
    v_pk_mul_f32 v[140:141], v[92:93], v[92:93]
    v_pk_mul_f32 v[142:143], v[94:95], v[94:95]
    v_pk_fma_f32 v[128:129], v[128:129], v[214:215], v[212:213] op_sel:[0,0,0] op_sel_hi:[1,0,0]
    v_pk_fma_f32 v[130:131], v[130:131], v[214:215], v[212:213] op_sel:[0,0,0] op_sel_hi:[1,0,0]
    v_pk_fma_f32 v[132:133], v[132:133], v[214:215], v[212:213] op_sel:[0,1,1] op_sel_hi:[1,1,1]
    v_pk_fma_f32 v[134:135], v[134:135], v[214:215], v[212:213] op_sel:[0,1,1] op_sel_hi:[1,1,1]
    v_pk_fma_f32 v[136:137], v[136:137], v[214:215], v[212:213] op_sel:[0,0,0] op_sel_hi:[1,0,0]
    v_pk_fma_f32 v[138:139], v[138:139], v[214:215], v[212:213] op_sel:[0,0,0] op_sel_hi:[1,0,0]
    v_pk_fma_f32 v[140:141], v[140:141], v[214:215], v[212:213] op_sel:[0,1,1] op_sel_hi:[1,1,1]
    v_pk_fma_f32 v[142:143], v[142:143], v[214:215], v[212:213] op_sel:[0,1,1] op_sel_hi:[1,1,1]
    v_pk_mul_f32 v[128:129], v[128:129], v[80:81]
    v_pk_mul_f32 v[130:131], v[130:131], v[82:83]
    v_pk_mul_f32 v[132:133], v[132:133], v[84:85]
    v_pk_mul_f32 v[134:135], v[134:135], v[86:87]
    v_pk_mul_f32 v[136:137], v[136:137], v[88:89]
    v_pk_mul_f32 v[138:139], v[138:139], v[90:91]
    v_pk_mul_f32 v[140:141], v[140:141], v[92:93]
    v_pk_mul_f32 v[142:143], v[142:143], v[94:95]
    v_exp_f32 v128, v128
    v_exp_f32 v129, v129
    v_exp_f32 v130, v130
    v_exp_f32 v131, v131
    v_exp_f32 v132, v132
    v_exp_f32 v133, v133
    v_exp_f32 v134, v134
    v_exp_f32 v135, v135
    v_exp_f32 v136, v136
    v_exp_f32 v137, v137
    v_exp_f32 v138, v138
    v_exp_f32 v139, v139
    v_exp_f32 v140, v140
    v_exp_f32 v141, v141
    v_exp_f32 v142, v142
    v_exp_f32 v143, v143
    v_pk_fma_f32 v[128:129], v[128:129], v[216:217], v[216:217] op_sel:[0,0,0] op_sel_hi:[1,0,0]
    v_pk_fma_f32 v[130:131], v[130:131], v[216:217], v[216:217] op_sel:[0,0,0] op_sel_hi:[1,0,0]
    v_pk_fma_f32 v[132:133], v[132:133], v[216:217], v[216:217] op_sel:[0,1,1] op_sel_hi:[1,1,1]
    v_pk_fma_f32 v[134:135], v[134:135], v[216:217], v[216:217] op_sel:[0,1,1] op_sel_hi:[1,1,1]
    v_pk_fma_f32 v[136:137], v[136:137], v[216:217], v[216:217] op_sel:[0,0,0] op_sel_hi:[1,0,0]
    v_pk_fma_f32 v[138:139], v[138:139], v[216:217], v[216:217] op_sel:[0,0,0] op_sel_hi:[1,0,0]
    v_pk_fma_f32 v[140:141], v[140:141], v[216:217], v[216:217] op_sel:[0,1,1] op_sel_hi:[1,1,1]
    v_pk_fma_f32 v[142:143], v[142:143], v[216:217], v[216:217] op_sel:[0,1,1] op_sel_hi:[1,1,1]
    v_rcp_f32 v128, v128
    v_rcp_f32 v129, v129
    v_rcp_f32 v130, v130
    v_rcp_f32 v131, v131
    v_rcp_f32 v132, v132
    v_rcp_f32 v133, v133
    v_rcp_f32 v134, v134
    v_rcp_f32 v135, v135
    v_rcp_f32 v136, v136
    v_rcp_f32 v137, v137
    v_rcp_f32 v138, v138
    v_rcp_f32 v139, v139
    v_rcp_f32 v140, v140
    v_rcp_f32 v141, v141
    v_rcp_f32 v142, v142
    v_rcp_f32 v143, v143
    v_pk_mul_f32 v[80:81], v[128:129], v[80:81]
    v_pk_mul_f32 v[82:83], v[130:131], v[82:83]
    v_pk_mul_f32 v[84:85], v[132:133], v[84:85]
    v_pk_mul_f32 v[86:87], v[134:135], v[86:87]
    v_pk_mul_f32 v[88:89], v[136:137], v[88:89]
    v_pk_mul_f32 v[90:91], v[138:139], v[90:91]
    v_pk_mul_f32 v[92:93], v[140:141], v[92:93]
    v_pk_mul_f32 v[94:95], v[142:143], v[94:95]
    v_cvt_pk_bf16_f32 v48, v80, v81
    v_cvt_pk_bf16_f32 v49, v82, v83
    v_cvt_pk_bf16_f32 v50, v88, v89
    v_cvt_pk_bf16_f32 v51, v90, v91
    v_cvt_pk_bf16_f32 v52, v84, v85
    v_cvt_pk_bf16_f32 v53, v86, v87
    v_cvt_pk_bf16_f32 v54, v92, v93
    v_cvt_pk_bf16_f32 v55, v94, v95
    buffer_store_dwordx4 v[48:51], v1, s[24:27], s42 offen offset:0 sc1
    buffer_store_dwordx4 v[52:55], v1, s[24:27], s42 offen offset:1024 sc1
    s_add_u32 s42, s42, 65536
    v_pk_mul_f32 v[128:129], v[96:97], v[96:97]
    v_pk_mul_f32 v[130:131], v[98:99], v[98:99]
    v_pk_mul_f32 v[132:133], v[100:101], v[100:101]
    v_pk_mul_f32 v[134:135], v[102:103], v[102:103]
    v_pk_mul_f32 v[136:137], v[104:105], v[104:105]
    v_pk_mul_f32 v[138:139], v[106:107], v[106:107]
    v_pk_mul_f32 v[140:141], v[108:109], v[108:109]
    v_pk_mul_f32 v[142:143], v[110:111], v[110:111]
    v_pk_fma_f32 v[128:129], v[128:129], v[214:215], v[212:213] op_sel:[0,0,0] op_sel_hi:[1,0,0]
    v_pk_fma_f32 v[130:131], v[130:131], v[214:215], v[212:213] op_sel:[0,0,0] op_sel_hi:[1,0,0]
    v_pk_fma_f32 v[132:133], v[132:133], v[214:215], v[212:213] op_sel:[0,1,1] op_sel_hi:[1,1,1]
    v_pk_fma_f32 v[134:135], v[134:135], v[214:215], v[212:213] op_sel:[0,1,1] op_sel_hi:[1,1,1]
    v_pk_fma_f32 v[136:137], v[136:137], v[214:215], v[212:213] op_sel:[0,0,0] op_sel_hi:[1,0,0]
    v_pk_fma_f32 v[138:139], v[138:139], v[214:215], v[212:213] op_sel:[0,0,0] op_sel_hi:[1,0,0]
    v_pk_fma_f32 v[140:141], v[140:141], v[214:215], v[212:213] op_sel:[0,1,1] op_sel_hi:[1,1,1]
    v_pk_fma_f32 v[142:143], v[142:143], v[214:215], v[212:213] op_sel:[0,1,1] op_sel_hi:[1,1,1]
    v_pk_mul_f32 v[128:129], v[128:129], v[96:97]
    v_pk_mul_f32 v[130:131], v[130:131], v[98:99]
    v_pk_mul_f32 v[132:133], v[132:133], v[100:101]
    v_pk_mul_f32 v[134:135], v[134:135], v[102:103]
    v_pk_mul_f32 v[136:137], v[136:137], v[104:105]
    v_pk_mul_f32 v[138:139], v[138:139], v[106:107]
    v_pk_mul_f32 v[140:141], v[140:141], v[108:109]
    v_pk_mul_f32 v[142:143], v[142:143], v[110:111]
    v_exp_f32 v128, v128
    v_exp_f32 v129, v129
    v_exp_f32 v130, v130
    v_exp_f32 v131, v131
    v_exp_f32 v132, v132
    v_exp_f32 v133, v133
    v_exp_f32 v134, v134
    v_exp_f32 v135, v135
    v_exp_f32 v136, v136
    v_exp_f32 v137, v137
    v_exp_f32 v138, v138
    v_exp_f32 v139, v139
    v_exp_f32 v140, v140
    v_exp_f32 v141, v141
    v_exp_f32 v142, v142
    v_exp_f32 v143, v143
    v_pk_fma_f32 v[128:129], v[128:129], v[216:217], v[216:217] op_sel:[0,0,0] op_sel_hi:[1,0,0]
    v_pk_fma_f32 v[130:131], v[130:131], v[216:217], v[216:217] op_sel:[0,0,0] op_sel_hi:[1,0,0]
    v_pk_fma_f32 v[132:133], v[132:133], v[216:217], v[216:217] op_sel:[0,1,1] op_sel_hi:[1,1,1]
    v_pk_fma_f32 v[134:135], v[134:135], v[216:217], v[216:217] op_sel:[0,1,1] op_sel_hi:[1,1,1]
    v_pk_fma_f32 v[136:137], v[136:137], v[216:217], v[216:217] op_sel:[0,0,0] op_sel_hi:[1,0,0]
    v_pk_fma_f32 v[138:139], v[138:139], v[216:217], v[216:217] op_sel:[0,0,0] op_sel_hi:[1,0,0]
    v_pk_fma_f32 v[140:141], v[140:141], v[216:217], v[216:217] op_sel:[0,1,1] op_sel_hi:[1,1,1]
    v_pk_fma_f32 v[142:143], v[142:143], v[216:217], v[216:217] op_sel:[0,1,1] op_sel_hi:[1,1,1]
    v_rcp_f32 v128, v128
    v_rcp_f32 v129, v129
    v_rcp_f32 v130, v130
    v_rcp_f32 v131, v131
    v_rcp_f32 v132, v132
    v_rcp_f32 v133, v133
    v_rcp_f32 v134, v134
    v_rcp_f32 v135, v135
    v_rcp_f32 v136, v136
    v_rcp_f32 v137, v137
    v_rcp_f32 v138, v138
    v_rcp_f32 v139, v139
    v_rcp_f32 v140, v140
    v_rcp_f32 v141, v141
    v_rcp_f32 v142, v142
    v_rcp_f32 v143, v143
    v_pk_mul_f32 v[96:97], v[128:129], v[96:97]
    v_pk_mul_f32 v[98:99], v[130:131], v[98:99]
    v_pk_mul_f32 v[100:101], v[132:133], v[100:101]
    v_pk_mul_f32 v[102:103], v[134:135], v[102:103]
    v_pk_mul_f32 v[104:105], v[136:137], v[104:105]
    v_pk_mul_f32 v[106:107], v[138:139], v[106:107]
    v_pk_mul_f32 v[108:109], v[140:141], v[108:109]
    v_pk_mul_f32 v[110:111], v[142:143], v[110:111]
    v_cvt_pk_bf16_f32 v56, v96, v97
    v_cvt_pk_bf16_f32 v57, v98, v99
    v_cvt_pk_bf16_f32 v58, v104, v105
    v_cvt_pk_bf16_f32 v59, v106, v107
    v_cvt_pk_bf16_f32 v60, v100, v101
    v_cvt_pk_bf16_f32 v61, v102, v103
    v_cvt_pk_bf16_f32 v62, v108, v109
    v_cvt_pk_bf16_f32 v63, v110, v111
    buffer_store_dwordx4 v[56:59], v1, s[24:27], s42 offen offset:0 sc1
    buffer_store_dwordx4 v[60:63], v1, s[24:27], s42 offen offset:1024 sc1
    s_add_u32 s42, s42, 65536
    v_add_u32 v6, 0, v1
    s_mov_b32 s49, 0
    s_mov_b32 s56, 0xfffe4000
    s_mov_b32 s57, 28672
    s_movk_i32 s48, 5
    s_barrier
    ds_read_b128 v[80:83], v6 offset:0
    ds_read_b128 v[84:87], v6 offset:1024
    ds_read_b128 v[88:91], v6 offset:2048
    ds_read_b128 v[92:95], v6 offset:3072
    ds_read_b128 v[96:99], v6 offset:4096
    v_pk_mul_f32 v[128:129], v[112:113], v[112:113]
    v_pk_mul_f32 v[130:131], v[114:115], v[114:115]
    v_pk_mul_f32 v[132:133], v[116:117], v[116:117]
    v_pk_mul_f32 v[134:135], v[118:119], v[118:119]
    v_pk_mul_f32 v[136:137], v[120:121], v[120:121]
    v_pk_mul_f32 v[138:139], v[122:123], v[122:123]
    v_pk_mul_f32 v[140:141], v[124:125], v[124:125]
    v_pk_mul_f32 v[142:143], v[126:127], v[126:127]
    v_pk_fma_f32 v[128:129], v[128:129], v[214:215], v[212:213] op_sel:[0,0,0] op_sel_hi:[1,0,0]
    v_pk_fma_f32 v[130:131], v[130:131], v[214:215], v[212:213] op_sel:[0,0,0] op_sel_hi:[1,0,0]
    v_pk_fma_f32 v[132:133], v[132:133], v[214:215], v[212:213] op_sel:[0,1,1] op_sel_hi:[1,1,1]
    v_pk_fma_f32 v[134:135], v[134:135], v[214:215], v[212:213] op_sel:[0,1,1] op_sel_hi:[1,1,1]
    v_pk_fma_f32 v[136:137], v[136:137], v[214:215], v[212:213] op_sel:[0,0,0] op_sel_hi:[1,0,0]
    v_pk_fma_f32 v[138:139], v[138:139], v[214:215], v[212:213] op_sel:[0,0,0] op_sel_hi:[1,0,0]
    v_pk_fma_f32 v[140:141], v[140:141], v[214:215], v[212:213] op_sel:[0,1,1] op_sel_hi:[1,1,1]
    v_pk_fma_f32 v[142:143], v[142:143], v[214:215], v[212:213] op_sel:[0,1,1] op_sel_hi:[1,1,1]
    v_pk_mul_f32 v[128:129], v[128:129], v[112:113]
    v_pk_mul_f32 v[130:131], v[130:131], v[114:115]
    v_pk_mul_f32 v[132:133], v[132:133], v[116:117]
    v_pk_mul_f32 v[134:135], v[134:135], v[118:119]
    v_pk_mul_f32 v[136:137], v[136:137], v[120:121]
    v_pk_mul_f32 v[138:139], v[138:139], v[122:123]
    v_pk_mul_f32 v[140:141], v[140:141], v[124:125]
    v_pk_mul_f32 v[142:143], v[142:143], v[126:127]
    v_exp_f32 v128, v128
    v_exp_f32 v129, v129
    v_exp_f32 v130, v130
    v_exp_f32 v131, v131
    v_exp_f32 v132, v132
    v_exp_f32 v133, v133
    v_exp_f32 v134, v134
    v_exp_f32 v135, v135
    v_exp_f32 v136, v136
    v_exp_f32 v137, v137
    v_exp_f32 v138, v138
    v_exp_f32 v139, v139
    v_exp_f32 v140, v140
    v_exp_f32 v141, v141
    v_exp_f32 v142, v142
    v_exp_f32 v143, v143
    v_pk_fma_f32 v[128:129], v[128:129], v[216:217], v[216:217] op_sel:[0,0,0] op_sel_hi:[1,0,0]
    v_pk_fma_f32 v[130:131], v[130:131], v[216:217], v[216:217] op_sel:[0,0,0] op_sel_hi:[1,0,0]
    v_pk_fma_f32 v[132:133], v[132:133], v[216:217], v[216:217] op_sel:[0,1,1] op_sel_hi:[1,1,1]
    v_pk_fma_f32 v[134:135], v[134:135], v[216:217], v[216:217] op_sel:[0,1,1] op_sel_hi:[1,1,1]
    v_pk_fma_f32 v[136:137], v[136:137], v[216:217], v[216:217] op_sel:[0,0,0] op_sel_hi:[1,0,0]
    v_pk_fma_f32 v[138:139], v[138:139], v[216:217], v[216:217] op_sel:[0,0,0] op_sel_hi:[1,0,0]
    v_pk_fma_f32 v[140:141], v[140:141], v[216:217], v[216:217] op_sel:[0,1,1] op_sel_hi:[1,1,1]
    v_pk_fma_f32 v[142:143], v[142:143], v[216:217], v[216:217] op_sel:[0,1,1] op_sel_hi:[1,1,1]
    v_rcp_f32 v128, v128
    v_rcp_f32 v129, v129
    v_rcp_f32 v130, v130
    v_rcp_f32 v131, v131
    v_rcp_f32 v132, v132
    v_rcp_f32 v133, v133
    v_rcp_f32 v134, v134
    v_rcp_f32 v135, v135
    v_rcp_f32 v136, v136
    v_rcp_f32 v137, v137
    v_rcp_f32 v138, v138
    v_rcp_f32 v139, v139
    v_rcp_f32 v140, v140
    v_rcp_f32 v141, v141
    v_rcp_f32 v142, v142
    v_rcp_f32 v143, v143
    v_pk_mul_f32 v[112:113], v[128:129], v[112:113]
    v_pk_mul_f32 v[114:115], v[130:131], v[114:115]
    v_pk_mul_f32 v[116:117], v[132:133], v[116:117]
    v_pk_mul_f32 v[118:119], v[134:135], v[118:119]
    v_pk_mul_f32 v[120:121], v[136:137], v[120:121]
    v_pk_mul_f32 v[122:123], v[138:139], v[122:123]
    v_pk_mul_f32 v[124:125], v[140:141], v[124:125]
    v_pk_mul_f32 v[126:127], v[142:143], v[126:127]
    v_cvt_pk_bf16_f32 v64, v112, v113
    v_cvt_pk_bf16_f32 v65, v114, v115
    v_cvt_pk_bf16_f32 v66, v120, v121
    v_cvt_pk_bf16_f32 v67, v122, v123
    v_cvt_pk_bf16_f32 v68, v116, v117
    v_cvt_pk_bf16_f32 v69, v118, v119
    v_cvt_pk_bf16_f32 v70, v124, v125
    v_cvt_pk_bf16_f32 v71, v126, v127
    buffer_store_dwordx4 v[64:67], v1, s[24:27], s42 offen offset:0 sc1
    buffer_store_dwordx4 v[68:71], v1, s[24:27], s42 offen offset:1024 sc1
    s_add_u32 s42, s42, 65536
    s_waitcnt lgkmcnt(3)
    v_mfma_f32_16x16x32_bf16 v[192:195], v[80:83], v[16:19], 0
    ds_read_b128 v[100:103], v6 offset:5120
    v_mfma_f32_16x16x32_bf16 v[196:199], v[80:83], v[20:23], 0
    s_add_u32 s49, s49, 28672
    v_mfma_f32_16x16x32_bf16 v[204:207], v[84:87], v[20:23], 0
    ds_read_b128 v[104:107], v6 offset:6144
    v_mfma_f32_16x16x32_bf16 v[200:203], v[84:87], v[16:19], 0
    s_waitcnt lgkmcnt(3)
    v_mfma_f32_16x16x32_bf16 v[208:211], v[88:91], v[16:19], 0
    ds_read_b128 v[108:111], v6 offset:7168
    v_mfma_f32_16x16x32_bf16 v[212:215], v[88:91], v[20:23], 0
    s_cmp_eq_u32 s49, 143360
    s_cselect_b32 s52, s56, s57
    v_mfma_f32_16x16x32_bf16 v[220:223], v[92:95], v[20:23], 0
    ds_read_b128 v[80:83], v6 offset:8192
    v_mfma_f32_16x16x32_bf16 v[216:219], v[92:95], v[16:19], 0
    s_waitcnt lgkmcnt(3)
    v_mfma_f32_16x16x32_bf16 v[224:227], v[96:99], v[16:19], v[224:227]
    ds_read_b128 v[84:87], v6 offset:9216
    v_mfma_f32_16x16x32_bf16 v[228:231], v[96:99], v[20:23], v[228:231]
    s_cselect_b32 s49, 0, s49
    v_mfma_f32_16x16x32_bf16 v[236:239], v[100:103], v[20:23], v[236:239]
    ds_read_b128 v[88:91], v6 offset:10240
    v_mfma_f32_16x16x32_bf16 v[232:235], v[100:103], v[16:19], v[232:235]
    s_waitcnt lgkmcnt(3)
    v_mfma_f32_16x16x32_bf16 v[240:243], v[104:107], v[16:19], v[240:243]
    ds_read_b128 v[92:95], v6 offset:11264
    v_mfma_f32_16x16x32_bf16 v[244:247], v[104:107], v[20:23], v[244:247]
    v_mfma_f32_16x16x32_bf16 v[252:255], v[108:111], v[20:23], v[252:255]
    ds_read_b128 v[96:99], v6 offset:12288
    v_mfma_f32_16x16x32_bf16 v[248:251], v[108:111], v[16:19], v[248:251]
    s_waitcnt lgkmcnt(3)
    v_mfma_f32_16x16x32_bf16 v[192:195], v[80:83], v[24:27], v[192:195]
    ds_read_b128 v[100:103], v6 offset:13312
    v_mfma_f32_16x16x32_bf16 v[196:199], v[80:83], v[28:31], v[196:199]
    v_mfma_f32_16x16x32_bf16 v[204:207], v[84:87], v[28:31], v[204:207]
    ds_read_b128 v[104:107], v6 offset:14336
    v_mfma_f32_16x16x32_bf16 v[200:203], v[84:87], v[24:27], v[200:203]
    s_waitcnt lgkmcnt(3)
    v_mfma_f32_16x16x32_bf16 v[208:211], v[88:91], v[24:27], v[208:211]
    ds_read_b128 v[108:111], v6 offset:15360
    v_mfma_f32_16x16x32_bf16 v[212:215], v[88:91], v[28:31], v[212:215]
    v_mfma_f32_16x16x32_bf16 v[220:223], v[92:95], v[28:31], v[220:223]
    ds_read_b128 v[80:83], v6 offset:16384
    v_mfma_f32_16x16x32_bf16 v[216:219], v[92:95], v[24:27], v[216:219]
    s_waitcnt lgkmcnt(3)
    v_mfma_f32_16x16x32_bf16 v[224:227], v[96:99], v[24:27], v[224:227]
    ds_read_b128 v[84:87], v6 offset:17408
    v_mfma_f32_16x16x32_bf16 v[228:231], v[96:99], v[28:31], v[228:231]
    v_mfma_f32_16x16x32_bf16 v[236:239], v[100:103], v[28:31], v[236:239]
    ds_read_b128 v[88:91], v6 offset:18432
    v_mfma_f32_16x16x32_bf16 v[232:235], v[100:103], v[24:27], v[232:235]
    s_waitcnt lgkmcnt(3)
    v_mfma_f32_16x16x32_bf16 v[240:243], v[104:107], v[24:27], v[240:243]
    ds_read_b128 v[92:95], v6 offset:19456
    v_mfma_f32_16x16x32_bf16 v[244:247], v[104:107], v[28:31], v[244:247]
    v_mfma_f32_16x16x32_bf16 v[252:255], v[108:111], v[28:31], v[252:255]
    ds_read_b128 v[96:99], v6 offset:20480
    v_mfma_f32_16x16x32_bf16 v[248:251], v[108:111], v[24:27], v[248:251]
    s_waitcnt lgkmcnt(3)
    v_mfma_f32_16x16x32_bf16 v[192:195], v[80:83], v[32:35], v[192:195]
    ds_read_b128 v[100:103], v6 offset:21504
    v_mfma_f32_16x16x32_bf16 v[196:199], v[80:83], v[36:39], v[196:199]
    v_mfma_f32_16x16x32_bf16 v[204:207], v[84:87], v[36:39], v[204:207]
    ds_read_b128 v[104:107], v6 offset:22528
    v_mfma_f32_16x16x32_bf16 v[200:203], v[84:87], v[32:35], v[200:203]
    s_waitcnt lgkmcnt(3)
    v_mfma_f32_16x16x32_bf16 v[208:211], v[88:91], v[32:35], v[208:211]
    ds_read_b128 v[108:111], v6 offset:23552
    v_mfma_f32_16x16x32_bf16 v[212:215], v[88:91], v[36:39], v[212:215]
    v_mfma_f32_16x16x32_bf16 v[220:223], v[92:95], v[36:39], v[220:223]
    ds_read_b128 v[80:83], v6 offset:24576
    v_mfma_f32_16x16x32_bf16 v[216:219], v[92:95], v[32:35], v[216:219]
    s_waitcnt lgkmcnt(3)
    v_mfma_f32_16x16x32_bf16 v[224:227], v[96:99], v[32:35], v[224:227]
    ds_read_b128 v[84:87], v6 offset:25600
    v_mfma_f32_16x16x32_bf16 v[228:231], v[96:99], v[36:39], v[228:231]
    v_mfma_f32_16x16x32_bf16 v[236:239], v[100:103], v[36:39], v[236:239]
    ds_read_b128 v[88:91], v6 offset:26624
    v_mfma_f32_16x16x32_bf16 v[232:235], v[100:103], v[32:35], v[232:235]
    s_waitcnt lgkmcnt(3)
    v_mfma_f32_16x16x32_bf16 v[240:243], v[104:107], v[32:35], v[240:243]
    ds_read_b128 v[92:95], v6 offset:27648
    v_mfma_f32_16x16x32_bf16 v[244:247], v[104:107], v[36:39], v[244:247]
    v_add_u32 v6, s52, v6
    s_barrier
    v_mfma_f32_16x16x32_bf16 v[252:255], v[108:111], v[36:39], v[252:255]
    ds_read_b128 v[96:99], v6 offset:0
    v_mfma_f32_16x16x32_bf16 v[248:251], v[108:111], v[32:35], v[248:251]
    s_waitcnt vmcnt(0)
    s_mov_b64 exec, 1
    buffer_atomic_add v15, v2, s[24:27], s47 offen sc1
    s_mov_b64 exec, -1
    s_waitcnt lgkmcnt(3)
    v_mfma_f32_16x16x32_bf16 v[192:195], v[80:83], v[40:43], v[192:195]
    ds_read_b128 v[100:103], v6 offset:1024
    v_mfma_f32_16x16x32_bf16 v[196:199], v[80:83], v[44:47], v[196:199]
    buffer_load_dwordx4 v[16:19], v1, s[24:27], s50 offen offset:0 sc1
    v_mfma_f32_16x16x32_bf16 v[204:207], v[84:87], v[44:47], v[204:207]
    ds_read_b128 v[104:107], v6 offset:2048
    v_mfma_f32_16x16x32_bf16 v[200:203], v[84:87], v[40:43], v[200:203]
    buffer_load_dwordx4 v[20:23], v1, s[24:27], s50 offen offset:1024 sc1
    s_waitcnt lgkmcnt(3)
    v_mfma_f32_16x16x32_bf16 v[208:211], v[88:91], v[40:43], v[208:211]
    ds_read_b128 v[108:111], v6 offset:3072
    v_mfma_f32_16x16x32_bf16 v[212:215], v[88:91], v[44:47], v[212:215]
    s_add_u32 s50, s50, s72
    v_mfma_f32_16x16x32_bf16 v[220:223], v[92:95], v[44:47], v[220:223]
    ds_read_b128 v[80:83], v6 offset:4096
    v_mfma_f32_16x16x32_bf16 v[216:219], v[92:95], v[40:43], v[216:219]
    buffer_load_dwordx4 v[24:27], v1, s[24:27], s50 offen offset:0 sc1
    s_waitcnt lgkmcnt(3)
    v_mfma_f32_16x16x32_bf16 v[224:227], v[96:99], v[40:43], v[224:227]
    ds_read_b128 v[84:87], v6 offset:5120
    v_mfma_f32_16x16x32_bf16 v[228:231], v[96:99], v[44:47], v[228:231]
    buffer_load_dwordx4 v[28:31], v1, s[24:27], s50 offen offset:1024 sc1
    v_mfma_f32_16x16x32_bf16 v[236:239], v[100:103], v[44:47], v[236:239]
    ds_read_b128 v[88:91], v6 offset:6144
    v_mfma_f32_16x16x32_bf16 v[232:235], v[100:103], v[40:43], v[232:235]
    s_add_u32 s50, s50, s73
    s_waitcnt lgkmcnt(3)
    v_mfma_f32_16x16x32_bf16 v[240:243], v[104:107], v[40:43], v[240:243]
    ds_read_b128 v[92:95], v6 offset:7168
    v_mfma_f32_16x16x32_bf16 v[244:247], v[104:107], v[44:47], v[244:247]
    buffer_load_dwordx4 v[32:35], v1, s[24:27], s50 offen offset:0 sc1
    v_mfma_f32_16x16x32_bf16 v[252:255], v[108:111], v[44:47], v[252:255]
    ds_read_b128 v[96:99], v6 offset:8192
    v_mfma_f32_16x16x32_bf16 v[248:251], v[108:111], v[40:43], v[248:251]
    buffer_load_dwordx4 v[36:39], v1, s[24:27], s50 offen offset:1024 sc1
    s_add_u32 s50, s50, s74
    s_waitcnt lgkmcnt(3)
    v_mfma_f32_16x16x32_bf16 v[192:195], v[80:83], v[48:51], v[192:195]
    ds_read_b128 v[100:103], v6 offset:9216
    v_mfma_f32_16x16x32_bf16 v[196:199], v[80:83], v[52:55], v[196:199]
    buffer_load_dwordx4 v[40:43], v1, s[24:27], s50 offen offset:0 sc1
    v_mfma_f32_16x16x32_bf16 v[204:207], v[84:87], v[52:55], v[204:207]
    ds_read_b128 v[104:107], v6 offset:10240
    v_mfma_f32_16x16x32_bf16 v[200:203], v[84:87], v[48:51], v[200:203]
    buffer_load_dwordx4 v[44:47], v1, s[24:27], s50 offen offset:1024 sc1
    s_waitcnt lgkmcnt(3)
    v_mfma_f32_16x16x32_bf16 v[208:211], v[88:91], v[48:51], v[208:211]
    ds_read_b128 v[108:111], v6 offset:11264
    v_mfma_f32_16x16x32_bf16 v[212:215], v[88:91], v[52:55], v[212:215]
    s_add_u32 s50, s50, s75
    v_mfma_f32_16x16x32_bf16 v[220:223], v[92:95], v[52:55], v[220:223]
    ds_read_b128 v[80:83], v6 offset:12288
    v_mfma_f32_16x16x32_bf16 v[216:219], v[92:95], v[48:51], v[216:219]
    s_add_u32 s49, s49, 28672
    s_waitcnt lgkmcnt(3)
    v_mfma_f32_16x16x32_bf16 v[224:227], v[96:99], v[48:51], v[224:227]
    ds_read_b128 v[84:87], v6 offset:13312
    v_mfma_f32_16x16x32_bf16 v[228:231], v[96:99], v[52:55], v[228:231]
    s_cmp_eq_u32 s49, 143360
    s_cselect_b32 s52, s56, s57
    v_mfma_f32_16x16x32_bf16 v[236:239], v[100:103], v[52:55], v[236:239]
    ds_read_b128 v[88:91], v6 offset:14336
    v_mfma_f32_16x16x32_bf16 v[232:235], v[100:103], v[48:51], v[232:235]
    s_waitcnt lgkmcnt(3)
    v_mfma_f32_16x16x32_bf16 v[240:243], v[104:107], v[48:51], v[240:243]
    ds_read_b128 v[92:95], v6 offset:15360
    v_mfma_f32_16x16x32_bf16 v[244:247], v[104:107], v[52:55], v[244:247]
    s_cselect_b32 s49, 0, s49
    v_mfma_f32_16x16x32_bf16 v[252:255], v[108:111], v[52:55], v[252:255]
    ds_read_b128 v[96:99], v6 offset:16384
    v_mfma_f32_16x16x32_bf16 v[248:251], v[108:111], v[48:51], v[248:251]
    s_waitcnt lgkmcnt(3)
    v_mfma_f32_16x16x32_bf16 v[192:195], v[80:83], v[56:59], v[192:195]
    ds_read_b128 v[100:103], v6 offset:17408
    v_mfma_f32_16x16x32_bf16 v[196:199], v[80:83], v[60:63], v[196:199]
    buffer_load_dwordx4 v[48:51], v1, s[24:27], s50 offen offset:0 sc1
    v_mfma_f32_16x16x32_bf16 v[204:207], v[84:87], v[60:63], v[204:207]
    ds_read_b128 v[104:107], v6 offset:18432
    v_mfma_f32_16x16x32_bf16 v[200:203], v[84:87], v[56:59], v[200:203]
    s_waitcnt lgkmcnt(3)
    v_mfma_f32_16x16x32_bf16 v[208:211], v[88:91], v[56:59], v[208:211]
    ds_read_b128 v[108:111], v6 offset:19456
    v_mfma_f32_16x16x32_bf16 v[212:215], v[88:91], v[60:63], v[212:215]
    buffer_load_dwordx4 v[52:55], v1, s[24:27], s50 offen offset:1024 sc1
    v_mfma_f32_16x16x32_bf16 v[220:223], v[92:95], v[60:63], v[220:223]
    ds_read_b128 v[80:83], v6 offset:20480
    v_mfma_f32_16x16x32_bf16 v[216:219], v[92:95], v[56:59], v[216:219]
    s_waitcnt lgkmcnt(3)
    v_mfma_f32_16x16x32_bf16 v[224:227], v[96:99], v[56:59], v[224:227]
    ds_read_b128 v[84:87], v6 offset:21504
    v_mfma_f32_16x16x32_bf16 v[228:231], v[96:99], v[60:63], v[228:231]
    s_add_u32 s50, s50, s76
    v_mfma_f32_16x16x32_bf16 v[236:239], v[100:103], v[60:63], v[236:239]
    ds_read_b128 v[88:91], v6 offset:22528
    v_mfma_f32_16x16x32_bf16 v[232:235], v[100:103], v[56:59], v[232:235]
    s_waitcnt lgkmcnt(3)
    v_mfma_f32_16x16x32_bf16 v[240:243], v[104:107], v[56:59], v[240:243]
    ds_read_b128 v[92:95], v6 offset:23552
    v_mfma_f32_16x16x32_bf16 v[244:247], v[104:107], v[60:63], v[244:247]
    v_mfma_f32_16x16x32_bf16 v[252:255], v[108:111], v[60:63], v[252:255]
    ds_read_b128 v[96:99], v6 offset:24576
    v_mfma_f32_16x16x32_bf16 v[248:251], v[108:111], v[56:59], v[248:251]
    s_waitcnt lgkmcnt(3)
    v_mfma_f32_16x16x32_bf16 v[192:195], v[80:83], v[64:67], v[192:195]
    ds_read_b128 v[100:103], v6 offset:25600
    v_mfma_f32_16x16x32_bf16 v[196:199], v[80:83], v[68:71], v[196:199]
    buffer_load_dwordx4 v[56:59], v1, s[24:27], s50 offen offset:0 sc1
    v_mfma_f32_16x16x32_bf16 v[204:207], v[84:87], v[68:71], v[204:207]
    ds_read_b128 v[104:107], v6 offset:26624
    v_mfma_f32_16x16x32_bf16 v[200:203], v[84:87], v[64:67], v[200:203]
    s_waitcnt lgkmcnt(3)
    v_mfma_f32_16x16x32_bf16 v[208:211], v[88:91], v[64:67], v[208:211]
    ds_read_b128 v[108:111], v6 offset:27648
    v_mfma_f32_16x16x32_bf16 v[212:215], v[88:91], v[68:71], v[212:215]
    buffer_load_dwordx4 v[60:63], v1, s[24:27], s50 offen offset:1024 sc1
    v_add_u32 v6, s52, v6
    s_barrier
    v_mfma_f32_16x16x32_bf16 v[220:223], v[92:95], v[68:71], v[220:223]
    ds_read_b128 v[80:83], v6 offset:0
    v_mfma_f32_16x16x32_bf16 v[216:219], v[92:95], v[64:67], v[216:219]
    s_waitcnt lgkmcnt(3)
    v_mfma_f32_16x16x32_bf16 v[224:227], v[96:99], v[64:67], v[224:227]
    ds_read_b128 v[84:87], v6 offset:1024
    v_mfma_f32_16x16x32_bf16 v[228:231], v[96:99], v[68:71], v[228:231]
    s_add_u32 s50, s50, s77
    v_mfma_f32_16x16x32_bf16 v[236:239], v[100:103], v[68:71], v[236:239]
    ds_read_b128 v[88:91], v6 offset:2048
    v_mfma_f32_16x16x32_bf16 v[232:235], v[100:103], v[64:67], v[232:235]
    s_waitcnt lgkmcnt(3)
    v_mfma_f32_16x16x32_bf16 v[240:243], v[104:107], v[64:67], v[240:243]
    ds_read_b128 v[92:95], v6 offset:3072
    v_mfma_f32_16x16x32_bf16 v[244:247], v[104:107], v[68:71], v[244:247]
    v_mfma_f32_16x16x32_bf16 v[252:255], v[108:111], v[68:71], v[252:255]
    ds_read_b128 v[96:99], v6 offset:4096
    v_mfma_f32_16x16x32_bf16 v[248:251], v[108:111], v[64:67], v[248:251]
.p2align 3
.Lring_22:
    s_waitcnt vmcnt(10) lgkmcnt(3)
    v_mfma_f32_16x16x32_bf16 v[192:195], v[80:83], v[16:19], v[192:195]
    ds_read_b128 v[100:103], v6 offset:5120
    v_mfma_f32_16x16x32_bf16 v[196:199], v[80:83], v[20:23], v[196:199]
    buffer_load_dwordx4 v[64:67], v1, s[24:27], s50 offen offset:0 sc1
    v_mfma_f32_16x16x32_bf16 v[204:207], v[84:87], v[20:23], v[204:207]
    ds_read_b128 v[104:107], v6 offset:6144
    v_mfma_f32_16x16x32_bf16 v[200:203], v[84:87], v[16:19], v[200:203]
    buffer_load_dwordx4 v[68:71], v1, s[24:27], s50 offen offset:1024 sc1
    s_waitcnt lgkmcnt(3)
    v_mfma_f32_16x16x32_bf16 v[208:211], v[88:91], v[16:19], v[208:211]
    ds_read_b128 v[108:111], v6 offset:7168
    v_mfma_f32_16x16x32_bf16 v[212:215], v[88:91], v[20:23], v[212:215]
    s_add_u32 s50, s50, s78
    v_mfma_f32_16x16x32_bf16 v[220:223], v[92:95], v[20:23], v[220:223]
    ds_read_b128 v[80:83], v6 offset:8192
    v_mfma_f32_16x16x32_bf16 v[216:219], v[92:95], v[16:19], v[216:219]
    s_add_u32 s49, s49, 28672
    s_waitcnt lgkmcnt(3)
    v_mfma_f32_16x16x32_bf16 v[224:227], v[96:99], v[16:19], v[224:227]
    ds_read_b128 v[84:87], v6 offset:9216
    v_mfma_f32_16x16x32_bf16 v[228:231], v[96:99], v[20:23], v[228:231]
    s_cmp_eq_u32 s49, 143360
    s_cselect_b32 s52, s56, s57
    v_mfma_f32_16x16x32_bf16 v[236:239], v[100:103], v[20:23], v[236:239]
    ds_read_b128 v[88:91], v6 offset:10240
    v_mfma_f32_16x16x32_bf16 v[232:235], v[100:103], v[16:19], v[232:235]
    s_waitcnt lgkmcnt(3)
    v_mfma_f32_16x16x32_bf16 v[240:243], v[104:107], v[16:19], v[240:243]
    ds_read_b128 v[92:95], v6 offset:11264
    v_mfma_f32_16x16x32_bf16 v[244:247], v[104:107], v[20:23], v[244:247]
    s_cselect_b32 s49, 0, s49
    v_mfma_f32_16x16x32_bf16 v[252:255], v[108:111], v[20:23], v[252:255]
    ds_read_b128 v[96:99], v6 offset:12288
    v_mfma_f32_16x16x32_bf16 v[248:251], v[108:111], v[16:19], v[248:251]
    s_waitcnt vmcnt(10) lgkmcnt(3)
    v_mfma_f32_16x16x32_bf16 v[192:195], v[80:83], v[24:27], v[192:195]
    ds_read_b128 v[100:103], v6 offset:13312
    v_mfma_f32_16x16x32_bf16 v[196:199], v[80:83], v[28:31], v[196:199]
    buffer_load_dwordx4 v[16:19], v1, s[24:27], s50 offen offset:0 sc1
    v_mfma_f32_16x16x32_bf16 v[204:207], v[84:87], v[28:31], v[204:207]
    ds_read_b128 v[104:107], v6 offset:14336
    v_mfma_f32_16x16x32_bf16 v[200:203], v[84:87], v[24:27], v[200:203]
    s_waitcnt lgkmcnt(3)
    v_mfma_f32_16x16x32_bf16 v[208:211], v[88:91], v[24:27], v[208:211]
    ds_read_b128 v[108:111], v6 offset:15360
    v_mfma_f32_16x16x32_bf16 v[212:215], v[88:91], v[28:31], v[212:215]
    buffer_load_dwordx4 v[20:23], v1, s[24:27], s50 offen offset:1024 sc1
    v_mfma_f32_16x16x32_bf16 v[220:223], v[92:95], v[28:31], v[220:223]
    ds_read_b128 v[80:83], v6 offset:16384
    v_mfma_f32_16x16x32_bf16 v[216:219], v[92:95], v[24:27], v[216:219]
    s_waitcnt lgkmcnt(3)
    v_mfma_f32_16x16x32_bf16 v[224:227], v[96:99], v[24:27], v[224:227]
    ds_read_b128 v[84:87], v6 offset:17408
    v_mfma_f32_16x16x32_bf16 v[228:231], v[96:99], v[28:31], v[228:231]
    s_add_u32 s50, s50, s72
    v_mfma_f32_16x16x32_bf16 v[236:239], v[100:103], v[28:31], v[236:239]
    ds_read_b128 v[88:91], v6 offset:18432
    v_mfma_f32_16x16x32_bf16 v[232:235], v[100:103], v[24:27], v[232:235]
    s_waitcnt lgkmcnt(3)
    v_mfma_f32_16x16x32_bf16 v[240:243], v[104:107], v[24:27], v[240:243]
    ds_read_b128 v[92:95], v6 offset:19456
    v_mfma_f32_16x16x32_bf16 v[244:247], v[104:107], v[28:31], v[244:247]
    v_mfma_f32_16x16x32_bf16 v[252:255], v[108:111], v[28:31], v[252:255]
    ds_read_b128 v[96:99], v6 offset:20480
    v_mfma_f32_16x16x32_bf16 v[248:251], v[108:111], v[24:27], v[248:251]
    s_waitcnt vmcnt(10) lgkmcnt(3)
    v_mfma_f32_16x16x32_bf16 v[192:195], v[80:83], v[32:35], v[192:195]
    ds_read_b128 v[100:103], v6 offset:21504
    v_mfma_f32_16x16x32_bf16 v[196:199], v[80:83], v[36:39], v[196:199]
    buffer_load_dwordx4 v[24:27], v1, s[24:27], s50 offen offset:0 sc1
    v_mfma_f32_16x16x32_bf16 v[204:207], v[84:87], v[36:39], v[204:207]
    ds_read_b128 v[104:107], v6 offset:22528
    v_mfma_f32_16x16x32_bf16 v[200:203], v[84:87], v[32:35], v[200:203]
    s_waitcnt lgkmcnt(3)
    v_mfma_f32_16x16x32_bf16 v[208:211], v[88:91], v[32:35], v[208:211]
    ds_read_b128 v[108:111], v6 offset:23552
    v_mfma_f32_16x16x32_bf16 v[212:215], v[88:91], v[36:39], v[212:215]
    buffer_load_dwordx4 v[28:31], v1, s[24:27], s50 offen offset:1024 sc1
    v_mfma_f32_16x16x32_bf16 v[220:223], v[92:95], v[36:39], v[220:223]
    ds_read_b128 v[80:83], v6 offset:24576
    v_mfma_f32_16x16x32_bf16 v[216:219], v[92:95], v[32:35], v[216:219]
    s_waitcnt lgkmcnt(3)
    v_mfma_f32_16x16x32_bf16 v[224:227], v[96:99], v[32:35], v[224:227]
    ds_read_b128 v[84:87], v6 offset:25600
    v_mfma_f32_16x16x32_bf16 v[228:231], v[96:99], v[36:39], v[228:231]
    s_add_u32 s50, s50, s73
    v_mfma_f32_16x16x32_bf16 v[236:239], v[100:103], v[36:39], v[236:239]
    ds_read_b128 v[88:91], v6 offset:26624
    v_mfma_f32_16x16x32_bf16 v[232:235], v[100:103], v[32:35], v[232:235]
    s_waitcnt lgkmcnt(3)
    v_mfma_f32_16x16x32_bf16 v[240:243], v[104:107], v[32:35], v[240:243]
    ds_read_b128 v[92:95], v6 offset:27648
    v_mfma_f32_16x16x32_bf16 v[244:247], v[104:107], v[36:39], v[244:247]
    v_add_u32 v6, s52, v6
    s_barrier
    v_mfma_f32_16x16x32_bf16 v[252:255], v[108:111], v[36:39], v[252:255]
    ds_read_b128 v[96:99], v6 offset:0
    v_mfma_f32_16x16x32_bf16 v[248:251], v[108:111], v[32:35], v[248:251]
    s_waitcnt vmcnt(10) lgkmcnt(3)
    v_mfma_f32_16x16x32_bf16 v[192:195], v[80:83], v[40:43], v[192:195]
    ds_read_b128 v[100:103], v6 offset:1024
    v_mfma_f32_16x16x32_bf16 v[196:199], v[80:83], v[44:47], v[196:199]
    buffer_load_dwordx4 v[32:35], v1, s[24:27], s50 offen offset:0 sc1
    v_mfma_f32_16x16x32_bf16 v[204:207], v[84:87], v[44:47], v[204:207]
    ds_read_b128 v[104:107], v6 offset:2048
    v_mfma_f32_16x16x32_bf16 v[200:203], v[84:87], v[40:43], v[200:203]
    s_waitcnt lgkmcnt(3)
    v_mfma_f32_16x16x32_bf16 v[208:211], v[88:91], v[40:43], v[208:211]
    ds_read_b128 v[108:111], v6 offset:3072
    v_mfma_f32_16x16x32_bf16 v[212:215], v[88:91], v[44:47], v[212:215]
    buffer_load_dwordx4 v[36:39], v1, s[24:27], s50 offen offset:1024 sc1
    v_mfma_f32_16x16x32_bf16 v[220:223], v[92:95], v[44:47], v[220:223]
    ds_read_b128 v[80:83], v6 offset:4096
    v_mfma_f32_16x16x32_bf16 v[216:219], v[92:95], v[40:43], v[216:219]
    s_waitcnt lgkmcnt(3)
    v_mfma_f32_16x16x32_bf16 v[224:227], v[96:99], v[40:43], v[224:227]
    ds_read_b128 v[84:87], v6 offset:5120
    v_mfma_f32_16x16x32_bf16 v[228:231], v[96:99], v[44:47], v[228:231]
    s_add_u32 s50, s50, s74
    v_mfma_f32_16x16x32_bf16 v[236:239], v[100:103], v[44:47], v[236:239]
    ds_read_b128 v[88:91], v6 offset:6144
    v_mfma_f32_16x16x32_bf16 v[232:235], v[100:103], v[40:43], v[232:235]
    s_waitcnt lgkmcnt(3)
    v_mfma_f32_16x16x32_bf16 v[240:243], v[104:107], v[40:43], v[240:243]
    ds_read_b128 v[92:95], v6 offset:7168
    v_mfma_f32_16x16x32_bf16 v[244:247], v[104:107], v[44:47], v[244:247]
    v_mfma_f32_16x16x32_bf16 v[252:255], v[108:111], v[44:47], v[252:255]
    ds_read_b128 v[96:99], v6 offset:8192
    v_mfma_f32_16x16x32_bf16 v[248:251], v[108:111], v[40:43], v[248:251]
    s_waitcnt vmcnt(10) lgkmcnt(3)
    v_mfma_f32_16x16x32_bf16 v[192:195], v[80:83], v[48:51], v[192:195]
    ds_read_b128 v[100:103], v6 offset:9216
    v_mfma_f32_16x16x32_bf16 v[196:199], v[80:83], v[52:55], v[196:199]
    buffer_load_dwordx4 v[40:43], v1, s[24:27], s50 offen offset:0 sc1
    v_mfma_f32_16x16x32_bf16 v[204:207], v[84:87], v[52:55], v[204:207]
    ds_read_b128 v[104:107], v6 offset:10240
    v_mfma_f32_16x16x32_bf16 v[200:203], v[84:87], v[48:51], v[200:203]
    buffer_load_dwordx4 v[44:47], v1, s[24:27], s50 offen offset:1024 sc1
    s_waitcnt lgkmcnt(3)
    v_mfma_f32_16x16x32_bf16 v[208:211], v[88:91], v[48:51], v[208:211]
    ds_read_b128 v[108:111], v6 offset:11264
    v_mfma_f32_16x16x32_bf16 v[212:215], v[88:91], v[52:55], v[212:215]
    s_add_u32 s50, s50, s75
    v_mfma_f32_16x16x32_bf16 v[220:223], v[92:95], v[52:55], v[220:223]
    ds_read_b128 v[80:83], v6 offset:12288
    v_mfma_f32_16x16x32_bf16 v[216:219], v[92:95], v[48:51], v[216:219]
    s_add_u32 s49, s49, 28672
    s_waitcnt lgkmcnt(3)
    v_mfma_f32_16x16x32_bf16 v[224:227], v[96:99], v[48:51], v[224:227]
    ds_read_b128 v[84:87], v6 offset:13312
    v_mfma_f32_16x16x32_bf16 v[228:231], v[96:99], v[52:55], v[228:231]
    s_cmp_eq_u32 s49, 143360
    s_cselect_b32 s52, s56, s57
    v_mfma_f32_16x16x32_bf16 v[236:239], v[100:103], v[52:55], v[236:239]
    ds_read_b128 v[88:91], v6 offset:14336
    v_mfma_f32_16x16x32_bf16 v[232:235], v[100:103], v[48:51], v[232:235]
    s_waitcnt lgkmcnt(3)
    v_mfma_f32_16x16x32_bf16 v[240:243], v[104:107], v[48:51], v[240:243]
    ds_read_b128 v[92:95], v6 offset:15360
    v_mfma_f32_16x16x32_bf16 v[244:247], v[104:107], v[52:55], v[244:247]
    s_cselect_b32 s49, 0, s49
    v_mfma_f32_16x16x32_bf16 v[252:255], v[108:111], v[52:55], v[252:255]
    ds_read_b128 v[96:99], v6 offset:16384
    v_mfma_f32_16x16x32_bf16 v[248:251], v[108:111], v[48:51], v[248:251]
    s_waitcnt vmcnt(10) lgkmcnt(3)
    v_mfma_f32_16x16x32_bf16 v[192:195], v[80:83], v[56:59], v[192:195]
    ds_read_b128 v[100:103], v6 offset:17408
    v_mfma_f32_16x16x32_bf16 v[196:199], v[80:83], v[60:63], v[196:199]
    buffer_load_dwordx4 v[48:51], v1, s[24:27], s50 offen offset:0 sc1
    v_mfma_f32_16x16x32_bf16 v[204:207], v[84:87], v[60:63], v[204:207]
    ds_read_b128 v[104:107], v6 offset:18432
    v_mfma_f32_16x16x32_bf16 v[200:203], v[84:87], v[56:59], v[200:203]
    s_waitcnt lgkmcnt(3)
    v_mfma_f32_16x16x32_bf16 v[208:211], v[88:91], v[56:59], v[208:211]
    ds_read_b128 v[108:111], v6 offset:19456
    v_mfma_f32_16x16x32_bf16 v[212:215], v[88:91], v[60:63], v[212:215]
    buffer_load_dwordx4 v[52:55], v1, s[24:27], s50 offen offset:1024 sc1
    v_mfma_f32_16x16x32_bf16 v[220:223], v[92:95], v[60:63], v[220:223]
    ds_read_b128 v[80:83], v6 offset:20480
    v_mfma_f32_16x16x32_bf16 v[216:219], v[92:95], v[56:59], v[216:219]
    s_waitcnt lgkmcnt(3)
    v_mfma_f32_16x16x32_bf16 v[224:227], v[96:99], v[56:59], v[224:227]
    ds_read_b128 v[84:87], v6 offset:21504
    v_mfma_f32_16x16x32_bf16 v[228:231], v[96:99], v[60:63], v[228:231]
    s_add_u32 s50, s50, s76
    v_mfma_f32_16x16x32_bf16 v[236:239], v[100:103], v[60:63], v[236:239]
    ds_read_b128 v[88:91], v6 offset:22528
    v_mfma_f32_16x16x32_bf16 v[232:235], v[100:103], v[56:59], v[232:235]
    s_waitcnt lgkmcnt(3)
    v_mfma_f32_16x16x32_bf16 v[240:243], v[104:107], v[56:59], v[240:243]
    ds_read_b128 v[92:95], v6 offset:23552
    v_mfma_f32_16x16x32_bf16 v[244:247], v[104:107], v[60:63], v[244:247]
    v_mfma_f32_16x16x32_bf16 v[252:255], v[108:111], v[60:63], v[252:255]
    ds_read_b128 v[96:99], v6 offset:24576
    v_mfma_f32_16x16x32_bf16 v[248:251], v[108:111], v[56:59], v[248:251]
    s_waitcnt vmcnt(10) lgkmcnt(3)
    v_mfma_f32_16x16x32_bf16 v[192:195], v[80:83], v[64:67], v[192:195]
    ds_read_b128 v[100:103], v6 offset:25600
    v_mfma_f32_16x16x32_bf16 v[196:199], v[80:83], v[68:71], v[196:199]
    buffer_load_dwordx4 v[56:59], v1, s[24:27], s50 offen offset:0 sc1
    v_mfma_f32_16x16x32_bf16 v[204:207], v[84:87], v[68:71], v[204:207]
    ds_read_b128 v[104:107], v6 offset:26624
    v_mfma_f32_16x16x32_bf16 v[200:203], v[84:87], v[64:67], v[200:203]
    s_waitcnt lgkmcnt(3)
    v_mfma_f32_16x16x32_bf16 v[208:211], v[88:91], v[64:67], v[208:211]
    ds_read_b128 v[108:111], v6 offset:27648
    v_mfma_f32_16x16x32_bf16 v[212:215], v[88:91], v[68:71], v[212:215]
    buffer_load_dwordx4 v[60:63], v1, s[24:27], s50 offen offset:1024 sc1
    v_add_u32 v6, s52, v6
    s_barrier
    v_mfma_f32_16x16x32_bf16 v[220:223], v[92:95], v[68:71], v[220:223]
    ds_read_b128 v[80:83], v6 offset:0
    v_mfma_f32_16x16x32_bf16 v[216:219], v[92:95], v[64:67], v[216:219]
    s_waitcnt lgkmcnt(3)
    v_mfma_f32_16x16x32_bf16 v[224:227], v[96:99], v[64:67], v[224:227]
    ds_read_b128 v[84:87], v6 offset:1024
    v_mfma_f32_16x16x32_bf16 v[228:231], v[96:99], v[68:71], v[228:231]
    s_add_u32 s50, s50, s77
    v_mfma_f32_16x16x32_bf16 v[236:239], v[100:103], v[68:71], v[236:239]
    ds_read_b128 v[88:91], v6 offset:2048
    v_mfma_f32_16x16x32_bf16 v[232:235], v[100:103], v[64:67], v[232:235]
    s_waitcnt lgkmcnt(3)
    v_mfma_f32_16x16x32_bf16 v[240:243], v[104:107], v[64:67], v[240:243]
    ds_read_b128 v[92:95], v6 offset:3072
    v_mfma_f32_16x16x32_bf16 v[244:247], v[104:107], v[68:71], v[244:247]
    s_sub_u32 s48, s48, 1
    s_cmp_lg_u32 s48, 0
    v_mfma_f32_16x16x32_bf16 v[252:255], v[108:111], v[68:71], v[252:255]
    ds_read_b128 v[96:99], v6 offset:4096
    v_mfma_f32_16x16x32_bf16 v[248:251], v[108:111], v[64:67], v[248:251]
    s_cbranch_scc1 .Lring_22
    s_waitcnt vmcnt(10) lgkmcnt(3)
    v_mfma_f32_16x16x32_bf16 v[192:195], v[80:83], v[16:19], v[192:195]
    ds_read_b128 v[100:103], v6 offset:5120
    v_mfma_f32_16x16x32_bf16 v[196:199], v[80:83], v[20:23], v[196:199]
    buffer_load_dwordx4 v[64:67], v1, s[24:27], s50 offen offset:0 sc1
    v_mfma_f32_16x16x32_bf16 v[204:207], v[84:87], v[20:23], v[204:207]
    ds_read_b128 v[104:107], v6 offset:6144
    v_mfma_f32_16x16x32_bf16 v[200:203], v[84:87], v[16:19], v[200:203]
    buffer_load_dwordx4 v[68:71], v1, s[24:27], s50 offen offset:1024 sc1
    s_waitcnt lgkmcnt(3)
    v_mfma_f32_16x16x32_bf16 v[208:211], v[88:91], v[16:19], v[208:211]
    ds_read_b128 v[108:111], v6 offset:7168
    v_mfma_f32_16x16x32_bf16 v[212:215], v[88:91], v[20:23], v[212:215]
    s_add_u32 s50, s50, s78
    v_mfma_f32_16x16x32_bf16 v[220:223], v[92:95], v[20:23], v[220:223]
    ds_read_b128 v[80:83], v6 offset:8192
    v_mfma_f32_16x16x32_bf16 v[216:219], v[92:95], v[16:19], v[216:219]
    s_waitcnt vmcnt(10) lgkmcnt(3)
    v_mfma_f32_16x16x32_bf16 v[192:195], v[96:99], v[24:27], v[192:195]
    ds_read_b128 v[84:87], v6 offset:9216
    v_mfma_f32_16x16x32_bf16 v[196:199], v[96:99], v[28:31], v[196:199]
    buffer_load_dwordx4 v[112:115], v1, s[24:27], s50 offen offset:0 sc1
    v_mfma_f32_16x16x32_bf16 v[204:207], v[100:103], v[28:31], v[204:207]
    ds_read_b128 v[88:91], v6 offset:10240
    v_mfma_f32_16x16x32_bf16 v[200:203], v[100:103], v[24:27], v[200:203]
    buffer_load_dwordx4 v[116:119], v1, s[24:27], s50 offen offset:1024 sc1
    s_waitcnt lgkmcnt(3)
    v_mfma_f32_16x16x32_bf16 v[208:211], v[104:107], v[24:27], v[208:211]
    ds_read_b128 v[92:95], v6 offset:11264
    v_mfma_f32_16x16x32_bf16 v[212:215], v[104:107], v[28:31], v[212:215]
    s_add_u32 s50, s50, s72
    v_mfma_f32_16x16x32_bf16 v[220:223], v[108:111], v[28:31], v[220:223]
    ds_read_b128 v[96:99], v6 offset:12288
    v_mfma_f32_16x16x32_bf16 v[216:219], v[108:111], v[24:27], v[216:219]
    s_waitcnt vmcnt(10) lgkmcnt(3)
    v_mfma_f32_16x16x32_bf16 v[192:195], v[80:83], v[32:35], v[192:195]
    ds_read_b128 v[100:103], v6 offset:13312
    v_mfma_f32_16x16x32_bf16 v[196:199], v[80:83], v[36:39], v[196:199]
    buffer_load_dwordx4 v[120:123], v1, s[24:27], s50 offen offset:0 sc1
    v_mfma_f32_16x16x32_bf16 v[204:207], v[84:87], v[36:39], v[204:207]
    ds_read_b128 v[104:107], v6 offset:14336
    v_mfma_f32_16x16x32_bf16 v[200:203], v[84:87], v[32:35], v[200:203]
    buffer_load_dwordx4 v[124:127], v1, s[24:27], s50 offen offset:1024 sc1
    s_waitcnt lgkmcnt(3)
    v_mfma_f32_16x16x32_bf16 v[208:211], v[88:91], v[32:35], v[208:211]
    ds_read_b128 v[108:111], v6 offset:15360
    v_mfma_f32_16x16x32_bf16 v[212:215], v[88:91], v[36:39], v[212:215]
    s_add_u32 s50, s50, s73
    v_mfma_f32_16x16x32_bf16 v[220:223], v[92:95], v[36:39], v[220:223]
    ds_read_b128 v[80:83], v6 offset:16384
    v_mfma_f32_16x16x32_bf16 v[216:219], v[92:95], v[32:35], v[216:219]
    s_waitcnt vmcnt(10) lgkmcnt(3)
    v_mfma_f32_16x16x32_bf16 v[192:195], v[96:99], v[40:43], v[192:195]
    ds_read_b128 v[84:87], v6 offset:17408
    v_mfma_f32_16x16x32_bf16 v[196:199], v[96:99], v[44:47], v[196:199]
    buffer_load_dwordx4 v[128:131], v1, s[24:27], s50 offen offset:0 sc1
    v_mfma_f32_16x16x32_bf16 v[204:207], v[100:103], v[44:47], v[204:207]
    ds_read_b128 v[88:91], v6 offset:18432
    v_mfma_f32_16x16x32_bf16 v[200:203], v[100:103], v[40:43], v[200:203]
    buffer_load_dwordx4 v[132:135], v1, s[24:27], s50 offen offset:1024 sc1
    s_waitcnt lgkmcnt(3)
    v_mfma_f32_16x16x32_bf16 v[208:211], v[104:107], v[40:43], v[208:211]
    ds_read_b128 v[92:95], v6 offset:19456
    v_mfma_f32_16x16x32_bf16 v[212:215], v[104:107], v[44:47], v[212:215]
    s_add_u32 s50, s50, s74
    v_mfma_f32_16x16x32_bf16 v[220:223], v[108:111], v[44:47], v[220:223]
    ds_read_b128 v[96:99], v6 offset:20480
    v_mfma_f32_16x16x32_bf16 v[216:219], v[108:111], v[40:43], v[216:219]
    s_waitcnt vmcnt(10) lgkmcnt(3)
    v_mfma_f32_16x16x32_bf16 v[192:195], v[80:83], v[48:51], v[192:195]
    ds_read_b128 v[100:103], v6 offset:21504
    v_mfma_f32_16x16x32_bf16 v[196:199], v[80:83], v[52:55], v[196:199]
    buffer_load_dwordx4 v[136:139], v1, s[24:27], s50 offen offset:0 sc1
    v_mfma_f32_16x16x32_bf16 v[204:207], v[84:87], v[52:55], v[204:207]
    ds_read_b128 v[104:107], v6 offset:22528
    v_mfma_f32_16x16x32_bf16 v[200:203], v[84:87], v[48:51], v[200:203]
    buffer_load_dwordx4 v[140:143], v1, s[24:27], s50 offen offset:1024 sc1
    s_waitcnt lgkmcnt(3)
    v_mfma_f32_16x16x32_bf16 v[208:211], v[88:91], v[48:51], v[208:211]
    ds_read_b128 v[108:111], v6 offset:23552
    v_mfma_f32_16x16x32_bf16 v[212:215], v[88:91], v[52:55], v[212:215]
    s_add_u32 s50, s50, s75
    v_mfma_f32_16x16x32_bf16 v[220:223], v[92:95], v[52:55], v[220:223]
    ds_read_b128 v[80:83], v6 offset:24576
    v_mfma_f32_16x16x32_bf16 v[216:219], v[92:95], v[48:51], v[216:219]
    s_add_u32 s49, s49, 28672
    s_cmp_eq_u32 s49, 143360
    s_cselect_b32 s52, s56, s57
    s_cselect_b32 s49, 0, s49
    s_waitcnt vmcnt(10) lgkmcnt(3)
    v_mfma_f32_16x16x32_bf16 v[192:195], v[96:99], v[56:59], v[192:195]
    ds_read_b128 v[84:87], v6 offset:25600
    v_mfma_f32_16x16x32_bf16 v[196:199], v[96:99], v[60:63], v[196:199]
    buffer_load_dwordx4 v[144:147], v1, s[24:27], s50 offen offset:0 sc1
    v_mfma_f32_16x16x32_bf16 v[204:207], v[100:103], v[60:63], v[204:207]
    ds_read_b128 v[88:91], v6 offset:26624
    v_mfma_f32_16x16x32_bf16 v[200:203], v[100:103], v[56:59], v[200:203]
    buffer_load_dwordx4 v[148:151], v1, s[24:27], s50 offen offset:1024 sc1
    s_waitcnt lgkmcnt(3)
    v_mfma_f32_16x16x32_bf16 v[208:211], v[104:107], v[56:59], v[208:211]
    ds_read_b128 v[92:95], v6 offset:27648
    v_mfma_f32_16x16x32_bf16 v[212:215], v[104:107], v[60:63], v[212:215]
    s_add_u32 s50, s50, s76
    v_add_u32 v6, s52, v6
    s_barrier
    v_mfma_f32_16x16x32_bf16 v[220:223], v[108:111], v[60:63], v[220:223]
    ds_read_b128 v[96:99], v6 offset:0
    v_mfma_f32_16x16x32_bf16 v[216:219], v[108:111], v[56:59], v[216:219]
    s_waitcnt vmcnt(10) lgkmcnt(3)
    v_mfma_f32_16x16x32_bf16 v[192:195], v[80:83], v[64:67], v[192:195]
    ds_read_b128 v[100:103], v6 offset:1024
    v_mfma_f32_16x16x32_bf16 v[196:199], v[80:83], v[68:71], v[196:199]
    buffer_load_dwordx4 v[152:155], v1, s[24:27], s50 offen offset:0 sc1
    v_mfma_f32_16x16x32_bf16 v[204:207], v[84:87], v[68:71], v[204:207]
    ds_read_b128 v[104:107], v6 offset:2048
    v_mfma_f32_16x16x32_bf16 v[200:203], v[84:87], v[64:67], v[200:203]
    buffer_load_dwordx4 v[156:159], v1, s[24:27], s50 offen offset:1024 sc1
    s_waitcnt lgkmcnt(3)
    v_mfma_f32_16x16x32_bf16 v[208:211], v[88:91], v[64:67], v[208:211]
    ds_read_b128 v[108:111], v6 offset:3072
    v_mfma_f32_16x16x32_bf16 v[212:215], v[88:91], v[68:71], v[212:215]
    s_add_u32 s50, s50, s77
    v_mfma_f32_16x16x32_bf16 v[220:223], v[92:95], v[68:71], v[220:223]
    ds_read_b128 v[80:83], v6 offset:4096
    v_mfma_f32_16x16x32_bf16 v[216:219], v[92:95], v[64:67], v[216:219]
    s_waitcnt vmcnt(10) lgkmcnt(3)
    v_mfma_f32_16x16x32_bf16 v[192:195], v[96:99], v[112:115], v[192:195]
    ds_read_b128 v[84:87], v6 offset:5120
    v_mfma_f32_16x16x32_bf16 v[196:199], v[96:99], v[116:119], v[196:199]
    buffer_load_dwordx4 v[160:163], v1, s[24:27], s50 offen offset:0 sc1
    v_mfma_f32_16x16x32_bf16 v[204:207], v[100:103], v[116:119], v[204:207]
    ds_read_b128 v[88:91], v6 offset:6144
    v_mfma_f32_16x16x32_bf16 v[200:203], v[100:103], v[112:115], v[200:203]
    buffer_load_dwordx4 v[164:167], v1, s[24:27], s50 offen offset:1024 sc1
    s_waitcnt lgkmcnt(3)
    v_mfma_f32_16x16x32_bf16 v[208:211], v[104:107], v[112:115], v[208:211]
    ds_read_b128 v[92:95], v6 offset:7168
    v_mfma_f32_16x16x32_bf16 v[212:215], v[104:107], v[116:119], v[212:215]
    s_add_u32 s50, s50, s78
    v_mfma_f32_16x16x32_bf16 v[220:223], v[108:111], v[116:119], v[220:223]
    ds_read_b128 v[96:99], v6 offset:8192
    v_mfma_f32_16x16x32_bf16 v[216:219], v[108:111], v[112:115], v[216:219]
    s_waitcnt vmcnt(10) lgkmcnt(3)
    v_mfma_f32_16x16x32_bf16 v[192:195], v[80:83], v[120:123], v[192:195]
    ds_read_b128 v[100:103], v6 offset:9216
    v_mfma_f32_16x16x32_bf16 v[196:199], v[80:83], v[124:127], v[196:199]
    v_mfma_f32_16x16x32_bf16 v[204:207], v[84:87], v[124:127], v[204:207]
    ds_read_b128 v[104:107], v6 offset:10240
    v_mfma_f32_16x16x32_bf16 v[200:203], v[84:87], v[120:123], v[200:203]
    s_waitcnt lgkmcnt(3)
    v_mfma_f32_16x16x32_bf16 v[208:211], v[88:91], v[120:123], v[208:211]
    ds_read_b128 v[108:111], v6 offset:11264
    v_mfma_f32_16x16x32_bf16 v[212:215], v[88:91], v[124:127], v[212:215]
    v_mfma_f32_16x16x32_bf16 v[220:223], v[92:95], v[124:127], v[220:223]
    ds_read_b128 v[80:83], v6 offset:12288
    v_mfma_f32_16x16x32_bf16 v[216:219], v[92:95], v[120:123], v[216:219]
    s_waitcnt vmcnt(8) lgkmcnt(3)
    v_mfma_f32_16x16x32_bf16 v[192:195], v[96:99], v[128:131], v[192:195]
    ds_read_b128 v[84:87], v6 offset:13312
    v_mfma_f32_16x16x32_bf16 v[196:199], v[96:99], v[132:135], v[196:199]
    v_mfma_f32_16x16x32_bf16 v[204:207], v[100:103], v[132:135], v[204:207]
    ds_read_b128 v[88:91], v6 offset:14336
    v_mfma_f32_16x16x32_bf16 v[200:203], v[100:103], v[128:131], v[200:203]
    s_waitcnt lgkmcnt(3)
    v_mfma_f32_16x16x32_bf16 v[208:211], v[104:107], v[128:131], v[208:211]
    ds_read_b128 v[92:95], v6 offset:15360
    v_mfma_f32_16x16x32_bf16 v[212:215], v[104:107], v[132:135], v[212:215]
    v_mfma_f32_16x16x32_bf16 v[220:223], v[108:111], v[132:135], v[220:223]
    ds_read_b128 v[96:99], v6 offset:16384
    v_mfma_f32_16x16x32_bf16 v[216:219], v[108:111], v[128:131], v[216:219]
    s_waitcnt vmcnt(6) lgkmcnt(3)
    v_mfma_f32_16x16x32_bf16 v[192:195], v[80:83], v[136:139], v[192:195]
    ds_read_b128 v[100:103], v6 offset:17408
    v_mfma_f32_16x16x32_bf16 v[196:199], v[80:83], v[140:143], v[196:199]
    v_mfma_f32_16x16x32_bf16 v[204:207], v[84:87], v[140:143], v[204:207]
    ds_read_b128 v[104:107], v6 offset:18432
    v_mfma_f32_16x16x32_bf16 v[200:203], v[84:87], v[136:139], v[200:203]
    s_waitcnt lgkmcnt(3)
    v_mfma_f32_16x16x32_bf16 v[208:211], v[88:91], v[136:139], v[208:211]
    ds_read_b128 v[108:111], v6 offset:19456
    v_mfma_f32_16x16x32_bf16 v[212:215], v[88:91], v[140:143], v[212:215]
    v_mfma_f32_16x16x32_bf16 v[220:223], v[92:95], v[140:143], v[220:223]
    ds_read_b128 v[80:83], v6 offset:20480
    v_mfma_f32_16x16x32_bf16 v[216:219], v[92:95], v[136:139], v[216:219]
    s_waitcnt vmcnt(4) lgkmcnt(3)
    v_mfma_f32_16x16x32_bf16 v[192:195], v[96:99], v[144:147], v[192:195]
    ds_read_b128 v[84:87], v6 offset:21504
    v_mfma_f32_16x16x32_bf16 v[196:199], v[96:99], v[148:151], v[196:199]
    s_add_u32 s49, s49, 28672
    v_mfma_f32_16x16x32_bf16 v[204:207], v[100:103], v[148:151], v[204:207]
    ds_read_b128 v[88:91], v6 offset:22528
    v_mfma_f32_16x16x32_bf16 v[200:203], v[100:103], v[144:147], v[200:203]
    s_cmp_eq_u32 s49, 143360
    s_cselect_b32 s52, s56, s57
    s_waitcnt lgkmcnt(3)
    v_mfma_f32_16x16x32_bf16 v[208:211], v[104:107], v[144:147], v[208:211]
    ds_read_b128 v[92:95], v6 offset:23552
    v_mfma_f32_16x16x32_bf16 v[212:215], v[104:107], v[148:151], v[212:215]
    s_cselect_b32 s49, 0, s49
    v_mfma_f32_16x16x32_bf16 v[220:223], v[108:111], v[148:151], v[220:223]
    ds_read_b128 v[96:99], v6 offset:24576
    v_mfma_f32_16x16x32_bf16 v[216:219], v[108:111], v[144:147], v[216:219]
    s_waitcnt vmcnt(2) lgkmcnt(3)
    v_mfma_f32_16x16x32_bf16 v[192:195], v[80:83], v[152:155], v[192:195]
    ds_read_b128 v[100:103], v6 offset:25600
    v_mfma_f32_16x16x32_bf16 v[196:199], v[80:83], v[156:159], v[196:199]
    v_mfma_f32_16x16x32_bf16 v[204:207], v[84:87], v[156:159], v[204:207]
    ds_read_b128 v[104:107], v6 offset:26624
    v_mfma_f32_16x16x32_bf16 v[200:203], v[84:87], v[152:155], v[200:203]
    s_waitcnt lgkmcnt(3)
    v_mfma_f32_16x16x32_bf16 v[208:211], v[88:91], v[152:155], v[208:211]
    ds_read_b128 v[108:111], v6 offset:27648
    v_mfma_f32_16x16x32_bf16 v[212:215], v[88:91], v[156:159], v[212:215]
    v_add_u32 v6, s52, v6
    s_barrier
    v_mfma_f32_16x16x32_bf16 v[220:223], v[92:95], v[156:159], v[220:223]
    ds_read_b128 v[80:83], v6 offset:0
    v_mfma_f32_16x16x32_bf16 v[216:219], v[92:95], v[152:155], v[216:219]
    s_waitcnt vmcnt(0) lgkmcnt(3)
    v_mfma_f32_16x16x32_bf16 v[192:195], v[96:99], v[160:163], v[192:195]
    ds_read_b128 v[84:87], v6 offset:1024
    v_mfma_f32_16x16x32_bf16 v[196:199], v[96:99], v[164:167], v[196:199]
    v_mfma_f32_16x16x32_bf16 v[204:207], v[100:103], v[164:167], v[204:207]
    ds_read_b128 v[88:91], v6 offset:2048
    v_mfma_f32_16x16x32_bf16 v[200:203], v[100:103], v[160:163], v[200:203]
    s_waitcnt lgkmcnt(3)
    v_mfma_f32_16x16x32_bf16 v[208:211], v[104:107], v[160:163], v[208:211]
    ds_read_b128 v[92:95], v6 offset:3072
    v_mfma_f32_16x16x32_bf16 v[212:215], v[104:107], v[164:167], v[212:215]
    v_mfma_f32_16x16x32_bf16 v[220:223], v[108:111], v[164:167], v[220:223]
    ds_read_b128 v[96:99], v6 offset:4096
    v_mfma_f32_16x16x32_bf16 v[216:219], v[108:111], v[160:163], v[216:219]
    s_waitcnt lgkmcnt(3)
    v_mfma_f32_16x16x32_bf16 v[224:227], v[80:83], v[16:19], v[224:227]
    ds_read_b128 v[100:103], v6 offset:5120
    v_mfma_f32_16x16x32_bf16 v[228:231], v[80:83], v[20:23], v[228:231]
    v_mfma_f32_16x16x32_bf16 v[236:239], v[84:87], v[20:23], v[236:239]
    ds_read_b128 v[104:107], v6 offset:6144
    v_mfma_f32_16x16x32_bf16 v[232:235], v[84:87], v[16:19], v[232:235]
    s_waitcnt lgkmcnt(3)
    v_mfma_f32_16x16x32_bf16 v[240:243], v[88:91], v[16:19], v[240:243]
    ds_read_b128 v[108:111], v6 offset:7168
    v_mfma_f32_16x16x32_bf16 v[244:247], v[88:91], v[20:23], v[244:247]
    v_mfma_f32_16x16x32_bf16 v[252:255], v[92:95], v[20:23], v[252:255]
    ds_read_b128 v[80:83], v6 offset:8192
    v_mfma_f32_16x16x32_bf16 v[248:251], v[92:95], v[16:19], v[248:251]
    s_waitcnt lgkmcnt(3)
    v_mfma_f32_16x16x32_bf16 v[224:227], v[96:99], v[24:27], v[224:227]
    ds_read_b128 v[84:87], v6 offset:9216
    v_mfma_f32_16x16x32_bf16 v[228:231], v[96:99], v[28:31], v[228:231]
    v_cvt_pk_bf16_f32 v168, v192, v193
    v_cvt_pk_bf16_f32 v169, v194, v195
    v_mfma_f32_16x16x32_bf16 v[236:239], v[100:103], v[28:31], v[236:239]
    ds_read_b128 v[88:91], v6 offset:10240
    v_mfma_f32_16x16x32_bf16 v[232:235], v[100:103], v[24:27], v[232:235]
    v_cvt_pk_bf16_f32 v170, v200, v201
    v_cvt_pk_bf16_f32 v171, v202, v203
    s_waitcnt lgkmcnt(3)
    v_mfma_f32_16x16x32_bf16 v[240:243], v[104:107], v[24:27], v[240:243]
    ds_read_b128 v[92:95], v6 offset:11264
    v_mfma_f32_16x16x32_bf16 v[244:247], v[104:107], v[28:31], v[244:247]
    v_cvt_pk_bf16_f32 v172, v196, v197
    v_cvt_pk_bf16_f32 v173, v198, v199
    v_mfma_f32_16x16x32_bf16 v[252:255], v[108:111], v[28:31], v[252:255]
    ds_read_b128 v[96:99], v6 offset:12288
    v_mfma_f32_16x16x32_bf16 v[248:251], v[108:111], v[24:27], v[248:251]
    v_cvt_pk_bf16_f32 v174, v204, v205
    v_cvt_pk_bf16_f32 v175, v206, v207
    s_waitcnt lgkmcnt(3)
    v_mfma_f32_16x16x32_bf16 v[224:227], v[80:83], v[32:35], v[224:227]
    ds_read_b128 v[100:103], v6 offset:13312
    v_mfma_f32_16x16x32_bf16 v[228:231], v[80:83], v[36:39], v[228:231]
    buffer_store_dwordx4 v[168:171], v1, s[24:27], s8 offen offset:0 sc1
    buffer_store_dwordx4 v[172:175], v1, s[24:27], s8 offen offset:1024 sc1
    v_mfma_f32_16x16x32_bf16 v[236:239], v[84:87], v[36:39], v[236:239]
    ds_read_b128 v[104:107], v6 offset:14336
    v_mfma_f32_16x16x32_bf16 v[232:235], v[84:87], v[32:35], v[232:235]
    v_cvt_pk_bf16_f32 v176, v208, v209
    v_cvt_pk_bf16_f32 v177, v210, v211
    s_waitcnt lgkmcnt(3)
    v_mfma_f32_16x16x32_bf16 v[240:243], v[88:91], v[32:35], v[240:243]
    ds_read_b128 v[108:111], v6 offset:15360
    v_mfma_f32_16x16x32_bf16 v[244:247], v[88:91], v[36:39], v[244:247]
    v_cvt_pk_bf16_f32 v178, v216, v217
    v_cvt_pk_bf16_f32 v179, v218, v219
    v_mfma_f32_16x16x32_bf16 v[252:255], v[92:95], v[36:39], v[252:255]
    ds_read_b128 v[80:83], v6 offset:16384
    v_mfma_f32_16x16x32_bf16 v[248:251], v[92:95], v[32:35], v[248:251]
    v_cvt_pk_bf16_f32 v180, v212, v213
    v_cvt_pk_bf16_f32 v181, v214, v215
    s_waitcnt lgkmcnt(3)
    v_mfma_f32_16x16x32_bf16 v[224:227], v[96:99], v[40:43], v[224:227]
    ds_read_b128 v[84:87], v6 offset:17408
    v_mfma_f32_16x16x32_bf16 v[228:231], v[96:99], v[44:47], v[228:231]
    v_cvt_pk_bf16_f32 v182, v220, v221
    v_cvt_pk_bf16_f32 v183, v222, v223
    v_mfma_f32_16x16x32_bf16 v[236:239], v[100:103], v[44:47], v[236:239]
    ds_read_b128 v[88:91], v6 offset:18432
    v_mfma_f32_16x16x32_bf16 v[232:235], v[100:103], v[40:43], v[232:235]
    buffer_store_dwordx4 v[176:179], v1, s[24:27], s8 offen offset:2048 sc1
    buffer_store_dwordx4 v[180:183], v1, s[24:27], s8 offen offset:3072 sc1
    s_waitcnt lgkmcnt(3)
    v_mfma_f32_16x16x32_bf16 v[240:243], v[104:107], v[40:43], v[240:243]
    ds_read_b128 v[92:95], v6 offset:19456
    v_mfma_f32_16x16x32_bf16 v[244:247], v[104:107], v[44:47], v[244:247]
    v_mfma_f32_16x16x32_bf16 v[252:255], v[108:111], v[44:47], v[252:255]
    ds_read_b128 v[96:99], v6 offset:20480
    v_mfma_f32_16x16x32_bf16 v[248:251], v[108:111], v[40:43], v[248:251]
    s_waitcnt lgkmcnt(3)
    v_mfma_f32_16x16x32_bf16 v[224:227], v[80:83], v[48:51], v[224:227]
    ds_read_b128 v[100:103], v6 offset:21504
    v_mfma_f32_16x16x32_bf16 v[228:231], v[80:83], v[52:55], v[228:231]
    s_add_u32 s49, s49, 28672
    v_mfma_f32_16x16x32_bf16 v[236:239], v[84:87], v[52:55], v[236:239]
    ds_read_b128 v[104:107], v6 offset:22528
    v_mfma_f32_16x16x32_bf16 v[232:235], v[84:87], v[48:51], v[232:235]
    s_cmp_eq_u32 s49, 143360
    s_cselect_b32 s52, s56, s57
    s_waitcnt lgkmcnt(3)
    v_mfma_f32_16x16x32_bf16 v[240:243], v[88:91], v[48:51], v[240:243]
    ds_read_b128 v[108:111], v6 offset:23552
    v_mfma_f32_16x16x32_bf16 v[244:247], v[88:91], v[52:55], v[244:247]
    s_cselect_b32 s49, 0, s49
    v_mfma_f32_16x16x32_bf16 v[252:255], v[92:95], v[52:55], v[252:255]
    ds_read_b128 v[80:83], v6 offset:24576
    v_mfma_f32_16x16x32_bf16 v[248:251], v[92:95], v[48:51], v[248:251]
    s_waitcnt lgkmcnt(3)
    v_mfma_f32_16x16x32_bf16 v[224:227], v[96:99], v[56:59], v[224:227]
    ds_read_b128 v[84:87], v6 offset:25600
    v_mfma_f32_16x16x32_bf16 v[228:231], v[96:99], v[60:63], v[228:231]
    v_mfma_f32_16x16x32_bf16 v[236:239], v[100:103], v[60:63], v[236:239]
    ds_read_b128 v[88:91], v6 offset:26624
    v_mfma_f32_16x16x32_bf16 v[232:235], v[100:103], v[56:59], v[232:235]
    s_waitcnt lgkmcnt(3)
    v_mfma_f32_16x16x32_bf16 v[240:243], v[104:107], v[56:59], v[240:243]
    ds_read_b128 v[92:95], v6 offset:27648
    v_mfma_f32_16x16x32_bf16 v[244:247], v[104:107], v[60:63], v[244:247]
    v_add_u32 v6, s52, v6
    s_barrier
    v_mfma_f32_16x16x32_bf16 v[252:255], v[108:111], v[60:63], v[252:255]
    ds_read_b128 v[96:99], v6 offset:0
    v_mfma_f32_16x16x32_bf16 v[248:251], v[108:111], v[56:59], v[248:251]
    s_waitcnt lgkmcnt(3)
    v_mfma_f32_16x16x32_bf16 v[224:227], v[80:83], v[64:67], v[224:227]
    ds_read_b128 v[100:103], v6 offset:1024
    v_mfma_f32_16x16x32_bf16 v[228:231], v[80:83], v[68:71], v[228:231]
    v_mfma_f32_16x16x32_bf16 v[236:239], v[84:87], v[68:71], v[236:239]
    ds_read_b128 v[104:107], v6 offset:2048
    v_mfma_f32_16x16x32_bf16 v[232:235], v[84:87], v[64:67], v[232:235]
    s_waitcnt lgkmcnt(3)
    v_mfma_f32_16x16x32_bf16 v[240:243], v[88:91], v[64:67], v[240:243]
    ds_read_b128 v[108:111], v6 offset:3072
    v_mfma_f32_16x16x32_bf16 v[244:247], v[88:91], v[68:71], v[244:247]
    v_mfma_f32_16x16x32_bf16 v[252:255], v[92:95], v[68:71], v[252:255]
    ds_read_b128 v[80:83], v6 offset:4096
    v_mfma_f32_16x16x32_bf16 v[248:251], v[92:95], v[64:67], v[248:251]
    s_add_u32 s47, s12, 0x104000
    v_mov_b32 v15, 1
    s_waitcnt vmcnt(0)
    s_mov_b64 exec, 1
    buffer_atomic_add v15, v2, s[24:27], s47 offen sc0 sc1
    s_mov_b64 exec, -1
    s_waitcnt lgkmcnt(3)
    v_mfma_f32_16x16x32_bf16 v[224:227], v[96:99], v[112:115], v[224:227]
    ds_read_b128 v[84:87], v6 offset:5120
    v_mfma_f32_16x16x32_bf16 v[228:231], v[96:99], v[116:119], v[228:231]
    v_mfma_f32_16x16x32_bf16 v[236:239], v[100:103], v[116:119], v[236:239]
    ds_read_b128 v[88:91], v6 offset:6144
    v_mfma_f32_16x16x32_bf16 v[232:235], v[100:103], v[112:115], v[232:235]
    s_waitcnt lgkmcnt(3)
    v_mfma_f32_16x16x32_bf16 v[240:243], v[104:107], v[112:115], v[240:243]
    ds_read_b128 v[92:95], v6 offset:7168
    v_mfma_f32_16x16x32_bf16 v[244:247], v[104:107], v[116:119], v[244:247]
    v_mfma_f32_16x16x32_bf16 v[252:255], v[108:111], v[116:119], v[252:255]
    ds_read_b128 v[96:99], v6 offset:8192
    v_mfma_f32_16x16x32_bf16 v[248:251], v[108:111], v[112:115], v[248:251]
    s_waitcnt lgkmcnt(3)
    v_mfma_f32_16x16x32_bf16 v[224:227], v[80:83], v[120:123], v[224:227]
    ds_read_b128 v[100:103], v6 offset:9216
    v_mfma_f32_16x16x32_bf16 v[228:231], v[80:83], v[124:127], v[228:231]
    v_mfma_f32_16x16x32_bf16 v[236:239], v[84:87], v[124:127], v[236:239]
    ds_read_b128 v[104:107], v6 offset:10240
    v_mfma_f32_16x16x32_bf16 v[232:235], v[84:87], v[120:123], v[232:235]
    s_waitcnt lgkmcnt(3)
    v_mfma_f32_16x16x32_bf16 v[240:243], v[88:91], v[120:123], v[240:243]
    ds_read_b128 v[108:111], v6 offset:11264
    v_mfma_f32_16x16x32_bf16 v[244:247], v[88:91], v[124:127], v[244:247]
    v_mfma_f32_16x16x32_bf16 v[252:255], v[92:95], v[124:127], v[252:255]
    ds_read_b128 v[80:83], v6 offset:12288
    v_mfma_f32_16x16x32_bf16 v[248:251], v[92:95], v[120:123], v[248:251]
    s_waitcnt lgkmcnt(3)
    v_mfma_f32_16x16x32_bf16 v[224:227], v[96:99], v[128:131], v[224:227]
    ds_read_b128 v[84:87], v6 offset:13312
    v_mfma_f32_16x16x32_bf16 v[228:231], v[96:99], v[132:135], v[228:231]
    v_mfma_f32_16x16x32_bf16 v[236:239], v[100:103], v[132:135], v[236:239]
    ds_read_b128 v[88:91], v6 offset:14336
    v_mfma_f32_16x16x32_bf16 v[232:235], v[100:103], v[128:131], v[232:235]
    s_waitcnt lgkmcnt(3)
    v_mfma_f32_16x16x32_bf16 v[240:243], v[104:107], v[128:131], v[240:243]
    ds_read_b128 v[92:95], v6 offset:15360
    v_mfma_f32_16x16x32_bf16 v[244:247], v[104:107], v[132:135], v[244:247]
    v_mfma_f32_16x16x32_bf16 v[252:255], v[108:111], v[132:135], v[252:255]
    ds_read_b128 v[96:99], v6 offset:16384
    v_mfma_f32_16x16x32_bf16 v[248:251], v[108:111], v[128:131], v[248:251]
    s_waitcnt lgkmcnt(3)
    v_mfma_f32_16x16x32_bf16 v[224:227], v[80:83], v[136:139], v[224:227]
    ds_read_b128 v[100:103], v6 offset:17408
    v_mfma_f32_16x16x32_bf16 v[228:231], v[80:83], v[140:143], v[228:231]
    v_mfma_f32_16x16x32_bf16 v[236:239], v[84:87], v[140:143], v[236:239]
    ds_read_b128 v[104:107], v6 offset:18432
    v_mfma_f32_16x16x32_bf16 v[232:235], v[84:87], v[136:139], v[232:235]
    s_waitcnt lgkmcnt(3)
    v_mfma_f32_16x16x32_bf16 v[240:243], v[88:91], v[136:139], v[240:243]
    ds_read_b128 v[108:111], v6 offset:19456
    v_mfma_f32_16x16x32_bf16 v[244:247], v[88:91], v[140:143], v[244:247]
    v_mfma_f32_16x16x32_bf16 v[252:255], v[92:95], v[140:143], v[252:255]
    ds_read_b128 v[80:83], v6 offset:20480
    v_mfma_f32_16x16x32_bf16 v[248:251], v[92:95], v[136:139], v[248:251]
    s_waitcnt lgkmcnt(3)
    v_mfma_f32_16x16x32_bf16 v[224:227], v[96:99], v[144:147], v[224:227]
    ds_read_b128 v[84:87], v6 offset:21504
    v_mfma_f32_16x16x32_bf16 v[228:231], v[96:99], v[148:151], v[228:231]
    v_mfma_f32_16x16x32_bf16 v[236:239], v[100:103], v[148:151], v[236:239]
    ds_read_b128 v[88:91], v6 offset:22528
    v_mfma_f32_16x16x32_bf16 v[232:235], v[100:103], v[144:147], v[232:235]
    s_waitcnt lgkmcnt(3)
    v_mfma_f32_16x16x32_bf16 v[240:243], v[104:107], v[144:147], v[240:243]
    ds_read_b128 v[92:95], v6 offset:23552
    v_mfma_f32_16x16x32_bf16 v[244:247], v[104:107], v[148:151], v[244:247]
    v_mfma_f32_16x16x32_bf16 v[252:255], v[108:111], v[148:151], v[252:255]
    ds_read_b128 v[96:99], v6 offset:24576
    v_mfma_f32_16x16x32_bf16 v[248:251], v[108:111], v[144:147], v[248:251]
    s_waitcnt lgkmcnt(3)
    v_mfma_f32_16x16x32_bf16 v[224:227], v[80:83], v[152:155], v[224:227]
    ds_read_b128 v[100:103], v6 offset:25600
    v_mfma_f32_16x16x32_bf16 v[228:231], v[80:83], v[156:159], v[228:231]
    v_mfma_f32_16x16x32_bf16 v[236:239], v[84:87], v[156:159], v[236:239]
    ds_read_b128 v[104:107], v6 offset:26624
    v_mfma_f32_16x16x32_bf16 v[232:235], v[84:87], v[152:155], v[232:235]
    s_waitcnt lgkmcnt(3)
    v_mfma_f32_16x16x32_bf16 v[240:243], v[88:91], v[152:155], v[240:243]
    ds_read_b128 v[108:111], v6 offset:27648
    v_mfma_f32_16x16x32_bf16 v[244:247], v[88:91], v[156:159], v[244:247]
    v_mfma_f32_16x16x32_bf16 v[252:255], v[92:95], v[156:159], v[252:255]
    v_mfma_f32_16x16x32_bf16 v[248:251], v[92:95], v[152:155], v[248:251]
    s_waitcnt lgkmcnt(2)
    v_mfma_f32_16x16x32_bf16 v[224:227], v[96:99], v[160:163], v[224:227]
    v_mfma_f32_16x16x32_bf16 v[228:231], v[96:99], v[164:167], v[228:231]
    v_mfma_f32_16x16x32_bf16 v[236:239], v[100:103], v[164:167], v[236:239]
    v_mfma_f32_16x16x32_bf16 v[232:235], v[100:103], v[160:163], v[232:235]
    s_waitcnt lgkmcnt(0)
    v_mfma_f32_16x16x32_bf16 v[240:243], v[104:107], v[160:163], v[240:243]
    v_mfma_f32_16x16x32_bf16 v[244:247], v[104:107], v[164:167], v[244:247]
    v_mfma_f32_16x16x32_bf16 v[252:255], v[108:111], v[164:167], v[252:255]
    v_mfma_f32_16x16x32_bf16 v[248:251], v[108:111], v[160:163], v[248:251]
    s_xor_b32 s44, s8, 4096
    s_mov_b32 s58, 0x40000
    s_mov_b64 exec, 1
    s_waitcnt vmcnt(0)
    v_cmp_gt_u32 vcc, 1, v15
    s_cbranch_vccz .Lpollok_24
.Lpoll_23:
    v_mov_b32 v15, 0
    buffer_atomic_add v15, v2, s[24:27], s47 offen sc0 sc1
    s_waitcnt vmcnt(0)
    v_cmp_gt_u32 vcc, 2, v15
    s_cbranch_vccz .Lpollok_24
    s_sub_u32 s58, s58, 1
    s_cbranch_scc0 .Lpoll_23
.Lpollok_24:
    s_mov_b64 exec, -1
    buffer_load_dwordx4 v[16:19], v1, s[24:27], s44 offen offset:0 sc1
    buffer_load_dwordx4 v[20:23], v1, s[24:27], s44 offen offset:1024 sc1
    buffer_load_dwordx4 v[24:27], v1, s[24:27], s44 offen offset:2048 sc1
    buffer_load_dwordx4 v[28:31], v1, s[24:27], s44 offen offset:3072 sc1
    s_cmp_lg_u32 s41, 0
    s_cbranch_scc1 .Llast_25
    s_add_u32 s4, s4, 0x2300000
    s_add_u32 s5, s5, 0x2300000
    s_add_u32 s6, s6, 0x2300000
    s_add_u32 s7, s7, 0x2300000
    s_add_u32 s8, s8, 0x2300000
    s_add_u32 s9, s9, 0x2300000
    s_add_u32 s10, s10, 0x2300000
    s_add_u32 s11, s11, 0x2300000
    s_add_u32 s12, s12, 0x2300000
    s_add_u32 s43, s5, 8192
    s_waitcnt vmcnt(3)
    v_lshlrev_b32 v32, 16, v16
    v_and_b32 v33, s54, v16
    v_pk_add_f32 v[224:225], v[224:225], v[32:33]
    v_lshlrev_b32 v32, 16, v17
    v_and_b32 v33, s54, v17
    v_pk_add_f32 v[226:227], v[226:227], v[32:33]
    v_lshlrev_b32 v32, 16, v18
    v_and_b32 v33, s54, v18
    v_pk_add_f32 v[232:233], v[232:233], v[32:33]
    v_lshlrev_b32 v32, 16, v19
    v_and_b32 v33, s54, v19
    v_pk_add_f32 v[234:235], v[234:235], v[32:33]
    s_waitcnt vmcnt(2)
    v_lshlrev_b32 v32, 16, v20
    v_and_b32 v33, s54, v20
    v_pk_add_f32 v[228:229], v[228:229], v[32:33]
    v_lshlrev_b32 v32, 16, v21
    v_and_b32 v33, s54, v21
    v_pk_add_f32 v[230:231], v[230:231], v[32:33]
    v_lshlrev_b32 v32, 16, v22
    v_and_b32 v33, s54, v22
    v_pk_add_f32 v[236:237], v[236:237], v[32:33]
    v_lshlrev_b32 v32, 16, v23
    v_and_b32 v33, s54, v23
    v_pk_add_f32 v[238:239], v[238:239], v[32:33]
    v_cvt_pk_bf16_f32 v48, v224, v225
    v_cvt_pk_bf16_f32 v49, v226, v227
    v_cvt_pk_bf16_f32 v50, v232, v233
    v_cvt_pk_bf16_f32 v51, v234, v235
    v_cvt_pk_bf16_f32 v52, v228, v229
    v_cvt_pk_bf16_f32 v53, v230, v231
    v_cvt_pk_bf16_f32 v54, v236, v237
    v_cvt_pk_bf16_f32 v55, v238, v239
    buffer_store_dwordx4 v[48:51], v1, s[24:27], s5 offen offset:0 sc1
    buffer_store_dwordx4 v[52:55], v1, s[24:27], s5 offen offset:1024 sc1
    s_waitcnt vmcnt(3)
    v_lshlrev_b32 v32, 16, v24
    v_and_b32 v33, s54, v24
    v_pk_add_f32 v[240:241], v[240:241], v[32:33]
    v_lshlrev_b32 v32, 16, v25
    v_and_b32 v33, s54, v25
    v_pk_add_f32 v[242:243], v[242:243], v[32:33]
    v_lshlrev_b32 v32, 16, v26
    v_and_b32 v33, s54, v26
    v_pk_add_f32 v[248:249], v[248:249], v[32:33]
    v_lshlrev_b32 v32, 16, v27
    v_and_b32 v33, s54, v27
    v_pk_add_f32 v[250:251], v[250:251], v[32:33]
    s_waitcnt vmcnt(2)
    v_lshlrev_b32 v32, 16, v28
    v_and_b32 v33, s54, v28
    v_pk_add_f32 v[244:245], v[244:245], v[32:33]
    v_lshlrev_b32 v32, 16, v29
    v_and_b32 v33, s54, v29
    v_pk_add_f32 v[246:247], v[246:247], v[32:33]
    v_lshlrev_b32 v32, 16, v30
    v_and_b32 v33, s54, v30
    v_pk_add_f32 v[252:253], v[252:253], v[32:33]
    v_lshlrev_b32 v32, 16, v31
    v_and_b32 v33, s54, v31
    v_pk_add_f32 v[254:255], v[254:255], v[32:33]
    v_cvt_pk_bf16_f32 v56, v240, v241
    v_cvt_pk_bf16_f32 v57, v242, v243
    v_cvt_pk_bf16_f32 v58, v248, v249
    v_cvt_pk_bf16_f32 v59, v250, v251
    v_cvt_pk_bf16_f32 v60, v244, v245
    v_cvt_pk_bf16_f32 v61, v246, v247
    v_cvt_pk_bf16_f32 v62, v252, v253
    v_cvt_pk_bf16_f32 v63, v254, v255
    buffer_store_dwordx4 v[56:59], v1, s[24:27], s43 offen offset:0 sc1
    buffer_store_dwordx4 v[60:63], v1, s[24:27], s43 offen offset:1024 sc1
    v_pk_add_f32 v[32:33], v[224:225], v[226:227]
    v_pk_mul_f32 v[34:35], v[224:225], v[224:225]
    v_pk_fma_f32 v[34:35], v[226:227], v[226:227], v[34:35]
    v_pk_add_f32 v[32:33], v[32:33], v[232:233]
    v_pk_fma_f32 v[34:35], v[232:233], v[232:233], v[34:35]
    v_pk_add_f32 v[32:33], v[32:33], v[234:235]
    v_pk_fma_f32 v[34:35], v[234:235], v[234:235], v[34:35]
    v_pk_add_f32 v[32:33], v[32:33], v[240:241]
    v_pk_fma_f32 v[34:35], v[240:241], v[240:241], v[34:35]
    v_pk_add_f32 v[32:33], v[32:33], v[242:243]
    v_pk_fma_f32 v[34:35], v[242:243], v[242:243], v[34:35]
    v_pk_add_f32 v[32:33], v[32:33], v[248:249]
    v_pk_fma_f32 v[34:35], v[248:249], v[248:249], v[34:35]
    v_pk_add_f32 v[32:33], v[32:33], v[250:251]
    v_pk_fma_f32 v[34:35], v[250:251], v[250:251], v[34:35]
    v_pk_add_f32 v[36:37], v[228:229], v[230:231]
    v_pk_mul_f32 v[38:39], v[228:229], v[228:229]
    v_pk_fma_f32 v[38:39], v[230:231], v[230:231], v[38:39]
    v_pk_add_f32 v[36:37], v[36:37], v[236:237]
    v_pk_fma_f32 v[38:39], v[236:237], v[236:237], v[38:39]
    v_pk_add_f32 v[36:37], v[36:37], v[238:239]
    v_pk_fma_f32 v[38:39], v[238:239], v[238:239], v[38:39]
    v_pk_add_f32 v[36:37], v[36:37], v[244:245]
    v_pk_fma_f32 v[38:39], v[244:245], v[244:245], v[38:39]
    v_pk_add_f32 v[36:37], v[36:37], v[246:247]
    v_pk_fma_f32 v[38:39], v[246:247], v[246:247], v[38:39]
    v_pk_add_f32 v[36:37], v[36:37], v[252:253]
    v_pk_fma_f32 v[38:39], v[252:253], v[252:253], v[38:39]
    v_pk_add_f32 v[36:37], v[36:37], v[254:255]
    v_pk_fma_f32 v[38:39], v[254:255], v[254:255], v[38:39]
    v_add_f32 v32, v32, v33
    v_add_f32 v34, v34, v35
    v_add_f32 v36, v36, v37
    v_add_f32 v38, v38, v39
    s_add_u32 s46, s10, 0x1c40000
    s_nop 0
    v_permlane16_swap_b32 v32, v36
    v_permlane16_swap_b32 v34, v38
    v_add_f32 v32, v32, v36
    v_add_f32 v34, v34, v38
    s_nop 1
    v_permlane32_swap_b32 v32, v34
    v_add_f32 v32, v32, v34
    buffer_store_dword v32, v14, s[24:27], s46 offen sc1
    s_barrier
    s_add_u32 s47, s9, 0x0
    v_mov_b32 v15, 1
    s_waitcnt vmcnt(0)
    s_mov_b64 exec, 1
    buffer_atomic_add v15, v2, s[24:27], s47 offen sc0 sc1
    s_mov_b64 exec, -1
    s_mov_b32 s41, 1
    s_add_u32 s40, s40, 0x2300000
    s_add_u32 s28, s28, 0x2300000
    s_addc_u32 s29, s29, 0
    s_branch .Lctop_3
.Llast_25:
    s_lshl_b32 s42, s59, 16
    s_lshl_b32 s43, s23, 7
    s_add_u32 s42, s42, s43
    v_and_b32 v4, 15, v0
    v_lshl_add_u32 v4, v4, 11, s42
    v_bfe_u32 v5, v0, 4, 1
    v_lshl_add_u32 v4, v5, 5, v4
    v_lshrrev_b32 v5, 5, v0
    v_lshl_add_u32 v4, v5, 4, v4
    v_add_u32 v5, 0x8000, v4
    s_waitcnt vmcnt(3)
    v_lshlrev_b32 v32, 16, v16
    v_and_b32 v33, s54, v16
    v_pk_add_f32 v[224:225], v[224:225], v[32:33]
    v_lshlrev_b32 v32, 16, v17
    v_and_b32 v33, s54, v17
    v_pk_add_f32 v[226:227], v[226:227], v[32:33]
    v_lshlrev_b32 v32, 16, v18
    v_and_b32 v33, s54, v18
    v_pk_add_f32 v[232:233], v[232:233], v[32:33]
    v_lshlrev_b32 v32, 16, v19
    v_and_b32 v33, s54, v19
    v_pk_add_f32 v[234:235], v[234:235], v[32:33]
    s_waitcnt vmcnt(2)
    v_lshlrev_b32 v32, 16, v20
    v_and_b32 v33, s54, v20
    v_pk_add_f32 v[228:229], v[228:229], v[32:33]
    v_lshlrev_b32 v32, 16, v21
    v_and_b32 v33, s54, v21
    v_pk_add_f32 v[230:231], v[230:231], v[32:33]
    v_lshlrev_b32 v32, 16, v22
    v_and_b32 v33, s54, v22
    v_pk_add_f32 v[236:237], v[236:237], v[32:33]
    v_lshlrev_b32 v32, 16, v23
    v_and_b32 v33, s54, v23
    v_pk_add_f32 v[238:239], v[238:239], v[32:33]
    v_cvt_pk_bf16_f32 v48, v224, v225
    v_cvt_pk_bf16_f32 v49, v226, v227
    v_cvt_pk_bf16_f32 v50, v232, v233
    v_cvt_pk_bf16_f32 v51, v234, v235
    v_cvt_pk_bf16_f32 v52, v228, v229
    v_cvt_pk_bf16_f32 v53, v230, v231
    v_cvt_pk_bf16_f32 v54, v236, v237
    v_cvt_pk_bf16_f32 v55, v238, v239
    v_permlane16_swap_b32 v48, v50
    v_permlane16_swap_b32 v49, v51
    buffer_store_dwordx4 v[48:51], v4, s[32:35], 0 offen offset:0 sc1
    v_permlane16_swap_b32 v52, v54
    v_permlane16_swap_b32 v53, v55
    buffer_store_dwordx4 v[52:55], v5, s[32:35], 0 offen offset:0 sc1
    s_waitcnt vmcnt(3)
    v_lshlrev_b32 v32, 16, v24
    v_and_b32 v33, s54, v24
    v_pk_add_f32 v[240:241], v[240:241], v[32:33]
    v_lshlrev_b32 v32, 16, v25
    v_and_b32 v33, s54, v25
    v_pk_add_f32 v[242:243], v[242:243], v[32:33]
    v_lshlrev_b32 v32, 16, v26
    v_and_b32 v33, s54, v26
    v_pk_add_f32 v[248:249], v[248:249], v[32:33]
    v_lshlrev_b32 v32, 16, v27
    v_and_b32 v33, s54, v27
    v_pk_add_f32 v[250:251], v[250:251], v[32:33]
    s_waitcnt vmcnt(2)
    v_lshlrev_b32 v32, 16, v28
    v_and_b32 v33, s54, v28
    v_pk_add_f32 v[244:245], v[244:245], v[32:33]
    v_lshlrev_b32 v32, 16, v29
    v_and_b32 v33, s54, v29
    v_pk_add_f32 v[246:247], v[246:247], v[32:33]
    v_lshlrev_b32 v32, 16, v30
    v_and_b32 v33, s54, v30
    v_pk_add_f32 v[252:253], v[252:253], v[32:33]
    v_lshlrev_b32 v32, 16, v31
    v_and_b32 v33, s54, v31
    v_pk_add_f32 v[254:255], v[254:255], v[32:33]
    v_cvt_pk_bf16_f32 v56, v240, v241
    v_cvt_pk_bf16_f32 v57, v242, v243
    v_cvt_pk_bf16_f32 v58, v248, v249
    v_cvt_pk_bf16_f32 v59, v250, v251
    v_cvt_pk_bf16_f32 v60, v244, v245
    v_cvt_pk_bf16_f32 v61, v246, v247
    v_cvt_pk_bf16_f32 v62, v252, v253
    v_cvt_pk_bf16_f32 v63, v254, v255
    v_permlane16_swap_b32 v56, v58
    v_permlane16_swap_b32 v57, v59
    buffer_store_dwordx4 v[56:59], v4, s[32:35], 0 offen offset:64 sc1
    v_permlane16_swap_b32 v60, v62
    v_permlane16_swap_b32 v61, v63
    buffer_store_dwordx4 v[60:63], v5, s[32:35], 0 offen offset:64 sc1
    s_endpgm
.Llinit_5:
    s_mov_b32 s36, s12
    s_mov_b32 s37, s13
    s_mov_b32 s38, 0x200000
    s_mov_b32 s39, 0x20000
    s_mov_b32 s88, s18
    s_mov_b32 s89, s19
    s_mov_b32 s90, 0x1c00
    s_mov_b32 s91, 0x20000
    v_lshrrev_b32 v4, 3, v0
    v_and_b32 v5, 7, v0
    v_lshlrev_b32 v5, 4, v5
    v_mul_u32_u24 v100, 7168, v4
    v_add_u32 v100, v100, v5
    v_lshl_add_u32 v101, v4, 11, v5
    v_lshrrev_b32 v4, 2, v0
    v_and_b32 v5, 3, v0
    v_lshlrev_b32 v5, 3, v5
    v_lshl_add_u32 v102, v4, 7, v5
    s_lshl_b32 s42, s21, 5
    v_add_u32 v102, s42, v102
    v_and_b32 v4, 15, v0
    v_lshlrev_b32 v103, 1, v4
    v_mov_b32 v104, 0x3f803f80
    v_mov_b32 v105, 0x3f803f80
    v_mov_b32 v106, 0x3f803f80
    v_mov_b32 v107, 0x3f803f80
    s_bfe_u32 s43, s23, 0x10001
    s_lshl_b32 s43, s43, 2
    v_lshl_add_u32 v108, v4, 4, s43
    v_bfe_u32 v5, v0, 4, 1
    v_lshl_add_u32 v108, v5, 11, v108
    v_lshrrev_b32 v5, 5, v0
    v_lshl_add_u32 v108, v5, 3, v108
    s_lshl_b32 s44, s21, 13
    s_add_u32 s44, s44, 131072
    s_lshl_b32 s46, s21, 14
    v_lshrrev_b32 v4, 2, v0
    v_and_b32 v5, 3, v0
    v_lshlrev_b32 v4, 6, v4
    v_lshl_add_u32 v4, v5, 3, v4
    v_add_u32 v4, s44, v4
    s_lshl_b32 s55, s21, 12
    s_add_u32 m0, s44, 0
    s_add_u32 s42, s46, 0
    s_waitcnt vmcnt(7)
    buffer_load_dwordx4 v1, s[64:67], s42 offen offset:0 lds
    s_waitcnt vmcnt(7)
    buffer_load_dwordx4 v1, s[64:67], s42 offen offset:1024 lds
    s_waitcnt vmcnt(7)
    buffer_load_dwordx4 v1, s[64:67], s42 offen offset:2048 lds
    s_waitcnt vmcnt(7)
    buffer_load_dwordx4 v1, s[64:67], s42 offen offset:3072 lds
    s_add_u32 m0, s44, 4096
    s_add_u32 s42, s46, 4096
    s_waitcnt vmcnt(7)
    buffer_load_dwordx4 v1, s[64:67], s42 offen offset:0 lds
    s_waitcnt vmcnt(7)
    buffer_load_dwordx4 v1, s[64:67], s42 offen offset:1024 lds
    s_waitcnt vmcnt(7)
    buffer_load_dwordx4 v1, s[64:67], s42 offen offset:2048 lds
    s_waitcnt vmcnt(7)
    buffer_load_dwordx4 v1, s[64:67], s42 offen offset:3072 lds
    s_add_u32 s43, s21, 0
    s_cmp_lt_u32 s43, s86
    s_cselect_b32 s42, 2, 0
    s_sub_u32 s43, s43, s42
    s_cselect_b32 s42, s86, 0
    s_add_u32 s43, s43, s42
    s_lshl_b32 s43, s43, 16
    s_add_u32 s43, s43, s87
    s_add_u32 m0, s55, 0
    s_add_u32 s42, s43, 0
    s_waitcnt vmcnt(7)
    buffer_load_dwordx4 v8, s[32:35], s42 offen lds
    s_add_u32 m0, s55, 1024
    s_add_u32 s42, s43, 16384
    s_waitcnt vmcnt(7)
    buffer_load_dwordx4 v8, s[32:35], s42 offen lds
    s_add_u32 m0, s55, 2048
    s_add_u32 s42, s43, 32768
    s_waitcnt vmcnt(7)
    buffer_load_dwordx4 v8, s[32:35], s42 offen lds
    s_add_u32 m0, s55, 3072
    s_add_u32 s42, s43, 49152
    s_waitcnt vmcnt(7)
    buffer_load_dwordx4 v8, s[32:35], s42 offen lds
    s_add_u32 s43, s21, 4
    s_cmp_lt_u32 s43, s86
    s_cselect_b32 s42, 2, 0
    s_sub_u32 s43, s43, s42
    s_lshl_b32 s43, s43, 16
    s_add_u32 s43, s43, s87
    s_add_u32 m0, s55, 16384
    s_add_u32 s42, s43, 0
    s_waitcnt vmcnt(7)
    buffer_load_dwordx4 v8, s[32:35], s42 offen lds
    s_add_u32 m0, s55, 17408
    s_add_u32 s42, s43, 16384
    s_waitcnt vmcnt(7)
    buffer_load_dwordx4 v8, s[32:35], s42 offen lds
    s_add_u32 m0, s55, 18432
    s_add_u32 s42, s43, 32768
    s_waitcnt vmcnt(7)
    buffer_load_dwordx4 v8, s[32:35], s42 offen lds
    s_add_u32 m0, s55, 19456
    s_add_u32 s42, s43, 49152
    s_waitcnt vmcnt(7)
    buffer_load_dwordx4 v8, s[32:35], s42 offen lds
    s_waitcnt vmcnt(8)
    ds_read_b64_tr_b16 v[192:193], v4 offset:0
    ds_read_b64_tr_b16 v[194:195], v4 offset:1024
    ds_read_b64_tr_b16 v[196:197], v4 offset:32
    ds_read_b64_tr_b16 v[198:199], v4 offset:1056
    ds_read_b64_tr_b16 v[200:201], v4 offset:2048
    ds_read_b64_tr_b16 v[202:203], v4 offset:3072
    ds_read_b64_tr_b16 v[204:205], v4 offset:2080
    ds_read_b64_tr_b16 v[206:207], v4 offset:3104
    s_waitcnt lgkmcnt(0)
    ds_read_b64_tr_b16 v[208:209], v4 offset:4096
    ds_read_b64_tr_b16 v[210:211], v4 offset:5120
    ds_read_b64_tr_b16 v[212:213], v4 offset:4128
    ds_read_b64_tr_b16 v[214:215], v4 offset:5152
    ds_read_b64_tr_b16 v[216:217], v4 offset:6144
    ds_read_b64_tr_b16 v[218:219], v4 offset:7168
    ds_read_b64_tr_b16 v[220:221], v4 offset:6176
    ds_read_b64_tr_b16 v[222:223], v4 offset:7200
    s_waitcnt lgkmcnt(0)
    s_add_u32 m0, s44, 0
    s_add_u32 s42, s46, 8192
    s_waitcnt vmcnt(7)
    buffer_load_dwordx4 v1, s[64:67], s42 offen offset:0 lds
    s_waitcnt vmcnt(7)
    buffer_load_dwordx4 v1, s[64:67], s42 offen offset:1024 lds
    s_waitcnt vmcnt(7)
    buffer_load_dwordx4 v1, s[64:67], s42 offen offset:2048 lds
    s_waitcnt vmcnt(7)
    buffer_load_dwordx4 v1, s[64:67], s42 offen offset:3072 lds
    s_add_u32 m0, s44, 4096
    s_add_u32 s42, s46, 12288
    s_waitcnt vmcnt(7)
    buffer_load_dwordx4 v1, s[64:67], s42 offen offset:0 lds
    s_waitcnt vmcnt(7)
    buffer_load_dwordx4 v1, s[64:67], s42 offen offset:1024 lds
    s_waitcnt vmcnt(7)
    buffer_load_dwordx4 v1, s[64:67], s42 offen offset:2048 lds
    s_waitcnt vmcnt(7)
    buffer_load_dwordx4 v1, s[64:67], s42 offen offset:3072 lds
    s_add_u32 s43, s21, 8
    s_cmp_lt_u32 s43, s86
    s_cselect_b32 s42, 2, 0
    s_sub_u32 s43, s43, s42
    s_lshl_b32 s43, s43, 16
    s_add_u32 s43, s43, s87
    s_add_u32 m0, s55, 32768
    s_add_u32 s42, s43, 0
    s_waitcnt vmcnt(7)
    buffer_load_dwordx4 v8, s[32:35], s42 offen lds
    s_add_u32 m0, s55, 33792
    s_add_u32 s42, s43, 16384
    s_waitcnt vmcnt(7)
    buffer_load_dwordx4 v8, s[32:35], s42 offen lds
    s_add_u32 m0, s55, 34816
    s_add_u32 s42, s43, 32768
    s_waitcnt vmcnt(7)
    buffer_load_dwordx4 v8, s[32:35], s42 offen lds
    s_add_u32 m0, s55, 35840
    s_add_u32 s42, s43, 49152
    s_waitcnt vmcnt(7)
    buffer_load_dwordx4 v8, s[32:35], s42 offen lds
    s_add_u32 s43, s21, 12
    s_cmp_lt_u32 s43, s86
    s_cselect_b32 s42, 2, 0
    s_sub_u32 s43, s43, s42
    s_lshl_b32 s43, s43, 16
    s_add_u32 s43, s43, s87
    s_add_u32 m0, s55, 49152
    s_add_u32 s42, s43, 0
    s_waitcnt vmcnt(7)
    buffer_load_dwordx4 v8, s[32:35], s42 offen lds
    s_add_u32 m0, s55, 50176
    s_add_u32 s42, s43, 16384
    s_waitcnt vmcnt(7)
    buffer_load_dwordx4 v8, s[32:35], s42 offen lds
    s_add_u32 m0, s55, 51200
    s_add_u32 s42, s43, 32768
    s_waitcnt vmcnt(7)
    buffer_load_dwordx4 v8, s[32:35], s42 offen lds
    s_add_u32 m0, s55, 52224
    s_add_u32 s42, s43, 49152
    s_waitcnt vmcnt(7)
    buffer_load_dwordx4 v8, s[32:35], s42 offen lds
    s_waitcnt vmcnt(8)
    ds_read_b64_tr_b16 v[224:225], v4 offset:0
    ds_read_b64_tr_b16 v[226:227], v4 offset:1024
    ds_read_b64_tr_b16 v[228:229], v4 offset:32
    ds_read_b64_tr_b16 v[230:231], v4 offset:1056
    ds_read_b64_tr_b16 v[232:233], v4 offset:2048
    ds_read_b64_tr_b16 v[234:235], v4 offset:3072
    ds_read_b64_tr_b16 v[236:237], v4 offset:2080
    ds_read_b64_tr_b16 v[238:239], v4 offset:3104
    s_waitcnt lgkmcnt(0)
    ds_read_b64_tr_b16 v[240:241], v4 offset:4096
    ds_read_b64_tr_b16 v[242:243], v4 offset:5120
    ds_read_b64_tr_b16 v[244:245], v4 offset:4128
    ds_read_b64_tr_b16 v[246:247], v4 offset:5152
    ds_read_b64_tr_b16 v[248:249], v4 offset:6144
    ds_read_b64_tr_b16 v[250:251], v4 offset:7168
    ds_read_b64_tr_b16 v[252:253], v4 offset:6176
    ds_read_b64_tr_b16 v[254:255], v4 offset:7200
    s_waitcnt lgkmcnt(0)
    s_add_u32 s43, s21, 16
    s_cmp_lt_u32 s43, s86
    s_cselect_b32 s42, 2, 0
    s_sub_u32 s43, s43, s42
    s_lshl_b32 s43, s43, 16
    s_add_u32 s43, s43, s87
    s_add_u32 m0, s55, 65536
    s_add_u32 s42, s43, 0
    s_waitcnt vmcnt(7)
    buffer_load_dwordx4 v8, s[32:35], s42 offen lds
    s_add_u32 m0, s55, 66560
    s_add_u32 s42, s43, 16384
    s_waitcnt vmcnt(7)
    buffer_load_dwordx4 v8, s[32:35], s42 offen lds
    s_add_u32 m0, s55, 67584
    s_add_u32 s42, s43, 32768
    s_waitcnt vmcnt(7)
    buffer_load_dwordx4 v8, s[32:35], s42 offen lds
    s_add_u32 m0, s55, 68608
    s_add_u32 s42, s43, 49152
    s_waitcnt vmcnt(7)
    buffer_load_dwordx4 v8, s[32:35], s42 offen lds
    s_add_u32 s43, s21, 20
    s_cmp_lt_u32 s43, s86
    s_cselect_b32 s42, 2, 0
    s_sub_u32 s43, s43, s42
    s_lshl_b32 s43, s43, 16
    s_add_u32 s43, s43, s87
    s_add_u32 m0, s55, 81920
    s_add_u32 s42, s43, 0
    s_waitcnt vmcnt(7)
    buffer_load_dwordx4 v8, s[32:35], s42 offen lds
    s_add_u32 m0, s55, 82944
    s_add_u32 s42, s43, 16384
    s_waitcnt vmcnt(7)
    buffer_load_dwordx4 v8, s[32:35], s42 offen lds
    s_add_u32 m0, s55, 83968
    s_add_u32 s42, s43, 32768
    s_waitcnt vmcnt(7)
    buffer_load_dwordx4 v8, s[32:35], s42 offen lds
    s_add_u32 m0, s55, 84992
    s_add_u32 s42, s43, 49152
    s_waitcnt vmcnt(7)
    buffer_load_dwordx4 v8, s[32:35], s42 offen lds
    v_mfma_f32_16x16x32_bf16 v[52:55], v[104:107], v[192:195], 0
    v_mfma_f32_16x16x32_bf16 v[56:59], v[104:107], v[196:199], 0
    v_mfma_f32_16x16x32_bf16 v[52:55], v[104:107], v[200:203], v[52:55]
    v_mfma_f32_16x16x32_bf16 v[56:59], v[104:107], v[204:207], v[56:59]
    v_mfma_f32_16x16x32_bf16 v[52:55], v[104:107], v[208:211], v[52:55]
    v_mfma_f32_16x16x32_bf16 v[56:59], v[104:107], v[212:215], v[56:59]
    v_mfma_f32_16x16x32_bf16 v[52:55], v[104:107], v[216:219], v[52:55]
    v_mfma_f32_16x16x32_bf16 v[56:59], v[104:107], v[220:223], v[56:59]
    v_mfma_f32_16x16x32_bf16 v[52:55], v[104:107], v[224:227], v[52:55]
    v_mfma_f32_16x16x32_bf16 v[56:59], v[104:107], v[228:231], v[56:59]
    v_mfma_f32_16x16x32_bf16 v[52:55], v[104:107], v[232:235], v[52:55]
    v_mfma_f32_16x16x32_bf16 v[56:59], v[104:107], v[236:239], v[56:59]
    v_mfma_f32_16x16x32_bf16 v[52:55], v[104:107], v[240:243], v[52:55]
    v_mfma_f32_16x16x32_bf16 v[56:59], v[104:107], v[244:247], v[56:59]
    v_mfma_f32_16x16x32_bf16 v[52:55], v[104:107], v[248:251], v[52:55]
    v_mfma_f32_16x16x32_bf16 v[56:59], v[104:107], v[252:255], v[56:59]
    s_lshl_b32 s43, s21, 4
    s_lshl_b64 s[62:63], 0xffff, s43
    v_lshrrev_b32 v12, 4, v0
    v_lshl_add_u32 v12, v12, 13, v1
    v_add_u32 v12, 131072, v12
    v_mov_b32 v187, 0
    v_mov_b32 v191, 0
    s_nop 1
    v_and_b32 v55, s54, v52
    v_sub_f32 v53, v52, v55
    v_and_b32 v55, s54, v53
    v_sub_f32 v54, v53, v55
    v_perm_b32 v184, v52, v52, s53
    v_perm_b32 v185, v53, v53, s53
    v_perm_b32 v186, v54, v52, s53
    v_and_b32 v59, s54, v56
    v_sub_f32 v57, v56, v59
    v_and_b32 v59, s54, v57
    v_sub_f32 v58, v57, v59
    v_perm_b32 v188, v56, v56, s53
    v_perm_b32 v189, v57, v57, s53
    v_perm_b32 v190, v58, v56, s53
    s_mov_b64 exec, s[62:63]
    ds_write_b128 v12, v[184:187] offset:0
    ds_write_b128 v12, v[188:191] offset:1024
    s_mov_b64 exec, -1
    s_cmp_lg_u32 s21, 2
    s_cbranch_scc1 .Lnz_26
    v_mov_b32 v5, 148480
    ds_write_b32 v5, v2
.Lnz_26:
    v_bfe_u32 v4, v0, 2, 3
    v_lshrrev_b32 v5, 5, v0
    v_lshl_add_u32 v5, v5, 3, v4
    v_lshlrev_b32 v96, 7, v5
    v_lshrrev_b32 v4, 1, v4
    v_lshl_add_u32 v96, v4, 5, v96
    v_and_b32 v4, 3, v0
    v_lshl_add_u32 v96, v4, 3, v96
    v_add_u32 v96, s55, v96
    v_xor_b32 v97, 32, v96
    v_xor_b32 v98, 64, v96
    v_xor_b32 v99, 96, v96
    s_waitcnt vmcnt(8) lgkmcnt(0)
    ds_read_b64_tr_b16 v[128:129], v96 offset:0
    ds_read_b64_tr_b16 v[130:131], v96 offset:2048
    ds_read_b64_tr_b16 v[132:133], v97 offset:0
    ds_read_b64_tr_b16 v[134:135], v97 offset:2048
    ds_read_b64_tr_b16 v[136:137], v98 offset:0
    ds_read_b64_tr_b16 v[138:139], v98 offset:2048
    ds_read_b64_tr_b16 v[140:141], v99 offset:0
    ds_read_b64_tr_b16 v[142:143], v99 offset:2048
    ds_read_b64_tr_b16 v[144:145], v96 offset:16384
    ds_read_b64_tr_b16 v[146:147], v96 offset:18432
    ds_read_b64_tr_b16 v[148:149], v97 offset:16384
    ds_read_b64_tr_b16 v[150:151], v97 offset:18432
    s_waitcnt lgkmcnt(10)
    v_mfma_f32_16x16x32_bf16 v[112:115], v[104:107], v[128:131], 0
    ds_read_b64_tr_b16 v[152:153], v98 offset:16384
    ds_read_b64_tr_b16 v[154:155], v98 offset:18432
    s_waitcnt lgkmcnt(10)
    v_mfma_f32_16x16x32_bf16 v[116:119], v[104:107], v[132:135], 0
    ds_read_b64_tr_b16 v[156:157], v99 offset:16384
    ds_read_b64_tr_b16 v[158:159], v99 offset:18432
    s_waitcnt lgkmcnt(10)
    v_mfma_f32_16x16x32_bf16 v[120:123], v[104:107], v[136:139], 0
    ds_read_b64_tr_b16 v[128:129], v96 offset:32768
    ds_read_b64_tr_b16 v[130:131], v96 offset:34816
    s_waitcnt lgkmcnt(10)
    v_mfma_f32_16x16x32_bf16 v[124:127], v[104:107], v[140:143], 0
    ds_read_b64_tr_b16 v[132:133], v97 offset:32768
    ds_read_b64_tr_b16 v[134:135], v97 offset:34816
    s_waitcnt lgkmcnt(10)
    v_mfma_f32_16x16x32_bf16 v[112:115], v[104:107], v[144:147], v[112:115]
    ds_read_b64_tr_b16 v[136:137], v98 offset:32768
    ds_read_b64_tr_b16 v[138:139], v98 offset:34816
    s_waitcnt lgkmcnt(10)
    v_mfma_f32_16x16x32_bf16 v[116:119], v[104:107], v[148:151], v[116:119]
    ds_read_b64_tr_b16 v[140:141], v99 offset:32768
    ds_read_b64_tr_b16 v[142:143], v99 offset:34816
    s_waitcnt lgkmcnt(10)
    v_mfma_f32_16x16x32_bf16 v[120:123], v[104:107], v[152:155], v[120:123]
    ds_read_b64_tr_b16 v[144:145], v96 offset:49152
    ds_read_b64_tr_b16 v[146:147], v96 offset:51200
    s_waitcnt lgkmcnt(10)
    v_mfma_f32_16x16x32_bf16 v[124:127], v[104:107], v[156:159], v[124:127]
    ds_read_b64_tr_b16 v[148:149], v97 offset:49152
    ds_read_b64_tr_b16 v[150:151], v97 offset:51200
    s_waitcnt lgkmcnt(10)
    v_mfma_f32_16x16x32_bf16 v[112:115], v[104:107], v[128:131], v[112:115]
    ds_read_b64_tr_b16 v[152:153], v98 offset:49152
    ds_read_b64_tr_b16 v[154:155], v98 offset:51200
    s_waitcnt lgkmcnt(10)
    v_mfma_f32_16x16x32_bf16 v[116:119], v[104:107], v[132:135], v[116:119]
    ds_read_b64_tr_b16 v[156:157], v99 offset:49152
    ds_read_b64_tr_b16 v[158:159], v99 offset:51200
    s_waitcnt lgkmcnt(10)
    v_mfma_f32_16x16x32_bf16 v[120:123], v[104:107], v[136:139], v[120:123]
    s_waitcnt lgkmcnt(8)
    v_mfma_f32_16x16x32_bf16 v[124:127], v[104:107], v[140:143], v[124:127]
    s_waitcnt lgkmcnt(6)
    v_mfma_f32_16x16x32_bf16 v[112:115], v[104:107], v[144:147], v[112:115]
    s_waitcnt lgkmcnt(4)
    v_mfma_f32_16x16x32_bf16 v[116:119], v[104:107], v[148:151], v[116:119]
    s_waitcnt lgkmcnt(2)
    v_mfma_f32_16x16x32_bf16 v[120:123], v[104:107], v[152:155], v[120:123]
    s_waitcnt lgkmcnt(0)
    v_mfma_f32_16x16x32_bf16 v[124:127], v[104:107], v[156:159], v[124:127]
    v_add_u32 v96, 0x10000, v96
    v_add_u32 v97, 0x10000, v97
    v_add_u32 v98, 0x10000, v98
    v_add_u32 v99, 0x10000, v99
    s_barrier
    s_branch .Llmid_27
.Lltop_4:
    s_lshl_b32 s43, s21, 12
    s_mul_i32 s45, s23, 131072
    s_add_u32 s45, s45, s43
    s_add_u32 m0, s43, 0
    s_add_u32 s42, s45, 0
    s_waitcnt vmcnt(7)
    buffer_load_dwordx4 v1, s[24:27], s42 offen offset:0 sc1 lds
    s_waitcnt vmcnt(7)
    buffer_load_dwordx4 v1, s[24:27], s42 offen offset:1024 sc1 lds
    s_waitcnt vmcnt(7)
    buffer_load_dwordx4 v1, s[24:27], s42 offen offset:2048 sc1 lds
    s_waitcnt vmcnt(7)
    buffer_load_dwordx4 v1, s[24:27], s42 offen offset:3072 sc1 lds
    s_add_u32 m0, s43, 16384
    s_add_u32 s42, s45, 16384
    s_waitcnt vmcnt(7)
    buffer_load_dwordx4 v1, s[24:27], s42 offen offset:0 sc1 lds
    s_waitcnt vmcnt(7)
    buffer_load_dwordx4 v1, s[24:27], s42 offen offset:1024 sc1 lds
    s_waitcnt vmcnt(7)
    buffer_load_dwordx4 v1, s[24:27], s42 offen offset:2048 sc1 lds
    s_waitcnt vmcnt(7)
    buffer_load_dwordx4 v1, s[24:27], s42 offen offset:3072 sc1 lds
    s_add_u32 m0, s43, 114688
    s_add_u32 s42, s45, 114688
    s_waitcnt vmcnt(7)
    buffer_load_dwordx4 v1, s[24:27], s42 offen offset:0 sc1 lds
    s_waitcnt vmcnt(7)
    buffer_load_dwordx4 v1, s[24:27], s42 offen offset:1024 sc1 lds
    s_waitcnt vmcnt(7)
    buffer_load_dwordx4 v1, s[24:27], s42 offen offset:2048 sc1 lds
    s_waitcnt vmcnt(7)
    buffer_load_dwordx4 v1, s[24:27], s42 offen offset:3072 sc1 lds
    s_cmp_lg_u32 s21, 2
    s_cbranch_scc1 .Lnz_28
    v_mov_b32 v5, 148480
    ds_write_b32 v5, v2
.Lnz_28:
    s_waitcnt vmcnt(0) lgkmcnt(0)
    s_barrier
.Llmid_27:
    s_lshl_b32 s55, s21, 12
    s_setprio 3
    s_lshr_b32 s44, s23, 2
    s_lshl_b32 s45, s22, 2
    s_add_u32 s45, s45, s44
    s_lshl_b32 s42, s21, 6
    s_lshr_b32 s43, s23, 1
    s_add_u32 s42, s42, s43
    s_lshl_b32 s42, s42, 10
    s_mul_i32 s43, s22, 262144
    s_add_u32 s42, s42, s43
    s_add_u32 s42, s42, s40
    v_mov_b32 v5, 148480
    s_cmp_eq_u32 s21, 0
    s_cbranch_scc1 .Llead_32
    buffer_load_dwordx4 v[16:19], v1, s[24:27], s42 offen sc1
    s_add_u32 s42, s42, 8192
    buffer_load_dwordx4 v[20:23], v1, s[24:27], s42 offen sc1
    s_add_u32 s42, s42, 8192
    buffer_load_dwordx4 v[24:27], v1, s[24:27], s42 offen sc1
    s_add_u32 s42, s42, 8192
    buffer_load_dwordx4 v[28:31], v1, s[24:27], s42 offen sc1
    s_add_u32 s42, s42, 8192
    s_waitcnt vmcnt(3)
    buffer_load_dwordx4 v[32:35], v1, s[24:27], s42 offen sc1
    s_add_u32 s42, s42, 8192
    s_waitcnt vmcnt(3)
    buffer_load_dwordx4 v[36:39], v1, s[24:27], s42 offen sc1
    s_add_u32 s42, s42, 8192
    s_waitcnt vmcnt(3)
    buffer_load_dwordx4 v[40:43], v1, s[24:27], s42 offen sc1
    s_add_u32 s42, s42, 8192
    s_waitcnt vmcnt(3)
    buffer_load_dwordx4 v[44:47], v1, s[24:27], s42 offen sc1
    s_add_u32 s42, s42, 8192
    s_waitcnt vmcnt(7)
    v_mfma_f32_16x16x32_bf16 v[64:67], v[192:195], v[16:19], 0
    v_mfma_f32_16x16x32_bf16 v[68:71], v[196:199], v[16:19], 0
    s_waitcnt vmcnt(6)
    v_mfma_f32_16x16x32_bf16 v[64:67], v[200:203], v[20:23], v[64:67]
    v_mfma_f32_16x16x32_bf16 v[68:71], v[204:207], v[20:23], v[68:71]
    s_waitcnt vmcnt(5)
    v_mfma_f32_16x16x32_bf16 v[64:67], v[208:211], v[24:27], v[64:67]
    v_mfma_f32_16x16x32_bf16 v[68:71], v[212:215], v[24:27], v[68:71]
    s_waitcnt vmcnt(4)
    v_mfma_f32_16x16x32_bf16 v[64:67], v[216:219], v[28:31], v[64:67]
    v_mfma_f32_16x16x32_bf16 v[68:71], v[220:223], v[28:31], v[68:71]
    s_waitcnt vmcnt(3)
    v_mfma_f32_16x16x32_bf16 v[64:67], v[224:227], v[32:35], v[64:67]
    v_mfma_f32_16x16x32_bf16 v[68:71], v[228:231], v[32:35], v[68:71]
    s_waitcnt vmcnt(2)
    v_mfma_f32_16x16x32_bf16 v[64:67], v[232:235], v[36:39], v[64:67]
    v_mfma_f32_16x16x32_bf16 v[68:71], v[236:239], v[36:39], v[68:71]
    s_waitcnt vmcnt(1)
    v_mfma_f32_16x16x32_bf16 v[64:67], v[240:243], v[40:43], v[64:67]
    v_mfma_f32_16x16x32_bf16 v[68:71], v[244:247], v[40:43], v[68:71]
    s_waitcnt vmcnt(0)
    v_mfma_f32_16x16x32_bf16 v[64:67], v[248:251], v[44:47], v[64:67]
    v_mfma_f32_16x16x32_bf16 v[68:71], v[252:255], v[44:47], v[68:71]
    s_lshl_b32 s42, s21, 11
    s_add_u32 s42, s42, 147456
    v_add_u32 v4, s42, v1
    v_mov_b32 v6, 1
    s_nop 3
    ds_write_b128 v4, v[64:67] offset:0
    ds_write_b128 v4, v[68:71] offset:1024
    s_mov_b64 exec, 1
    ds_add_u32 v5, v6
    s_mov_b64 exec, -1
    s_cmp_lg_u32 s41, 0
    s_cbranch_scc1 .Lnotfirst_34
    s_mov_b32 s44, s42
    s_add_u32 s43, s21, 24
    s_cmp_lt_u32 s43, s86
    s_cselect_b32 s42, 2, 0
    s_sub_u32 s43, s43, s42
    s_lshl_b32 s43, s43, 16
    s_add_u32 s43, s43, s87
    s_add_u32 m0, s55, 98304
    s_add_u32 s42, s43, 0
    buffer_load_dwordx4 v8, s[32:35], s42 offen lds
    s_add_u32 m0, s55, 99328
    s_add_u32 s42, s43, 16384
    buffer_load_dwordx4 v8, s[32:35], s42 offen lds
    s_add_u32 m0, s55, 100352
    s_add_u32 s42, s43, 32768
    buffer_load_dwordx4 v8, s[32:35], s42 offen lds
    s_add_u32 m0, s55, 101376
    s_add_u32 s42, s43, 49152
    buffer_load_dwordx4 v8, s[32:35], s42 offen lds
    s_add_u32 s43, s21, 28
    s_cmp_lt_u32 s43, s86
    s_cselect_b32 s42, 2, 0
    s_sub_u32 s43, s43, s42
    s_lshl_b32 s43, s43, 16
    s_add_u32 s43, s43, s87
    s_add_u32 m0, s55, 114688
    s_add_u32 s42, s43, 0
    buffer_load_dwordx4 v8, s[32:35], s42 offen lds
    s_add_u32 m0, s55, 115712
    s_add_u32 s42, s43, 16384
    buffer_load_dwordx4 v8, s[32:35], s42 offen lds
    s_add_u32 m0, s55, 116736
    s_add_u32 s42, s43, 32768
    buffer_load_dwordx4 v8, s[32:35], s42 offen lds
    s_add_u32 m0, s55, 117760
    s_add_u32 s42, s43, 49152
    buffer_load_dwordx4 v8, s[32:35], s42 offen lds
    s_mov_b32 s42, s44
    s_barrier
    s_waitcnt vmcnt(0)
.Lnotfirst_34:
    s_branch .Lkvdone_29
.Llead_32:
    s_cmp_lg_u32 s41, 0
    s_cbranch_scc1 .Lnotfirst_35
    ds_read_b128 v[184:187], v12 offset:0
    ds_read_b128 v[188:191], v12 offset:1024
    s_mov_b32 s44, s42
    s_add_u32 s43, s21, 24
    s_cmp_lt_u32 s43, s86
    s_cselect_b32 s42, 2, 0
    s_sub_u32 s43, s43, s42
    s_lshl_b32 s43, s43, 16
    s_add_u32 s43, s43, s87
    s_add_u32 m0, s55, 98304
    s_add_u32 s42, s43, 0
    buffer_load_dwordx4 v8, s[32:35], s42 offen lds
    s_add_u32 m0, s55, 99328
    s_add_u32 s42, s43, 16384
    buffer_load_dwordx4 v8, s[32:35], s42 offen lds
    s_add_u32 m0, s55, 100352
    s_add_u32 s42, s43, 32768
    buffer_load_dwordx4 v8, s[32:35], s42 offen lds
    s_add_u32 m0, s55, 101376
    s_add_u32 s42, s43, 49152
    buffer_load_dwordx4 v8, s[32:35], s42 offen lds
    s_add_u32 s43, s21, 28
    s_cmp_lt_u32 s43, s86
    s_cselect_b32 s42, 2, 0
    s_sub_u32 s43, s43, s42
    s_lshl_b32 s43, s43, 16
    s_add_u32 s43, s43, s87
    s_add_u32 m0, s55, 114688
    s_add_u32 s42, s43, 0
    buffer_load_dwordx4 v8, s[32:35], s42 offen lds
    s_add_u32 m0, s55, 115712
    s_add_u32 s42, s43, 16384
    buffer_load_dwordx4 v8, s[32:35], s42 offen lds
    s_add_u32 m0, s55, 116736
    s_add_u32 s42, s43, 32768
    buffer_load_dwordx4 v8, s[32:35], s42 offen lds
    s_add_u32 m0, s55, 117760
    s_add_u32 s42, s43, 49152
    buffer_load_dwordx4 v8, s[32:35], s42 offen lds
    s_mov_b32 s42, s44
.Lnotfirst_35:
    s_lshl_b32 s46, s45, 12
    s_add_u32 s46, s46, s40
    s_add_u32 s46, s46, 0x1c40000
    buffer_load_dword v48, v108, s[24:27], s46 offen offset:0 sc1
    buffer_load_dword v49, v108, s[24:27], s46 offen offset:256 sc1
    buffer_load_dword v50, v108, s[24:27], s46 offen offset:512 sc1
    buffer_load_dword v51, v108, s[24:27], s46 offen offset:768 sc1
    buffer_load_dword v52, v108, s[24:27], s46 offen offset:1024 sc1
    buffer_load_dword v53, v108, s[24:27], s46 offen offset:1280 sc1
    buffer_load_dword v54, v108, s[24:27], s46 offen offset:1536 sc1
    buffer_load_dword v55, v108, s[24:27], s46 offen offset:1792 sc1
    buffer_load_dwordx4 v[16:19], v1, s[24:27], s42 offen sc1
    s_add_u32 s42, s42, 8192
    buffer_load_dwordx4 v[20:23], v1, s[24:27], s42 offen sc1
    s_add_u32 s42, s42, 8192
    buffer_load_dwordx4 v[24:27], v1, s[24:27], s42 offen sc1
    s_add_u32 s42, s42, 8192
    buffer_load_dwordx4 v[28:31], v1, s[24:27], s42 offen sc1
    s_add_u32 s42, s42, 8192
    buffer_load_dwordx4 v[32:35], v1, s[24:27], s42 offen sc1
    s_add_u32 s42, s42, 8192
    buffer_load_dwordx4 v[36:39], v1, s[24:27], s42 offen sc1
    s_add_u32 s42, s42, 8192
    buffer_load_dwordx4 v[40:43], v1, s[24:27], s42 offen sc1
    s_add_u32 s42, s42, 8192
    buffer_load_dwordx4 v[44:47], v1, s[24:27], s42 offen sc1
    s_add_u32 s42, s42, 8192
    s_waitcnt vmcnt(8)
    v_add_f32 v48, v48, v52
    v_add_f32 v49, v49, v53
    v_add_f32 v50, v50, v54
    v_add_f32 v51, v51, v55
    v_add_f32 v48, v48, v50
    v_add_f32 v49, v49, v51
    v_add_f32 v48, v48, v49
    v_mov_b32 v49, v48
    s_nop 1
    v_permlane16_swap_b32 v48, v49
    v_add_f32 v48, v48, v49
    v_mov_b32 v49, v48
    s_nop 1
    v_permlane32_swap_b32 v48, v49
    v_mul_f32 v50, 0xba800000, v48
    v_mul_f32 v52, 0x3a800000, v49
    v_fma_f32 v52, -v50, v50, v52
    v_max_f32 v52, 0, v52
    v_add_f32 v53, 0x3727c5ac, v52
    v_rsq_f32 v51, v53
    s_nop 0
    v_and_b32 v58, s54, v50
    v_sub_f32 v56, v50, v58
    v_and_b32 v58, s54, v56
    v_sub_f32 v57, v56, v58
    v_perm_b32 v80, v56, v50, s53
    v_perm_b32 v81, v56, v50, s53
    v_perm_b32 v82, v50, v57, s53
    v_mov_b32 v83, 0
    s_waitcnt vmcnt(7)
    v_mfma_f32_16x16x32_bf16 v[64:67], v[192:195], v[16:19], 0
    v_mfma_f32_16x16x32_bf16 v[68:71], v[196:199], v[16:19], 0
    s_waitcnt vmcnt(6)
    v_mfma_f32_16x16x32_bf16 v[64:67], v[200:203], v[20:23], v[64:67]
    v_mfma_f32_16x16x32_bf16 v[68:71], v[204:207], v[20:23], v[68:71]
    s_waitcnt vmcnt(5)
    v_mfma_f32_16x16x32_bf16 v[64:67], v[208:211], v[24:27], v[64:67]
    v_mfma_f32_16x16x32_bf16 v[68:71], v[212:215], v[24:27], v[68:71]
    s_waitcnt vmcnt(4)
    v_mfma_f32_16x16x32_bf16 v[64:67], v[216:219], v[28:31], v[64:67]
    v_mfma_f32_16x16x32_bf16 v[68:71], v[220:223], v[28:31], v[68:71]
    s_waitcnt vmcnt(3)
    v_mfma_f32_16x16x32_bf16 v[64:67], v[224:227], v[32:35], v[64:67]
    v_mfma_f32_16x16x32_bf16 v[68:71], v[228:231], v[32:35], v[68:71]
    s_waitcnt vmcnt(2)
    v_mfma_f32_16x16x32_bf16 v[64:67], v[232:235], v[36:39], v[64:67]
    v_mfma_f32_16x16x32_bf16 v[68:71], v[236:239], v[36:39], v[68:71]
    s_waitcnt vmcnt(1)
    v_mfma_f32_16x16x32_bf16 v[64:67], v[240:243], v[40:43], v[64:67]
    v_mfma_f32_16x16x32_bf16 v[68:71], v[244:247], v[40:43], v[68:71]
    s_waitcnt vmcnt(0)
    v_mfma_f32_16x16x32_bf16 v[64:67], v[248:251], v[44:47], v[64:67]
    v_mfma_f32_16x16x32_bf16 v[68:71], v[252:255], v[44:47], v[68:71]
    v_add_u32 v4, 147456, v1
    s_waitcnt lgkmcnt(0)
    v_mfma_f32_16x16x32_bf16 v[64:67], v[184:187], v[80:83], v[64:67]
    v_mfma_f32_16x16x32_bf16 v[68:71], v[188:191], v[80:83], v[68:71]
.Lspin_33:
    ds_read_b32 v6, v5
    s_waitcnt lgkmcnt(0)
    v_cmp_gt_u32 vcc, 3, v6
    s_cbranch_vccnz .Lspin_33
    ds_read_b128 v[24:27], v4 offset:2048
    ds_read_b128 v[28:31], v4 offset:3072
    ds_read_b128 v[32:35], v4 offset:4096
    ds_read_b128 v[36:39], v4 offset:5120
    ds_read_b128 v[40:43], v4 offset:6144
    ds_read_b128 v[44:47], v4 offset:7168
    s_lshl_b32 s42, s45, 12
    s_add_u32 s42, s42, s40
    s_add_u32 s42, s42, 0x1c00000
    s_bfe_u32 s43, s23, 0x10001
    s_waitcnt lgkmcnt(0)
    v_add_f32 v16, v64, v24
    v_add_f32 v32, v32, v40
    v_add_f32 v17, v65, v25
    v_add_f32 v33, v33, v41
    v_add_f32 v18, v66, v26
    v_add_f32 v34, v34, v42
    v_add_f32 v19, v67, v27
    v_add_f32 v35, v35, v43
    v_add_f32 v20, v68, v28
    v_add_f32 v36, v36, v44
    v_add_f32 v21, v69, v29
    v_add_f32 v37, v37, v45
    v_add_f32 v22, v70, v30
    v_add_f32 v38, v38, v46
    v_add_f32 v23, v71, v31
    v_add_f32 v39, v39, v47
    v_add_f32 v16, v16, v32
    v_add_f32 v17, v17, v33
    v_add_f32 v18, v18, v34
    v_add_f32 v19, v19, v35
    v_add_f32 v20, v20, v36
    v_add_f32 v21, v21, v37
    v_add_f32 v22, v22, v38
    v_add_f32 v23, v23, v39
    v_mul_f32 v16, v16, v51
    v_mul_f32 v17, v17, v51
    v_mul_f32 v18, v18, v51
    v_mul_f32 v19, v19, v51
    v_mul_f32 v20, v20, v51
    v_mul_f32 v21, v21, v51
    v_mul_f32 v22, v22, v51
    v_mul_f32 v23, v23, v51
    v_cvt_pk_bf16_f32 v88, v16, v17
    v_cvt_pk_bf16_f32 v89, v18, v19
    v_cvt_pk_bf16_f32 v90, v20, v21
    v_cvt_pk_bf16_f32 v91, v22, v23
    v_and_b32 v4, 15, v0
    v_bfe_u32 v5, v0, 4, 1
    v_lshrrev_b32 v6, 5, v0
    s_bitcmp1_b32 s23, 0
    s_cbranch_scc1 .Lisv_30
    s_lshl_b32 s43, s43, 8
    s_add_u32 s42, s42, s43
    v_lshlrev_b32 v4, 4, v4
    v_lshl_add_u32 v4, v5, 10, v4
    v_lshl_add_u32 v4, v6, 9, v4
    buffer_store_dwordx4 v[88:91], v4, s[24:27], s42 offen sc1
    s_branch .Lkvfin_31
.Lisv_30:
    s_lshl_b32 s43, s43, 10
    s_add_u32 s42, s42, s43
    v_lshlrev_b32 v4, 6, v4
    v_lshrrev_b32 v10, 4, v0
    v_lshl_add_u32 v4, v10, 3, v4
    v_add_u32 v4, 147456, v4
    ds_write_b64 v4, v[88:89]
    ds_write_b64 v4, v[90:91] offset:32
    v_bfe_u32 v4, v0, 2, 2
    v_lshl_add_u32 v4, v6, 3, v4
    v_lshlrev_b32 v4, 6, v4
    v_lshl_add_u32 v4, v5, 5, v4
    v_and_b32 v10, 3, v0
    v_lshl_add_u32 v4, v10, 3, v4
    v_add_u32 v4, 147456, v4
    s_waitcnt lgkmcnt(0)
    ds_read_b64_tr_b16 v[92:93], v4
    ds_read_b64_tr_b16 v[94:95], v4 offset:256
    s_waitcnt lgkmcnt(0)
    buffer_store_dwordx4 v[92:95], v1, s[24:27], s42 offen offset:2048 sc1
.Lkvfin_31:
    s_cmp_lg_u32 s41, 0
    s_cbranch_scc1 .Lseen_36
    v_min_u32 v13, 3, v0
    v_lshlrev_b32 v13, 2, v13
    v_add_u32 v13, 128, v13
    s_mov_b32 s58, 0x40000
.Linit_37:
    buffer_load_dword v15, v13, s[68:71], 0 offen sc1
    s_waitcnt vmcnt(0)
    v_cmp_eq_u32 vcc, 0, v15
    s_cbranch_vccz .Linitok_38
    s_sub_u32 s58, s58, 1
    s_cbranch_scc0 .Linit_37
.Linitok_38:
.Lseen_36:
    v_mul_u32_u24 v4, 20480, v0
    v_mov_b32 v5, 1
    s_mul_i32 s47, s22, 1280
    s_add_u32 s47, s47, s40
    s_add_u32 s47, s47, 0x1cd4000
    s_waitcnt vmcnt(0)
    s_mov_b64 exec, 0xffff
    buffer_atomic_add v5, v4, s[24:27], s47 offen sc1
    s_mov_b64 exec, -1
    s_cmp_lg_u32 s41, 0
    s_cbranch_scc1 .Lnotfirst_39
    s_barrier
.Lnotfirst_39:
.Lkvdone_29:
    s_cmp_lg_u32 s41, 0
    s_cbranch_scc1 .Lhave_40
    s_lshr_b32 s43, s22, 1
    s_lshl_b32 s43, s43, 3
    s_and_b32 s42, s22, 1
    s_add_u32 s43, s43, s42
    s_lshl_b32 s43, s43, 11
    s_add_u32 s43, s43, s55
    v_add_u32 v7, s43, v1
    s_mul_i32 s42, s23, 131072
    s_add_u32 s43, s43, s42
    ds_read_b128 v[88:91], v7 offset:0
    ds_read_b128 v[92:95], v7 offset:1024
    ds_read_b64_tr_b16 v[128:129], v96 offset:0
    ds_read_b64_tr_b16 v[130:131], v96 offset:2048
    ds_read_b64_tr_b16 v[132:133], v97 offset:0
    ds_read_b64_tr_b16 v[134:135], v97 offset:2048
    ds_read_b64_tr_b16 v[136:137], v98 offset:0
    ds_read_b64_tr_b16 v[138:139], v98 offset:2048
    ds_read_b64_tr_b16 v[140:141], v99 offset:0
    ds_read_b64_tr_b16 v[142:143], v99 offset:2048
    ds_read_b64_tr_b16 v[144:145], v96 offset:16384
    ds_read_b64_tr_b16 v[146:147], v96 offset:18432
    ds_read_b64_tr_b16 v[148:149], v97 offset:16384
    ds_read_b64_tr_b16 v[150:151], v97 offset:18432
    s_waitcnt lgkmcnt(10)
    v_mfma_f32_16x16x32_bf16 v[112:115], v[104:107], v[128:131], v[112:115]
    ds_read_b64_tr_b16 v[152:153], v98 offset:16384
    ds_read_b64_tr_b16 v[154:155], v98 offset:18432
    s_waitcnt lgkmcnt(10)
    v_mfma_f32_16x16x32_bf16 v[116:119], v[104:107], v[132:135], v[116:119]
    ds_read_b64_tr_b16 v[156:157], v99 offset:16384
    ds_read_b64_tr_b16 v[158:159], v99 offset:18432
    s_waitcnt lgkmcnt(10)
    v_mfma_f32_16x16x32_bf16 v[120:123], v[104:107], v[136:139], v[120:123]
    ds_read_b64_tr_b16 v[128:129], v96 offset:32768
    ds_read_b64_tr_b16 v[130:131], v96 offset:34816
    s_waitcnt lgkmcnt(10)
    v_mfma_f32_16x16x32_bf16 v[124:127], v[104:107], v[140:143], v[124:127]
    ds_read_b64_tr_b16 v[132:133], v97 offset:32768
    ds_read_b64_tr_b16 v[134:135], v97 offset:34816
    s_waitcnt lgkmcnt(10)
    v_mfma_f32_16x16x32_bf16 v[112:115], v[104:107], v[144:147], v[112:115]
    ds_read_b64_tr_b16 v[136:137], v98 offset:32768
    ds_read_b64_tr_b16 v[138:139], v98 offset:34816
    s_waitcnt lgkmcnt(10)
    v_mfma_f32_16x16x32_bf16 v[116:119], v[104:107], v[148:151], v[116:119]
    ds_read_b64_tr_b16 v[140:141], v99 offset:32768
    ds_read_b64_tr_b16 v[142:143], v99 offset:34816
    s_waitcnt lgkmcnt(10)
    v_mfma_f32_16x16x32_bf16 v[120:123], v[104:107], v[152:155], v[120:123]
    ds_read_b64_tr_b16 v[144:145], v96 offset:49152
    ds_read_b64_tr_b16 v[146:147], v96 offset:51200
    s_waitcnt lgkmcnt(10)
    v_mfma_f32_16x16x32_bf16 v[124:127], v[104:107], v[156:159], v[124:127]
    ds_read_b64_tr_b16 v[148:149], v97 offset:49152
    ds_read_b64_tr_b16 v[150:151], v97 offset:51200
    s_waitcnt lgkmcnt(10)
    v_mfma_f32_16x16x32_bf16 v[112:115], v[104:107], v[128:131], v[112:115]
    ds_read_b64_tr_b16 v[152:153], v98 offset:49152
    ds_read_b64_tr_b16 v[154:155], v98 offset:51200
    s_waitcnt lgkmcnt(10)
    v_mfma_f32_16x16x32_bf16 v[116:119], v[104:107], v[132:135], v[116:119]
    ds_read_b64_tr_b16 v[156:157], v99 offset:49152
    ds_read_b64_tr_b16 v[158:159], v99 offset:51200
    s_waitcnt lgkmcnt(10)
    v_mfma_f32_16x16x32_bf16 v[120:123], v[104:107], v[136:139], v[120:123]
    s_waitcnt lgkmcnt(8)
    v_mfma_f32_16x16x32_bf16 v[124:127], v[104:107], v[140:143], v[124:127]
    s_waitcnt lgkmcnt(6)
    v_mfma_f32_16x16x32_bf16 v[112:115], v[104:107], v[144:147], v[112:115]
    s_waitcnt lgkmcnt(4)
    v_mfma_f32_16x16x32_bf16 v[116:119], v[104:107], v[148:151], v[116:119]
    s_waitcnt lgkmcnt(2)
    v_mfma_f32_16x16x32_bf16 v[120:123], v[104:107], v[152:155], v[120:123]
    s_waitcnt lgkmcnt(0)
    v_mfma_f32_16x16x32_bf16 v[124:127], v[104:107], v[156:159], v[124:127]
    buffer_store_dwordx4 v[88:91], v1, s[24:27], s43 offen offset:0 sc1
    buffer_store_dwordx4 v[92:95], v1, s[24:27], s43 offen offset:1024 sc1
    v_mov_b32 v163, 0
    v_mov_b32 v167, 0
    v_mov_b32 v171, 0
    v_mov_b32 v175, 0
    v_and_b32 v115, s54, v112
    v_sub_f32 v113, v112, v115
    v_and_b32 v115, s54, v113
    v_sub_f32 v114, v113, v115
    v_perm_b32 v160, v112, v112, s53
    v_perm_b32 v161, v113, v113, s53
    v_perm_b32 v162, v114, v112, s53
    v_and_b32 v119, s54, v116
    v_sub_f32 v117, v116, v119
    v_and_b32 v119, s54, v117
    v_sub_f32 v118, v117, v119
    v_perm_b32 v164, v116, v116, s53
    v_perm_b32 v165, v117, v117, s53
    v_perm_b32 v166, v118, v116, s53
    v_and_b32 v123, s54, v120
    v_sub_f32 v121, v120, v123
    v_and_b32 v123, s54, v121
    v_sub_f32 v122, v121, v123
    v_perm_b32 v168, v120, v120, s53
    v_perm_b32 v169, v121, v121, s53
    v_perm_b32 v170, v122, v120, s53
    v_and_b32 v127, s54, v124
    v_sub_f32 v125, v124, v127
    v_and_b32 v127, s54, v125
    v_sub_f32 v126, v125, v127
    v_perm_b32 v172, v124, v124, s53
    v_perm_b32 v173, v125, v125, s53
    v_perm_b32 v174, v126, v124, s53
.Lhave_40:
    v_add_u32 v4, 159744, v1
    s_mov_b64 exec, s[62:63]
    ds_write_b128 v4, v[160:163] offset:0
    ds_write_b128 v4, v[164:167] offset:1024
    ds_write_b128 v4, v[168:171] offset:2048
    ds_write_b128 v4, v[172:175] offset:3072
    s_mov_b64 exec, -1
    s_waitcnt lgkmcnt(0)
    s_barrier
    s_cmp_lg_u32 s21, 1
    s_cbranch_scc1 .Lnopoll_41
    v_mul_u32_u24 v4, 1280, v0
    s_lshl_b32 s42, s22, 4
    s_mul_i32 s47, s42, 1280
    s_add_u32 s47, s47, s40
    s_add_u32 s47, s47, 0x1cd4000
    s_mov_b32 s58, 0x40000
    s_mov_b64 exec, 0xffff
.Lpoll_42:
    v_mov_b32 v15, 0
    buffer_atomic_add v15, v4, s[24:27], s47 offen sc0 sc1
    s_waitcnt vmcnt(0)
    v_cmp_gt_u32 vcc, 16, v15
    s_cbranch_vccz .Lpollok_43
    s_sub_u32 s58, s58, 1
    s_cbranch_scc0 .Lpoll_42
.Lpollok_43:
    s_mov_b64 exec, -1
    s_mov_b32 m0, 131072
    s_mov_b32 s42, 0
    buffer_load_dwordx4 v1, s[28:31], s42 offen offset:0 sc1 lds
    buffer_load_dwordx4 v1, s[28:31], s42 offen offset:1024 sc1 lds
    buffer_load_dwordx4 v1, s[28:31], s42 offen offset:2048 sc1 lds
    buffer_load_dwordx4 v1, s[28:31], s42 offen offset:3072 sc1 lds
    s_mov_b32 m0, 135168
    s_mov_b32 s42, 4096
    buffer_load_dwordx4 v1, s[28:31], s42 offen offset:0 sc1 lds
    buffer_load_dwordx4 v1, s[28:31], s42 offen offset:1024 sc1 lds
    buffer_load_dwordx4 v1, s[28:31], s42 offen offset:2048 sc1 lds
    buffer_load_dwordx4 v1, s[28:31], s42 offen offset:3072 sc1 lds
    s_mov_b32 m0, 139264
    s_mov_b32 s42, 8192
    buffer_load_dwordx4 v1, s[28:31], s42 offen offset:0 sc1 lds
    buffer_load_dwordx4 v1, s[28:31], s42 offen offset:1024 sc1 lds
    buffer_load_dwordx4 v1, s[28:31], s42 offen offset:2048 sc1 lds
    buffer_load_dwordx4 v1, s[28:31], s42 offen offset:3072 sc1 lds
    s_mov_b32 m0, 143360
    s_mov_b32 s42, 12288
    buffer_load_dwordx4 v1, s[28:31], s42 offen offset:0 sc1 lds
    buffer_load_dwordx4 v1, s[28:31], s42 offen offset:1024 sc1 lds
    buffer_load_dwordx4 v1, s[28:31], s42 offen offset:2048 sc1 lds
    buffer_load_dwordx4 v1, s[28:31], s42 offen offset:3072 sc1 lds
    s_waitcnt vmcnt(0)
.Lnopoll_41:
    s_barrier
    s_setprio 3
    s_cmp_lg_u32 s41, 0
    s_cbranch_scc1 .Lplain_44
    s_add_u32 m0, s55, 147456
    s_add_u32 s42, s55, 16384
    buffer_load_dwordx4 v1, s[28:31], s42 offen offset:0 sc1 lds
    buffer_load_dwordx4 v1, s[28:31], s42 offen offset:1024 sc1 lds
    buffer_load_dwordx4 v1, s[28:31], s42 offen offset:2048 sc1 lds
    buffer_load_dwordx4 v1, s[28:31], s42 offen offset:3072 sc1 lds
    s_add_u32 m0, s55, 98304
    s_add_u32 s42, s55, 32768
    buffer_load_dwordx4 v1, s[28:31], s42 offen offset:0 sc1 lds
    buffer_load_dwordx4 v1, s[28:31], s42 offen offset:1024 sc1 lds
    buffer_load_dwordx4 v1, s[28:31], s42 offen offset:2048 sc1 lds
    buffer_load_dwordx4 v1, s[28:31], s42 offen offset:3072 sc1 lds
    s_mov_b32 s75, 14336
    s_sub_u32 s45, s2, 224
    s_cselect_b32 s45, s2, s45
    s_mov_b32 s64, s16
    s_mov_b32 s65, s17
    s_mov_b32 s66, 0x700000
    s_mov_b32 s67, 0x20000
    s_lshr_b32 s43, s45, 2
    s_and_b32 s78, s45, 3
    s_lshl_b32 s44, s78, 2
    s_add_u32 s44, s44, s21
    s_mul_i32 s73, s44, 458752
    s_lshl_b32 s44, s43, 7
    s_add_u32 s73, s73, s44
    s_lshl_b32 s43, s43, 2
    s_add_u32 s43, s43, s21
    s_lshl_b32 s77, s43, 5
    s_mul_hi_u32 s44, s43, 306783379
    s_mul_i32 s45, s44, 14
    s_sub_u32 s45, s43, s45
    s_mov_b32 s56, s44
    s_mul_i32 s44, s44, 462
    s_add_u32 s44, s44, s45
    s_lshl_b32 s44, s44, 10
    s_add_u32 s44, s44, 0x500000
    s_add_u32 s76, s44, 458752
    s_mov_b32 s57, s44
    s_mul_i32 s42, s21, 8192
    s_add_u32 m0, s42, 0
    s_nop 0
    buffer_load_dwordx4 v100, s[64:67], s73 offen  lds
    s_add_u32 s73, s73, 57344
    s_add_u32 m0, s42, 1024
    s_nop 0
    buffer_load_dwordx4 v100, s[64:67], s73 offen  lds
    s_add_u32 s73, s73, 57344
    buffer_load_ushort v14, v103, s[88:91], s77 offen
    s_waitcnt vmcnt(7)
    s_barrier
    s_add_u32 m0, s55, 114688
    s_add_u32 s42, s55, 49152
    buffer_load_dwordx4 v1, s[28:31], s42 offen offset:0 sc1 lds
    buffer_load_dwordx4 v1, s[28:31], s42 offen offset:1024 sc1 lds
    buffer_load_dwordx4 v1, s[28:31], s42 offen offset:2048 sc1 lds
    buffer_load_dwordx4 v1, s[28:31], s42 offen offset:3072 sc1 lds
    s_mul_i32 s42, s21, 8192
    s_add_u32 m0, s42, 2048
    s_nop 0
    buffer_load_dwordx4 v100, s[64:67], s73 offen  lds
    s_add_u32 s73, s73, 57344
    s_add_u32 m0, s42, 3072
    s_nop 0
    buffer_load_dwordx4 v100, s[64:67], s73 offen  lds
    s_add_u32 s73, s73, 57344
    s_waitcnt vmcnt(9)
    s_barrier
    s_add_u32 m0, s55, 131072
    s_add_u32 s42, s55, 65536
    buffer_load_dwordx4 v1, s[28:31], s42 offen offset:0 sc1 lds
    buffer_load_dwordx4 v1, s[28:31], s42 offen offset:1024 sc1 lds
    buffer_load_dwordx4 v1, s[28:31], s42 offen offset:2048 sc1 lds
    buffer_load_dwordx4 v1, s[28:31], s42 offen offset:3072 sc1 lds
    s_mul_i32 s42, s21, 8192
    s_add_u32 m0, s42, 4096
    s_nop 0
    buffer_load_dwordx4 v100, s[64:67], s73 offen  lds
    s_add_u32 s73, s73, 57344
    s_add_u32 m0, s42, 5120
    s_nop 0
    buffer_load_dwordx4 v100, s[64:67], s73 offen  lds
    s_add_u32 s73, s73, 57344
    s_lshl_b32 s42, s59, 15
    s_lshl_b32 s43, s23, 7
    s_add_u32 s42, s42, s43
    v_lshlrev_b32 v9, 10, v103
    buffer_load_dword v11, v9, s[36:39], s42 offen
    s_waitcnt vmcnt(9)
    s_barrier
    s_add_u32 m0, s55, 147456
    s_add_u32 s42, s55, 81920
    buffer_load_dwordx4 v1, s[28:31], s42 offen offset:0 sc1 lds
    buffer_load_dwordx4 v1, s[28:31], s42 offen offset:1024 sc1 lds
    buffer_load_dwordx4 v1, s[28:31], s42 offen offset:2048 sc1 lds
    buffer_load_dwordx4 v1, s[28:31], s42 offen offset:3072 sc1 lds
    s_mul_i32 s42, s21, 8192
    s_add_u32 m0, s42, 6144
    s_nop 0
    buffer_load_dwordx4 v100, s[64:67], s73 offen  lds
    s_add_u32 s73, s73, 57344
    s_add_u32 m0, s42, 7168
    s_nop 0
    buffer_load_dwordx4 v100, s[64:67], s73 offen  lds
    s_add_u32 s73, s73, 57344
    s_waitcnt vmcnt(9)
    s_barrier
    s_add_u32 m0, s55, 98304
    s_add_u32 s42, s55, 98304
    buffer_load_dwordx4 v1, s[28:31], s42 offen offset:0 sc1 lds
    buffer_load_dwordx4 v1, s[28:31], s42 offen offset:1024 sc1 lds
    buffer_load_dwordx4 v1, s[28:31], s42 offen offset:2048 sc1 lds
    buffer_load_dwordx4 v1, s[28:31], s42 offen offset:3072 sc1 lds
    s_mov_b32 s75, 14336
    s_sub_u32 s45, s2, 224
    s_cselect_b32 s45, s2, s45
    s_mov_b32 s64, s14
    s_mov_b32 s65, s15
    s_mov_b32 s66, 0x700000
    s_mov_b32 s67, 0x20000
    s_and_b32 s43, s2, 15
    s_lshr_b32 s78, s2, 4
    s_lshl_b32 s44, s78, 2
    s_add_u32 s44, s44, s21
    s_mul_i32 s73, s44, 114688
    s_lshl_b32 s44, s43, 7
    s_add_u32 s73, s73, s44
    s_and_b32 s44, s78, 1
    s_and_b32 s45, s43, 14
    s_add_u32 s45, s45, s44
    s_mul_i32 s74, s45, 458752
    s_cmp_eq_u32 s45, s43
    s_cselect_b32 s44, 4, 0
    s_add_u32 s44, s44, s21
    s_lshr_b32 s45, s78, 1
    s_lshr_b32 s43, s43, 1
    s_cmp_gt_u32 s45, s43
    s_cselect_b32 s46, 6, 7
    s_add_u32 s46, s46, s45
    s_and_b32 s76, s44, 4
    s_mul_i32 s76, s76, 13
    s_add_u32 s76, s76, 28
    s_lshl_b32 s42, s46, 2
    s_sub_u32 s76, s76, s42
    s_lshl_b32 s76, s76, 10
    s_cmp_eq_u32 s45, s43
    s_cselect_b32 s76, 0, s76
    s_cselect_b32 s46, 0, s46
    s_cselect_b32 s75, 8, 56
    s_lshl_b32 s75, s75, 10
    s_lshl_b32 s46, s46, 3
    s_add_u32 s44, s44, s46
    s_lshl_b32 s44, s44, 10
    s_add_u32 s74, s74, s44
    s_add_u32 s74, s74, 0xd00000
    s_mul_i32 s42, s21, 7168
    s_add_u32 m0, s42, 32768
    s_nop 0
    buffer_load_dwordx4 v101, s[64:67], s73 offen  lds
    s_add_u32 s73, s73, 16384
    s_add_u32 m0, s42, 33792
    s_nop 0
    buffer_load_dwordx4 v101, s[64:67], s73 offen  lds
    s_add_u32 s73, s73, 16384
    s_waitcnt vmcnt(8)
    s_barrier
    s_add_u32 m0, s55, 114688
    s_add_u32 s42, s55, 114688
    buffer_load_dwordx4 v1, s[28:31], s42 offen offset:0 sc1 lds
    buffer_load_dwordx4 v1, s[28:31], s42 offen offset:1024 sc1 lds
    buffer_load_dwordx4 v1, s[28:31], s42 offen offset:2048 sc1 lds
    buffer_load_dwordx4 v1, s[28:31], s42 offen offset:3072 sc1 lds
    s_mul_i32 s42, s21, 7168
    s_add_u32 m0, s42, 34816
    s_nop 0
    buffer_load_dwordx4 v101, s[64:67], s73 offen  lds
    s_add_u32 s73, s73, 16384
    s_add_u32 m0, s42, 35840
    s_nop 0
    buffer_load_dwordx4 v101, s[64:67], s73 offen  lds
    s_add_u32 s73, s73, 16384
    s_waitcnt vmcnt(8)
    s_barrier
    s_add_u32 m0, s55, 131072
    s_add_u32 s42, s55, 131072
    buffer_load_dwordx4 v1, s[28:31], s42 offen offset:0 sc1 lds
    buffer_load_dwordx4 v1, s[28:31], s42 offen offset:1024 sc1 lds
    buffer_load_dwordx4 v1, s[28:31], s42 offen offset:2048 sc1 lds
    buffer_load_dwordx4 v1, s[28:31], s42 offen offset:3072 sc1 lds
    s_mul_i32 s42, s21, 7168
    s_add_u32 m0, s42, 36864
    s_nop 0
    buffer_load_dwordx4 v101, s[64:67], s73 offen  lds
    s_add_u32 s73, s73, 16384
    s_add_u32 m0, s42, 37888
    s_nop 0
    buffer_load_dwordx4 v101, s[64:67], s73 offen  lds
    s_add_u32 s73, s73, 16384
    s_waitcnt vmcnt(8)
    s_barrier
    s_add_u32 m0, s55, 147456
    s_add_u32 s42, s55, 147456
    buffer_load_dwordx4 v1, s[28:31], s42 offen offset:0 sc1 lds
    buffer_load_dwordx4 v1, s[28:31], s42 offen offset:1024 sc1 lds
    buffer_load_dwordx4 v1, s[28:31], s42 offen offset:2048 sc1 lds
    buffer_load_dwordx4 v1, s[28:31], s42 offen offset:3072 sc1 lds
    s_mul_i32 s42, s21, 7168
    s_add_u32 m0, s42, 38912
    s_nop 0
    buffer_load_dwordx4 v101, s[64:67], s73 offen  lds
    s_add_u32 s73, s73, 16384
    s_waitcnt vmcnt(7)
    s_barrier
    s_add_u32 m0, s55, 98304
    s_add_u32 s42, s55, 163840
    buffer_load_dwordx4 v1, s[28:31], s42 offen offset:0 sc1 lds
    buffer_load_dwordx4 v1, s[28:31], s42 offen offset:1024 sc1 lds
    buffer_load_dwordx4 v1, s[28:31], s42 offen offset:2048 sc1 lds
    buffer_load_dwordx4 v1, s[28:31], s42 offen offset:3072 sc1 lds
    s_mov_b32 s75, 14336
    s_sub_u32 s45, s2, 224
    s_cselect_b32 s45, s2, s45
    s_mov_b32 s64, s16
    s_mov_b32 s65, s17
    s_mov_b32 s66, 0x700000
    s_mov_b32 s67, 0x20000
    s_lshr_b32 s43, s45, 2
    s_and_b32 s78, s45, 3
    s_lshl_b32 s44, s78, 2
    s_add_u32 s44, s44, s21
    s_mul_i32 s73, s44, 458752
    s_lshl_b32 s44, s43, 7
    s_add_u32 s73, s73, s44
    s_lshl_b32 s43, s43, 2
    s_add_u32 s43, s43, s21
    s_lshl_b32 s77, s43, 5
    s_mul_hi_u32 s44, s43, 306783379
    s_mul_i32 s45, s44, 14
    s_sub_u32 s45, s43, s45
    s_mov_b32 s56, s44
    s_mul_i32 s44, s44, 462
    s_add_u32 s44, s44, s45
    s_lshl_b32 s44, s44, 10
    s_add_u32 s44, s44, 0x500000
    s_add_u32 s76, s44, 458752
    s_mov_b32 s57, s44
    ds_read_b64_tr_b16 v[16:17], v102 offset:0
    ds_read_b64_tr_b16 v[18:19], v102 offset:2048
    ds_read_b64_tr_b16 v[20:21], v102 offset:4096
    ds_read_b64_tr_b16 v[22:23], v102 offset:6144
    ds_read_b64_tr_b16 v[24:25], v102 offset:8192
    ds_read_b64_tr_b16 v[26:27], v102 offset:10240
    ds_read_b64_tr_b16 v[28:29], v102 offset:12288
    ds_read_b64_tr_b16 v[30:31], v102 offset:14336
    ds_read_b64_tr_b16 v[32:33], v102 offset:16384
    ds_read_b64_tr_b16 v[34:35], v102 offset:18432
    ds_read_b64_tr_b16 v[36:37], v102 offset:20480
    ds_read_b64_tr_b16 v[38:39], v102 offset:22528
    s_waitcnt lgkmcnt(4)
    ds_read_b64_tr_b16 v[40:41], v102 offset:24576
    ds_read_b64_tr_b16 v[42:43], v102 offset:26624
    ds_read_b64_tr_b16 v[44:45], v102 offset:28672
    ds_read_b64_tr_b16 v[46:47], v102 offset:30720
    s_lshl_b32 s43, s78, 2
    s_add_u32 s43, s43, 0
    s_cmp_lt_u32 s43, s56
    s_addc_u32 s44, s43, 0
    s_cmp_eq_u32 s43, s56
    s_cselect_b32 s44, 0, s44
    s_mul_i32 s74, s44, 28672
    s_add_u32 s74, s74, s57
    buffer_store_dwordx4 v[16:19], v1, s[24:27], s74 offen sc1
    s_add_u32 s74, s74, s75
    v_mfma_f32_16x16x32_bf16 v[52:55], v[104:107], v[16:19], 0
    buffer_store_dwordx4 v[20:23], v1, s[24:27], s74 offen sc1
    s_add_u32 s74, s74, s75
    v_mfma_f32_16x16x32_bf16 v[52:55], v[104:107], v[20:23], v[52:55]
    s_waitcnt lgkmcnt(0)
    s_waitcnt vmcnt(7)
    s_barrier
    s_add_u32 m0, s55, 114688
    s_add_u32 s42, s55, 180224
    buffer_load_dwordx4 v1, s[28:31], s42 offen offset:0 sc1 lds
    buffer_load_dwordx4 v1, s[28:31], s42 offen offset:1024 sc1 lds
    buffer_load_dwordx4 v1, s[28:31], s42 offen offset:2048 sc1 lds
    buffer_load_dwordx4 v1, s[28:31], s42 offen offset:3072 sc1 lds
    s_lshl_b32 s43, s78, 2
    s_add_u32 s43, s43, 1
    s_cmp_lt_u32 s43, s56
    s_addc_u32 s44, s43, 0
    s_cmp_eq_u32 s43, s56
    s_cselect_b32 s44, 0, s44
    s_mul_i32 s74, s44, 28672
    s_add_u32 s74, s74, s57
    buffer_store_dwordx4 v[24:27], v1, s[24:27], s74 offen sc1
    s_add_u32 s74, s74, s75
    v_mfma_f32_16x16x32_bf16 v[52:55], v[104:107], v[24:27], v[52:55]
    buffer_store_dwordx4 v[28:31], v1, s[24:27], s74 offen sc1
    s_add_u32 s74, s74, s75
    v_mfma_f32_16x16x32_bf16 v[52:55], v[104:107], v[28:31], v[52:55]
    s_lshl_b32 s43, s78, 2
    s_add_u32 s43, s43, 2
    s_cmp_lt_u32 s43, s56
    s_addc_u32 s44, s43, 0
    s_cmp_eq_u32 s43, s56
    s_cselect_b32 s44, 0, s44
    s_mul_i32 s74, s44, 28672
    s_add_u32 s74, s74, s57
    buffer_store_dwordx4 v[32:35], v1, s[24:27], s74 offen sc1
    s_add_u32 s74, s74, s75
    v_mfma_f32_16x16x32_bf16 v[52:55], v[104:107], v[32:35], v[52:55]
    buffer_store_dwordx4 v[36:39], v1, s[24:27], s74 offen sc1
    s_add_u32 s74, s74, s75
    v_mfma_f32_16x16x32_bf16 v[52:55], v[104:107], v[36:39], v[52:55]
    s_lshl_b32 s43, s78, 2
    s_add_u32 s43, s43, 3
    s_cmp_lt_u32 s43, s56
    s_addc_u32 s44, s43, 0
    s_cmp_eq_u32 s43, s56
    s_cselect_b32 s44, 0, s44
    s_mul_i32 s74, s44, 28672
    s_add_u32 s74, s74, s57
    buffer_store_dwordx4 v[40:43], v1, s[24:27], s74 offen sc1
    s_add_u32 s74, s74, s75
    v_mfma_f32_16x16x32_bf16 v[52:55], v[104:107], v[40:43], v[52:55]
    buffer_store_dwordx4 v[44:47], v1, s[24:27], s74 offen sc1
    s_add_u32 s74, s74, s75
    v_mfma_f32_16x16x32_bf16 v[52:55], v[104:107], v[44:47], v[52:55]
    s_lshl_b32 s43, s78, 4
    s_lshl_b64 s[60:61], 0xffff, s43
    v_lshl_or_b32 v59, v14, 16, v14
    s_nop 4
    v_and_b32 v55, s54, v52
    v_sub_f32 v53, v52, v55
    v_and_b32 v55, s54, v53
    v_sub_f32 v54, v53, v55
    v_perm_b32 v56, v52, v52, s53
    v_perm_b32 v57, v53, v53, s53
    v_perm_b32 v58, v54, v52, s53
    s_mov_b64 exec, s[60:61]
    buffer_store_dwordx4 v[56:59], v1, s[24:27], s76 offen sc1
    s_mov_b64 exec, -1
    s_add_u32 s43, s21, 0
    s_cmp_lt_u32 s43, s86
    s_cselect_b32 s42, 2, 0
    s_sub_u32 s43, s43, s42
    s_cselect_b32 s42, s86, 0
    s_add_u32 s43, s43, s42
    s_lshl_b32 s43, s43, 16
    s_add_u32 s43, s43, s87
    s_add_u32 m0, s55, 0
    s_add_u32 s42, s43, 0
    buffer_load_dwordx4 v8, s[36:39], s42 offen lds
    s_add_u32 m0, s55, 1024
    s_add_u32 s42, s43, 16384
    buffer_load_dwordx4 v8, s[36:39], s42 offen lds
    s_add_u32 m0, s55, 2048
    s_add_u32 s42, s43, 32768
    buffer_load_dwordx4 v8, s[36:39], s42 offen lds
    s_add_u32 m0, s55, 3072
    s_add_u32 s42, s43, 49152
    buffer_load_dwordx4 v8, s[36:39], s42 offen lds
    s_waitcnt vmcnt(17)
    s_barrier
    s_add_u32 m0, s55, 131072
    s_add_u32 s42, s55, 196608
    buffer_load_dwordx4 v1, s[28:31], s42 offen offset:0 sc1 lds
    buffer_load_dwordx4 v1, s[28:31], s42 offen offset:1024 sc1 lds
    buffer_load_dwordx4 v1, s[28:31], s42 offen offset:2048 sc1 lds
    buffer_load_dwordx4 v1, s[28:31], s42 offen offset:3072 sc1 lds
    s_mov_b32 s75, 14336
    s_sub_u32 s45, s2, 224
    s_cselect_b32 s45, s2, s45
    s_mov_b32 s64, s14
    s_mov_b32 s65, s15
    s_mov_b32 s66, 0x700000
    s_mov_b32 s67, 0x20000
    s_and_b32 s43, s2, 15
    s_lshr_b32 s78, s2, 4
    s_lshl_b32 s44, s78, 2
    s_add_u32 s44, s44, s21
    s_mul_i32 s73, s44, 114688
    s_lshl_b32 s44, s43, 7
    s_add_u32 s73, s73, s44
    s_and_b32 s44, s78, 1
    s_and_b32 s45, s43, 14
    s_add_u32 s45, s45, s44
    s_mul_i32 s74, s45, 458752
    s_cmp_eq_u32 s45, s43
    s_cselect_b32 s44, 4, 0
    s_add_u32 s44, s44, s21
    s_lshr_b32 s45, s78, 1
    s_lshr_b32 s43, s43, 1
    s_cmp_gt_u32 s45, s43
    s_cselect_b32 s46, 6, 7
    s_add_u32 s46, s46, s45
    s_and_b32 s76, s44, 4
    s_mul_i32 s76, s76, 13
    s_add_u32 s76, s76, 28
    s_lshl_b32 s42, s46, 2
    s_sub_u32 s76, s76, s42
    s_lshl_b32 s76, s76, 10
    s_cmp_eq_u32 s45, s43
    s_cselect_b32 s76, 0, s76
    s_cselect_b32 s46, 0, s46
    s_cselect_b32 s75, 8, 56
    s_lshl_b32 s75, s75, 10
    s_lshl_b32 s46, s46, 3
    s_add_u32 s44, s44, s46
    s_lshl_b32 s44, s44, 10
    s_add_u32 s74, s74, s44
    s_add_u32 s74, s74, 0xd00000
    ds_read_b64_tr_b16 v[16:17], v102 offset:32768
    ds_read_b64_tr_b16 v[18:19], v102 offset:34816
    ds_read_b64_tr_b16 v[20:21], v102 offset:36864
    ds_read_b64_tr_b16 v[22:23], v102 offset:38912
    ds_read_b64_tr_b16 v[24:25], v102 offset:40960
    ds_read_b64_tr_b16 v[26:27], v102 offset:43008
    ds_read_b64_tr_b16 v[28:29], v102 offset:45056
    ds_read_b64_tr_b16 v[30:31], v102 offset:47104
    ds_read_b64_tr_b16 v[32:33], v102 offset:49152
    ds_read_b64_tr_b16 v[34:35], v102 offset:51200
    ds_read_b64_tr_b16 v[36:37], v102 offset:53248
    ds_read_b64_tr_b16 v[38:39], v102 offset:55296
    s_waitcnt lgkmcnt(4)
    ds_read_b64_tr_b16 v[40:41], v102 offset:57344
    ds_read_b64_tr_b16 v[42:43], v102 offset:59392
    buffer_store_dwordx4 v[16:19], v1, s[24:27], s74 offen sc1
    s_add_u32 s74, s74, s75
    buffer_store_dwordx4 v[20:23], v1, s[24:27], s74 offen sc1
    s_add_u32 s74, s74, s75
    s_waitcnt lgkmcnt(0)
    s_add_u32 s43, s21, 4
    s_cmp_lt_u32 s43, s86
    s_cselect_b32 s42, 2, 0
    s_sub_u32 s43, s43, s42
    s_lshl_b32 s43, s43, 16
    s_add_u32 s43, s43, s87
    s_add_u32 m0, s55, 16384
    s_add_u32 s42, s43, 0
    buffer_load_dwordx4 v8, s[36:39], s42 offen lds
    s_add_u32 m0, s55, 17408
    s_add_u32 s42, s43, 16384
    buffer_load_dwordx4 v8, s[36:39], s42 offen lds
    s_add_u32 m0, s55, 18432
    s_add_u32 s42, s43, 32768
    buffer_load_dwordx4 v8, s[36:39], s42 offen lds
    s_add_u32 m0, s55, 19456
    s_add_u32 s42, s43, 49152
    buffer_load_dwordx4 v8, s[36:39], s42 offen lds
    s_waitcnt vmcnt(21)
    s_barrier
    s_add_u32 m0, s55, 147456
    s_add_u32 s42, s55, 212992
    buffer_load_dwordx4 v1, s[28:31], s42 offen offset:0 sc1 lds
    buffer_load_dwordx4 v1, s[28:31], s42 offen offset:1024 sc1 lds
    buffer_load_dwordx4 v1, s[28:31], s42 offen offset:2048 sc1 lds
    buffer_load_dwordx4 v1, s[28:31], s42 offen offset:3072 sc1 lds
    buffer_store_dwordx4 v[24:27], v1, s[24:27], s74 offen sc1
    s_add_u32 s74, s74, s75
    buffer_store_dwordx4 v[28:31], v1, s[24:27], s74 offen sc1
    s_add_u32 s74, s74, s75
    buffer_store_dwordx4 v[32:35], v1, s[24:27], s74 offen sc1
    s_add_u32 s74, s74, s75
    s_add_u32 s74, s74, s76
    s_min_u32 s75, s75, 28672
    buffer_store_dwordx4 v[36:39], v1, s[24:27], s74 offen sc1
    s_add_u32 s74, s74, s75
    buffer_store_dwordx4 v[40:43], v1, s[24:27], s74 offen sc1
    s_add_u32 s74, s74, s75
    s_add_u32 s43, s21, 8
    s_cmp_lt_u32 s43, s86
    s_cselect_b32 s42, 2, 0
    s_sub_u32 s43, s43, s42
    s_lshl_b32 s43, s43, 16
    s_add_u32 s43, s43, s87
    s_add_u32 m0, s55, 32768
    s_add_u32 s42, s43, 0
    buffer_load_dwordx4 v8, s[36:39], s42 offen lds
    s_add_u32 m0, s55, 33792
    s_add_u32 s42, s43, 16384
    buffer_load_dwordx4 v8, s[36:39], s42 offen lds
    s_add_u32 m0, s55, 34816
    s_add_u32 s42, s43, 32768
    buffer_load_dwordx4 v8, s[36:39], s42 offen lds
    s_add_u32 m0, s55, 35840
    s_add_u32 s42, s43, 49152
    buffer_load_dwordx4 v8, s[36:39], s42 offen lds
    s_waitcnt vmcnt(19)
    s_barrier
    s_add_u32 m0, s55, 98304
    s_add_u32 s42, s55, 229376
    buffer_load_dwordx4 v1, s[28:31], s42 offen offset:0 sc1 lds
    buffer_load_dwordx4 v1, s[28:31], s42 offen offset:1024 sc1 lds
    buffer_load_dwordx4 v1, s[28:31], s42 offen offset:2048 sc1 lds
    buffer_load_dwordx4 v1, s[28:31], s42 offen offset:3072 sc1 lds
    s_lshr_b32 s42, s2, 3
    s_lshl_b32 s42, s42, 11
    v_and_b32 v9, 15, v0
    v_lshl_add_u32 v9, v9, 7, s42
    v_min_u32 v9, .Lcode_end - .Lcode_pc - 4, v9
    global_load_dword v11, v9, s[100:101]
    s_add_u32 s43, s21, 12
    s_cmp_lt_u32 s43, s86
    s_cselect_b32 s42, 2, 0
    s_sub_u32 s43, s43, s42
    s_lshl_b32 s43, s43, 16
    s_add_u32 s43, s43, s87
    s_add_u32 m0, s55, 49152
    s_add_u32 s42, s43, 0
    buffer_load_dwordx4 v8, s[36:39], s42 offen lds
    s_add_u32 m0, s55, 50176
    s_add_u32 s42, s43, 16384
    buffer_load_dwordx4 v8, s[36:39], s42 offen lds
    s_add_u32 m0, s55, 51200
    s_add_u32 s42, s43, 32768
    buffer_load_dwordx4 v8, s[36:39], s42 offen lds
    s_add_u32 m0, s55, 52224
    s_add_u32 s42, s43, 49152
    buffer_load_dwordx4 v8, s[36:39], s42 offen lds
    s_waitcnt vmcnt(12)
    s_barrier
    s_cmp_lg_u32 s21, 0
    s_cbranch_scc1 .Lnod_46
    s_mul_i32 s47, s22, 1280
    s_add_u32 s47, s47, s40
    s_add_u32 s47, s47, 0x1d60000
    v_mov_b32 v15, 1
    s_mov_b64 exec, 1
    buffer_atomic_add v15, v2, s[24:27], s47 offen sc0 sc1
    s_mov_b64 exec, -1
.Lnod_46:
    s_add_u32 m0, s55, 114688
    s_add_u32 s42, s55, 245760
    buffer_load_dwordx4 v1, s[28:31], s42 offen offset:0 sc1 lds
    buffer_load_dwordx4 v1, s[28:31], s42 offen offset:1024 sc1 lds
    buffer_load_dwordx4 v1, s[28:31], s42 offen offset:2048 sc1 lds
    buffer_load_dwordx4 v1, s[28:31], s42 offen offset:3072 sc1 lds
    s_add_u32 s43, s21, 16
    s_cmp_lt_u32 s43, s86
    s_cselect_b32 s42, 2, 0
    s_sub_u32 s43, s43, s42
    s_lshl_b32 s43, s43, 16
    s_add_u32 s43, s43, s87
    s_add_u32 m0, s55, 65536
    s_add_u32 s42, s43, 0
    buffer_load_dwordx4 v8, s[36:39], s42 offen lds
    s_add_u32 m0, s55, 66560
    s_add_u32 s42, s43, 16384
    buffer_load_dwordx4 v8, s[36:39], s42 offen lds
    s_add_u32 m0, s55, 67584
    s_add_u32 s42, s43, 32768
    buffer_load_dwordx4 v8, s[36:39], s42 offen lds
    s_add_u32 m0, s55, 68608
    s_add_u32 s42, s43, 49152
    buffer_load_dwordx4 v8, s[36:39], s42 offen lds
    s_waitcnt vmcnt(12)
    s_barrier
    s_add_u32 s43, s21, 20
    s_cmp_lt_u32 s43, s86
    s_cselect_b32 s42, 2, 0
    s_sub_u32 s43, s43, s42
    s_lshl_b32 s43, s43, 16
    s_add_u32 s43, s43, s87
    s_add_u32 m0, s55, 81920
    s_add_u32 s42, s43, 0
    buffer_load_dwordx4 v8, s[36:39], s42 offen lds
    s_add_u32 m0, s55, 82944
    s_add_u32 s42, s43, 16384
    buffer_load_dwordx4 v8, s[36:39], s42 offen lds
    s_add_u32 m0, s55, 83968
    s_add_u32 s42, s43, 32768
    buffer_load_dwordx4 v8, s[36:39], s42 offen lds
    s_add_u32 m0, s55, 84992
    s_add_u32 s42, s43, 49152
    buffer_load_dwordx4 v8, s[36:39], s42 offen lds
    s_add_u32 s43, s21, 24
    s_cmp_lt_u32 s43, s86
    s_cselect_b32 s42, 2, 0
    s_sub_u32 s43, s43, s42
    s_lshl_b32 s43, s43, 16
    s_add_u32 s43, s43, s87
    s_add_u32 m0, s55, 131072
    s_add_u32 s42, s43, 0
    buffer_load_dwordx4 v8, s[36:39], s42 offen lds
    s_add_u32 m0, s55, 132096
    s_add_u32 s42, s43, 16384
    buffer_load_dwordx4 v8, s[36:39], s42 offen lds
    s_add_u32 m0, s55, 133120
    s_add_u32 s42, s43, 32768
    buffer_load_dwordx4 v8, s[36:39], s42 offen lds
    s_add_u32 m0, s55, 134144
    s_add_u32 s42, s43, 49152
    buffer_load_dwordx4 v8, s[36:39], s42 offen lds
    s_waitcnt vmcnt(12)
    s_barrier
    s_cmp_lg_u32 s21, 0
    s_cbranch_scc1 .Lnod_47
    v_readfirstlane_b32 s42, v15
    s_nop 0
    s_cmp_lg_u32 s42, 15
    s_cbranch_scc1 .Lnofan_48
    v_mul_u32_u24 v4, 1280, v0
    v_mov_b32 v5, 1
    s_add_u32 s47, s40, 0x1e64000
    buffer_atomic_add v5, v4, s[24:27], s47 offen sc1
    s_mov_b64 exec, -1
.Lnofan_48:
.Lnod_47:
    s_add_u32 s43, s21, 28
    s_cmp_lt_u32 s43, s86
    s_cselect_b32 s42, 2, 0
    s_sub_u32 s43, s43, s42
    s_lshl_b32 s43, s43, 16
    s_add_u32 s43, s43, s87
    s_add_u32 m0, s55, 147456
    s_add_u32 s42, s43, 0
    buffer_load_dwordx4 v8, s[36:39], s42 offen lds
    s_add_u32 m0, s55, 148480
    s_add_u32 s42, s43, 16384
    buffer_load_dwordx4 v8, s[36:39], s42 offen lds
    s_add_u32 m0, s55, 149504
    s_add_u32 s42, s43, 32768
    buffer_load_dwordx4 v8, s[36:39], s42 offen lds
    s_add_u32 m0, s55, 150528
    s_add_u32 s42, s43, 49152
    buffer_load_dwordx4 v8, s[36:39], s42 offen lds
    s_barrier
    s_branch .Lhend_45
.Lplain_44:
    s_add_u32 m0, s55, 147456
    s_add_u32 s42, s55, 16384
    buffer_load_dwordx4 v1, s[28:31], s42 offen offset:0 sc1 lds
    buffer_load_dwordx4 v1, s[28:31], s42 offen offset:1024 sc1 lds
    buffer_load_dwordx4 v1, s[28:31], s42 offen offset:2048 sc1 lds
    buffer_load_dwordx4 v1, s[28:31], s42 offen offset:3072 sc1 lds
    s_add_u32 m0, s55, 98304
    s_add_u32 s42, s55, 32768
    buffer_load_dwordx4 v1, s[28:31], s42 offen offset:0 sc1 lds
    buffer_load_dwordx4 v1, s[28:31], s42 offen offset:1024 sc1 lds
    buffer_load_dwordx4 v1, s[28:31], s42 offen offset:2048 sc1 lds
    buffer_load_dwordx4 v1, s[28:31], s42 offen offset:3072 sc1 lds
    s_waitcnt vmcnt(4)
    s_barrier
    s_add_u32 m0, s55, 114688
    s_add_u32 s42, s55, 49152
    buffer_load_dwordx4 v1, s[28:31], s42 offen offset:0 sc1 lds
    buffer_load_dwordx4 v1, s[28:31], s42 offen offset:1024 sc1 lds
    buffer_load_dwordx4 v1, s[28:31], s42 offen offset:2048 sc1 lds
    buffer_load_dwordx4 v1, s[28:31], s42 offen offset:3072 sc1 lds
    s_waitcnt vmcnt(4)
    s_barrier
    s_add_u32 m0, s55, 131072
    s_add_u32 s42, s55, 65536
    buffer_load_dwordx4 v1, s[28:31], s42 offen offset:0 sc1 lds
    buffer_load_dwordx4 v1, s[28:31], s42 offen offset:1024 sc1 lds
    buffer_load_dwordx4 v1, s[28:31], s42 offen offset:2048 sc1 lds
    buffer_load_dwordx4 v1, s[28:31], s42 offen offset:3072 sc1 lds
    s_waitcnt vmcnt(4)
    s_barrier
    s_add_u32 m0, s55, 147456
    s_add_u32 s42, s55, 81920
    buffer_load_dwordx4 v1, s[28:31], s42 offen offset:0 sc1 lds
    buffer_load_dwordx4 v1, s[28:31], s42 offen offset:1024 sc1 lds
    buffer_load_dwordx4 v1, s[28:31], s42 offen offset:2048 sc1 lds
    buffer_load_dwordx4 v1, s[28:31], s42 offen offset:3072 sc1 lds
    s_waitcnt vmcnt(4)
    s_barrier
    s_add_u32 m0, s55, 98304
    s_add_u32 s42, s55, 98304
    buffer_load_dwordx4 v1, s[28:31], s42 offen offset:0 sc1 lds
    buffer_load_dwordx4 v1, s[28:31], s42 offen offset:1024 sc1 lds
    buffer_load_dwordx4 v1, s[28:31], s42 offen offset:2048 sc1 lds
    buffer_load_dwordx4 v1, s[28:31], s42 offen offset:3072 sc1 lds
    s_waitcnt vmcnt(4)
    s_barrier
    s_add_u32 m0, s55, 114688
    s_add_u32 s42, s55, 114688
    buffer_load_dwordx4 v1, s[28:31], s42 offen offset:0 sc1 lds
    buffer_load_dwordx4 v1, s[28:31], s42 offen offset:1024 sc1 lds
    buffer_load_dwordx4 v1, s[28:31], s42 offen offset:2048 sc1 lds
    buffer_load_dwordx4 v1, s[28:31], s42 offen offset:3072 sc1 lds
    s_waitcnt vmcnt(4)
    s_barrier
    s_add_u32 m0, s55, 131072
    s_add_u32 s42, s55, 131072
    buffer_load_dwordx4 v1, s[28:31], s42 offen offset:0 sc1 lds
    buffer_load_dwordx4 v1, s[28:31], s42 offen offset:1024 sc1 lds
    buffer_load_dwordx4 v1, s[28:31], s42 offen offset:2048 sc1 lds
    buffer_load_dwordx4 v1, s[28:31], s42 offen offset:3072 sc1 lds
    s_waitcnt vmcnt(4)
    s_barrier
    s_add_u32 m0, s55, 147456
    s_add_u32 s42, s55, 147456
    buffer_load_dwordx4 v1, s[28:31], s42 offen offset:0 sc1 lds
    buffer_load_dwordx4 v1, s[28:31], s42 offen offset:1024 sc1 lds
    buffer_load_dwordx4 v1, s[28:31], s42 offen offset:2048 sc1 lds
    buffer_load_dwordx4 v1, s[28:31], s42 offen offset:3072 sc1 lds
    s_waitcnt vmcnt(4)
    s_barrier
    s_add_u32 m0, s55, 98304
    s_add_u32 s42, s55, 163840
    buffer_load_dwordx4 v1, s[28:31], s42 offen offset:0 sc1 lds
    buffer_load_dwordx4 v1, s[28:31], s42 offen offset:1024 sc1 lds
    buffer_load_dwordx4 v1, s[28:31], s42 offen offset:2048 sc1 lds
    buffer_load_dwordx4 v1, s[28:31], s42 offen offset:3072 sc1 lds
    s_waitcnt vmcnt(4)
    s_barrier
    s_add_u32 m0, s55, 114688
    s_add_u32 s42, s55, 180224
    buffer_load_dwordx4 v1, s[28:31], s42 offen offset:0 sc1 lds
    buffer_load_dwordx4 v1, s[28:31], s42 offen offset:1024 sc1 lds
    buffer_load_dwordx4 v1, s[28:31], s42 offen offset:2048 sc1 lds
    buffer_load_dwordx4 v1, s[28:31], s42 offen offset:3072 sc1 lds
    s_add_u32 s43, s21, 0
    s_cmp_lt_u32 s43, s86
    s_cselect_b32 s42, 2, 0
    s_sub_u32 s43, s43, s42
    s_cselect_b32 s42, s86, 0
    s_add_u32 s43, s43, s42
    s_lshl_b32 s43, s43, 16
    s_add_u32 s43, s43, s87
    s_add_u32 m0, s55, 0
    s_add_u32 s42, s43, 0
    buffer_load_dwordx4 v8, s[36:39], s42 offen lds
    s_add_u32 m0, s55, 1024
    s_add_u32 s42, s43, 16384
    buffer_load_dwordx4 v8, s[36:39], s42 offen lds
    s_add_u32 m0, s55, 2048
    s_add_u32 s42, s43, 32768
    buffer_load_dwordx4 v8, s[36:39], s42 offen lds
    s_add_u32 m0, s55, 3072
    s_add_u32 s42, s43, 49152
    buffer_load_dwordx4 v8, s[36:39], s42 offen lds
    s_waitcnt vmcnt(8)
    s_barrier
    s_add_u32 m0, s55, 131072
    s_add_u32 s42, s55, 196608
    buffer_load_dwordx4 v1, s[28:31], s42 offen offset:0 sc1 lds
    buffer_load_dwordx4 v1, s[28:31], s42 offen offset:1024 sc1 lds
    buffer_load_dwordx4 v1, s[28:31], s42 offen offset:2048 sc1 lds
    buffer_load_dwordx4 v1, s[28:31], s42 offen offset:3072 sc1 lds
    s_add_u32 s43, s21, 4
    s_cmp_lt_u32 s43, s86
    s_cselect_b32 s42, 2, 0
    s_sub_u32 s43, s43, s42
    s_lshl_b32 s43, s43, 16
    s_add_u32 s43, s43, s87
    s_add_u32 m0, s55, 16384
    s_add_u32 s42, s43, 0
    buffer_load_dwordx4 v8, s[36:39], s42 offen lds
    s_add_u32 m0, s55, 17408
    s_add_u32 s42, s43, 16384
    buffer_load_dwordx4 v8, s[36:39], s42 offen lds
    s_add_u32 m0, s55, 18432
    s_add_u32 s42, s43, 32768
    buffer_load_dwordx4 v8, s[36:39], s42 offen lds
    s_add_u32 m0, s55, 19456
    s_add_u32 s42, s43, 49152
    buffer_load_dwordx4 v8, s[36:39], s42 offen lds
    s_waitcnt vmcnt(12)
    s_barrier
    s_add_u32 m0, s55, 147456
    s_add_u32 s42, s55, 212992
    buffer_load_dwordx4 v1, s[28:31], s42 offen offset:0 sc1 lds
    buffer_load_dwordx4 v1, s[28:31], s42 offen offset:1024 sc1 lds
    buffer_load_dwordx4 v1, s[28:31], s42 offen offset:2048 sc1 lds
    buffer_load_dwordx4 v1, s[28:31], s42 offen offset:3072 sc1 lds
    s_add_u32 s43, s21, 8
    s_cmp_lt_u32 s43, s86
    s_cselect_b32 s42, 2, 0
    s_sub_u32 s43, s43, s42
    s_lshl_b32 s43, s43, 16
    s_add_u32 s43, s43, s87
    s_add_u32 m0, s55, 32768
    s_add_u32 s42, s43, 0
    buffer_load_dwordx4 v8, s[36:39], s42 offen lds
    s_add_u32 m0, s55, 33792
    s_add_u32 s42, s43, 16384
    buffer_load_dwordx4 v8, s[36:39], s42 offen lds
    s_add_u32 m0, s55, 34816
    s_add_u32 s42, s43, 32768
    buffer_load_dwordx4 v8, s[36:39], s42 offen lds
    s_add_u32 m0, s55, 35840
    s_add_u32 s42, s43, 49152
    buffer_load_dwordx4 v8, s[36:39], s42 offen lds
    s_waitcnt vmcnt(12)
    s_barrier
    s_add_u32 m0, s55, 98304
    s_add_u32 s42, s55, 229376
    buffer_load_dwordx4 v1, s[28:31], s42 offen offset:0 sc1 lds
    buffer_load_dwordx4 v1, s[28:31], s42 offen offset:1024 sc1 lds
    buffer_load_dwordx4 v1, s[28:31], s42 offen offset:2048 sc1 lds
    buffer_load_dwordx4 v1, s[28:31], s42 offen offset:3072 sc1 lds
    s_add_u32 s43, s21, 12
    s_cmp_lt_u32 s43, s86
    s_cselect_b32 s42, 2, 0
    s_sub_u32 s43, s43, s42
    s_lshl_b32 s43, s43, 16
    s_add_u32 s43, s43, s87
    s_add_u32 m0, s55, 49152
    s_add_u32 s42, s43, 0
    buffer_load_dwordx4 v8, s[36:39], s42 offen lds
    s_add_u32 m0, s55, 50176
    s_add_u32 s42, s43, 16384
    buffer_load_dwordx4 v8, s[36:39], s42 offen lds
    s_add_u32 m0, s55, 51200
    s_add_u32 s42, s43, 32768
    buffer_load_dwordx4 v8, s[36:39], s42 offen lds
    s_add_u32 m0, s55, 52224
    s_add_u32 s42, s43, 49152
    buffer_load_dwordx4 v8, s[36:39], s42 offen lds
    s_waitcnt vmcnt(12)
    s_barrier
    s_add_u32 m0, s55, 114688
    s_add_u32 s42, s55, 245760
    buffer_load_dwordx4 v1, s[28:31], s42 offen offset:0 sc1 lds
    buffer_load_dwordx4 v1, s[28:31], s42 offen offset:1024 sc1 lds
    buffer_load_dwordx4 v1, s[28:31], s42 offen offset:2048 sc1 lds
    buffer_load_dwordx4 v1, s[28:31], s42 offen offset:3072 sc1 lds
    s_add_u32 s43, s21, 16
    s_cmp_lt_u32 s43, s86
    s_cselect_b32 s42, 2, 0
    s_sub_u32 s43, s43, s42
    s_lshl_b32 s43, s43, 16
    s_add_u32 s43, s43, s87
    s_add_u32 m0, s55, 65536
    s_add_u32 s42, s43, 0
    buffer_load_dwordx4 v8, s[36:39], s42 offen lds
    s_add_u32 m0, s55, 66560
    s_add_u32 s42, s43, 16384
    buffer_load_dwordx4 v8, s[36:39], s42 offen lds
    s_add_u32 m0, s55, 67584
    s_add_u32 s42, s43, 32768
    buffer_load_dwordx4 v8, s[36:39], s42 offen lds
    s_add_u32 m0, s55, 68608
    s_add_u32 s42, s43, 49152
    buffer_load_dwordx4 v8, s[36:39], s42 offen lds
    s_waitcnt vmcnt(12)
    s_barrier
    s_add_u32 s43, s21, 20
    s_cmp_lt_u32 s43, s86
    s_cselect_b32 s42, 2, 0
    s_sub_u32 s43, s43, s42
    s_lshl_b32 s43, s43, 16
    s_add_u32 s43, s43, s87
    s_add_u32 m0, s55, 81920
    s_add_u32 s42, s43, 0
    buffer_load_dwordx4 v8, s[36:39], s42 offen lds
    s_add_u32 m0, s55, 82944
    s_add_u32 s42, s43, 16384
    buffer_load_dwordx4 v8, s[36:39], s42 offen lds
    s_add_u32 m0, s55, 83968
    s_add_u32 s42, s43, 32768
    buffer_load_dwordx4 v8, s[36:39], s42 offen lds
    s_add_u32 m0, s55, 84992
    s_add_u32 s42, s43, 49152
    buffer_load_dwordx4 v8, s[36:39], s42 offen lds
    s_add_u32 s43, s21, 24
    s_cmp_lt_u32 s43, s86
    s_cselect_b32 s42, 2, 0
    s_sub_u32 s43, s43, s42
    s_lshl_b32 s43, s43, 16
    s_add_u32 s43, s43, s87
    s_add_u32 m0, s55, 131072
    s_add_u32 s42, s43, 0
    buffer_load_dwordx4 v8, s[36:39], s42 offen lds
    s_add_u32 m0, s55, 132096
    s_add_u32 s42, s43, 16384
    buffer_load_dwordx4 v8, s[36:39], s42 offen lds
    s_add_u32 m0, s55, 133120
    s_add_u32 s42, s43, 32768
    buffer_load_dwordx4 v8, s[36:39], s42 offen lds
    s_add_u32 m0, s55, 134144
    s_add_u32 s42, s43, 49152
    buffer_load_dwordx4 v8, s[36:39], s42 offen lds
    s_waitcnt vmcnt(12)
    s_barrier
    s_add_u32 s43, s21, 28
    s_cmp_lt_u32 s43, s86
    s_cselect_b32 s42, 2, 0
    s_sub_u32 s43, s43, s42
    s_lshl_b32 s43, s43, 16
    s_add_u32 s43, s43, s87
    s_add_u32 m0, s55, 147456
    s_add_u32 s42, s43, 0
    buffer_load_dwordx4 v8, s[36:39], s42 offen lds
    s_add_u32 m0, s55, 148480
    s_add_u32 s42, s43, 16384
    buffer_load_dwordx4 v8, s[36:39], s42 offen lds
    s_add_u32 m0, s55, 149504
    s_add_u32 s42, s43, 32768
    buffer_load_dwordx4 v8, s[36:39], s42 offen lds
    s_add_u32 m0, s55, 150528
    s_add_u32 s42, s43, 49152
    buffer_load_dwordx4 v8, s[36:39], s42 offen lds
    s_barrier
.Lhend_45:
    s_setprio 0
    s_waitcnt vmcnt(0)
    s_barrier
    s_cmp_lg_u32 s41, 0
    s_cbranch_scc1 .Lnod_49
    s_mul_i32 s47, s59, 1280
    s_add_u32 s47, s47, s40
    s_add_u32 s47, s47, 0x1e64000
    s_mov_b32 s58, 0x40000
    s_mov_b64 exec, 1
.Lpoll_50:
    v_mov_b32 v15, 0
    buffer_atomic_add v15, v2, s[24:27], s47 offen sc0 sc1
    s_waitcnt vmcnt(0)
    v_cmp_gt_u32 vcc, 16, v15
    s_cbranch_vccz .Lpollok_51
    s_sub_u32 s58, s58, 1
    s_cbranch_scc0 .Lpoll_50
.Lpollok_51:
    s_mov_b64 exec, -1
.Lnod_49:
    s_mul_i32 s55, s21, 7168
    s_mul_i32 s51, s23, 473088
    s_add_u32 s51, s51, s55
    s_add_u32 s51, s51, 0x500000
    s_add_u32 m0, s55, 98304
    s_add_u32 s42, s51, 0
    buffer_load_dwordx4 v1, s[24:27], s42 offen offset:0 sc1 lds
    buffer_load_dwordx4 v1, s[24:27], s42 offen offset:1024 sc1 lds
    buffer_load_dwordx4 v1, s[24:27], s42 offen offset:2048 sc1 lds
    buffer_load_dwordx4 v1, s[24:27], s42 offen offset:3072 sc1 lds
    s_add_u32 m0, s55, 102400
    s_add_u32 s42, s51, 4096
    buffer_load_dwordx4 v1, s[24:27], s42 offen offset:0 sc1 lds
    buffer_load_dwordx4 v1, s[24:27], s42 offen offset:1024 sc1 lds
    buffer_load_dwordx4 v1, s[24:27], s42 offen offset:2048 sc1 lds
    s_add_u32 s51, s51, 28672
    s_waitcnt vmcnt(0)
    s_barrier
    s_add_u32 m0, s55, 126976
    s_add_u32 s42, s51, 0
    s_waitcnt vmcnt(7)
    buffer_load_dwordx4 v1, s[24:27], s42 offen offset:0 sc1 lds
    s_waitcnt vmcnt(7)
    buffer_load_dwordx4 v1, s[24:27], s42 offen offset:1024 sc1 lds
    s_waitcnt vmcnt(7)
    buffer_load_dwordx4 v1, s[24:27], s42 offen offset:2048 sc1 lds
    s_waitcnt vmcnt(7)
    buffer_load_dwordx4 v1, s[24:27], s42 offen offset:3072 sc1 lds
    s_add_u32 m0, s55, 131072
    s_add_u32 s42, s51, 4096
    s_waitcnt vmcnt(7)
    buffer_load_dwordx4 v1, s[24:27], s42 offen offset:0 sc1 lds
    s_waitcnt vmcnt(7)
    buffer_load_dwordx4 v1, s[24:27], s42 offen offset:1024 sc1 lds
    s_waitcnt vmcnt(7)
    buffer_load_dwordx4 v1, s[24:27], s42 offen offset:2048 sc1 lds
    s_add_u32 s51, s51, 28672
    s_add_u32 m0, s55, 12288
    s_add_u32 s42, s51, 0
    s_waitcnt vmcnt(7)
    buffer_load_dwordx4 v1, s[24:27], s42 offen offset:0 sc1 lds
    s_waitcnt vmcnt(7)
    buffer_load_dwordx4 v1, s[24:27], s42 offen offset:1024 sc1 lds
    s_waitcnt vmcnt(7)
    buffer_load_dwordx4 v1, s[24:27], s42 offen offset:2048 sc1 lds
    s_waitcnt vmcnt(7)
    buffer_load_dwordx4 v1, s[24:27], s42 offen offset:3072 sc1 lds
    s_add_u32 m0, s55, 16384
    s_add_u32 s42, s51, 4096
    s_waitcnt vmcnt(7)
    buffer_load_dwordx4 v1, s[24:27], s42 offen offset:0 sc1 lds
    s_waitcnt vmcnt(7)
    buffer_load_dwordx4 v1, s[24:27], s42 offen offset:1024 sc1 lds
    s_waitcnt vmcnt(7)
    buffer_load_dwordx4 v1, s[24:27], s42 offen offset:2048 sc1 lds
    s_add_u32 s51, s51, 28672
    s_waitcnt vmcnt(7)
    s_barrier
    s_add_u32 m0, s55, 40960
    s_add_u32 s42, s51, 0
    buffer_load_dwordx4 v1, s[24:27], s42 offen offset:0 sc1 lds
    buffer_load_dwordx4 v1, s[24:27], s42 offen offset:1024 sc1 lds
    buffer_load_dwordx4 v1, s[24:27], s42 offen offset:2048 sc1 lds
    buffer_load_dwordx4 v1, s[24:27], s42 offen offset:3072 sc1 lds
    s_add_u32 m0, s55, 45056
    s_add_u32 s42, s51, 4096
    buffer_load_dwordx4 v1, s[24:27], s42 offen offset:0 sc1 lds
    buffer_load_dwordx4 v1, s[24:27], s42 offen offset:1024 sc1 lds
    buffer_load_dwordx4 v1, s[24:27], s42 offen offset:2048 sc1 lds
    s_add_u32 s51, s51, 28672
    s_add_u32 m0, s55, 69632
    s_add_u32 s42, s51, 0
    buffer_load_dwordx4 v1, s[24:27], s42 offen offset:0 sc1 lds
    buffer_load_dwordx4 v1, s[24:27], s42 offen offset:1024 sc1 lds
    buffer_load_dwordx4 v1, s[24:27], s42 offen offset:2048 sc1 lds
    buffer_load_dwordx4 v1, s[24:27], s42 offen offset:3072 sc1 lds
    s_add_u32 m0, s55, 73728
    s_add_u32 s42, s51, 4096
    buffer_load_dwordx4 v1, s[24:27], s42 offen offset:0 sc1 lds
    buffer_load_dwordx4 v1, s[24:27], s42 offen offset:1024 sc1 lds
    buffer_load_dwordx4 v1, s[24:27], s42 offen offset:2048 sc1 lds
    s_add_u32 s51, s51, 28672
    s_waitcnt vmcnt(14)
    s_barrier
    s_add_u32 m0, s55, 98304
    s_add_u32 s42, s51, 0
    buffer_load_dwordx4 v1, s[24:27], s42 offen offset:0 sc1 lds
    buffer_load_dwordx4 v1, s[24:27], s42 offen offset:1024 sc1 lds
    buffer_load_dwordx4 v1, s[24:27], s42 offen offset:2048 sc1 lds
    buffer_load_dwordx4 v1, s[24:27], s42 offen offset:3072 sc1 lds
    s_add_u32 m0, s55, 102400
    s_add_u32 s42, s51, 4096
    buffer_load_dwordx4 v1, s[24:27], s42 offen offset:0 sc1 lds
    buffer_load_dwordx4 v1, s[24:27], s42 offen offset:1024 sc1 lds
    buffer_load_dwordx4 v1, s[24:27], s42 offen offset:2048 sc1 lds
    s_add_u32 s51, s51, 28672
    s_waitcnt vmcnt(14)
    s_barrier
    s_add_u32 m0, s55, 126976
    s_add_u32 s42, s51, 0
    buffer_load_dwordx4 v1, s[24:27], s42 offen offset:0 sc1 lds
    buffer_load_dwordx4 v1, s[24:27], s42 offen offset:1024 sc1 lds
    buffer_load_dwordx4 v1, s[24:27], s42 offen offset:2048 sc1 lds
    buffer_load_dwordx4 v1, s[24:27], s42 offen offset:3072 sc1 lds
    s_add_u32 m0, s55, 131072
    s_add_u32 s42, s51, 4096
    buffer_load_dwordx4 v1, s[24:27], s42 offen offset:0 sc1 lds
    buffer_load_dwordx4 v1, s[24:27], s42 offen offset:1024 sc1 lds
    buffer_load_dwordx4 v1, s[24:27], s42 offen offset:2048 sc1 lds
    s_add_u32 s51, s51, 28672
    s_waitcnt vmcnt(14)
    s_barrier
    s_add_u32 m0, s55, 12288
    s_add_u32 s42, s51, 0
    buffer_load_dwordx4 v1, s[24:27], s42 offen offset:0 sc1 lds
    buffer_load_dwordx4 v1, s[24:27], s42 offen offset:1024 sc1 lds
    buffer_load_dwordx4 v1, s[24:27], s42 offen offset:2048 sc1 lds
    buffer_load_dwordx4 v1, s[24:27], s42 offen offset:3072 sc1 lds
    s_add_u32 m0, s55, 16384
    s_add_u32 s42, s51, 4096
    buffer_load_dwordx4 v1, s[24:27], s42 offen offset:0 sc1 lds
    buffer_load_dwordx4 v1, s[24:27], s42 offen offset:1024 sc1 lds
    buffer_load_dwordx4 v1, s[24:27], s42 offen offset:2048 sc1 lds
    s_add_u32 s51, s51, 28672
    s_waitcnt vmcnt(14)
    s_barrier
    s_add_u32 m0, s55, 40960
    s_add_u32 s42, s51, 0
    buffer_load_dwordx4 v1, s[24:27], s42 offen offset:0 sc1 lds
    buffer_load_dwordx4 v1, s[24:27], s42 offen offset:1024 sc1 lds
    buffer_load_dwordx4 v1, s[24:27], s42 offen offset:2048 sc1 lds
    buffer_load_dwordx4 v1, s[24:27], s42 offen offset:3072 sc1 lds
    s_add_u32 m0, s55, 45056
    s_add_u32 s42, s51, 4096
    buffer_load_dwordx4 v1, s[24:27], s42 offen offset:0 sc1 lds
    buffer_load_dwordx4 v1, s[24:27], s42 offen offset:1024 sc1 lds
    buffer_load_dwordx4 v1, s[24:27], s42 offen offset:2048 sc1 lds
    s_add_u32 s51, s51, 28672
    s_waitcnt vmcnt(14)
    s_barrier
    s_add_u32 m0, s55, 69632
    s_add_u32 s42, s51, 0
    buffer_load_dwordx4 v1, s[24:27], s42 offen offset:0 sc1 lds
    buffer_load_dwordx4 v1, s[24:27], s42 offen offset:1024 sc1 lds
    buffer_load_dwordx4 v1, s[24:27], s42 offen offset:2048 sc1 lds
    buffer_load_dwordx4 v1, s[24:27], s42 offen offset:3072 sc1 lds
    s_add_u32 m0, s55, 73728
    s_add_u32 s42, s51, 4096
    buffer_load_dwordx4 v1, s[24:27], s42 offen offset:0 sc1 lds
    buffer_load_dwordx4 v1, s[24:27], s42 offen offset:1024 sc1 lds
    buffer_load_dwordx4 v1, s[24:27], s42 offen offset:2048 sc1 lds
    s_add_u32 s51, s51, 28672
    s_waitcnt vmcnt(14)
    s_barrier
    s_add_u32 m0, s55, 98304
    s_add_u32 s42, s51, 0
    buffer_load_dwordx4 v1, s[24:27], s42 offen offset:0 sc1 lds
    buffer_load_dwordx4 v1, s[24:27], s42 offen offset:1024 sc1 lds
    buffer_load_dwordx4 v1, s[24:27], s42 offen offset:2048 sc1 lds
    buffer_load_dwordx4 v1, s[24:27], s42 offen offset:3072 sc1 lds
    s_add_u32 m0, s55, 102400
    s_add_u32 s42, s51, 4096
    buffer_load_dwordx4 v1, s[24:27], s42 offen offset:0 sc1 lds
    buffer_load_dwordx4 v1, s[24:27], s42 offen offset:1024 sc1 lds
    buffer_load_dwordx4 v1, s[24:27], s42 offen offset:2048 sc1 lds
    s_add_u32 s51, s51, 28672
    s_waitcnt vmcnt(14)
    s_barrier
    s_add_u32 m0, s55, 126976
    s_add_u32 s42, s51, 0
    buffer_load_dwordx4 v1, s[24:27], s42 offen offset:0 sc1 lds
    buffer_load_dwordx4 v1, s[24:27], s42 offen offset:1024 sc1 lds
    buffer_load_dwordx4 v1, s[24:27], s42 offen offset:2048 sc1 lds
    buffer_load_dwordx4 v1, s[24:27], s42 offen offset:3072 sc1 lds
    s_add_u32 m0, s55, 131072
    s_add_u32 s42, s51, 4096
    buffer_load_dwordx4 v1, s[24:27], s42 offen offset:0 sc1 lds
    buffer_load_dwordx4 v1, s[24:27], s42 offen offset:1024 sc1 lds
    buffer_load_dwordx4 v1, s[24:27], s42 offen offset:2048 sc1 lds
    s_add_u32 s51, s51, 28672
    s_waitcnt vmcnt(14)
    s_barrier
    s_add_u32 m0, s55, 12288
    s_add_u32 s42, s51, 0
    buffer_load_dwordx4 v1, s[24:27], s42 offen offset:0 sc1 lds
    buffer_load_dwordx4 v1, s[24:27], s42 offen offset:1024 sc1 lds
    buffer_load_dwordx4 v1, s[24:27], s42 offen offset:2048 sc1 lds
    buffer_load_dwordx4 v1, s[24:27], s42 offen offset:3072 sc1 lds
    s_add_u32 m0, s55, 16384
    s_add_u32 s42, s51, 4096
    buffer_load_dwordx4 v1, s[24:27], s42 offen offset:0 sc1 lds
    buffer_load_dwordx4 v1, s[24:27], s42 offen offset:1024 sc1 lds
    buffer_load_dwordx4 v1, s[24:27], s42 offen offset:2048 sc1 lds
    s_add_u32 s51, s51, 28672
    s_waitcnt vmcnt(14)
    s_barrier
    s_add_u32 m0, s55, 40960
    s_add_u32 s42, s51, 0
    buffer_load_dwordx4 v1, s[24:27], s42 offen offset:0 sc1 lds
    buffer_load_dwordx4 v1, s[24:27], s42 offen offset:1024 sc1 lds
    buffer_load_dwordx4 v1, s[24:27], s42 offen offset:2048 sc1 lds
    buffer_load_dwordx4 v1, s[24:27], s42 offen offset:3072 sc1 lds
    s_add_u32 m0, s55, 45056
    s_add_u32 s42, s51, 4096
    buffer_load_dwordx4 v1, s[24:27], s42 offen offset:0 sc1 lds
    buffer_load_dwordx4 v1, s[24:27], s42 offen offset:1024 sc1 lds
    buffer_load_dwordx4 v1, s[24:27], s42 offen offset:2048 sc1 lds
    s_add_u32 s51, s51, 28672
    s_waitcnt vmcnt(14)
    s_barrier
    s_lshr_b32 s42, s2, 3
    s_lshl_b32 s42, s42, 11
    v_and_b32 v9, 15, v0
    v_lshl_add_u32 v9, v9, 7, s42
    v_min_u32 v9, .Lcode_end - .Lcode_pc - 4, v9
    global_load_dword v11, v9, s[100:101]
    s_add_u32 m0, s55, 69632
    s_add_u32 s42, s51, 0
    buffer_load_dwordx4 v1, s[24:27], s42 offen offset:0 sc1 lds
    buffer_load_dwordx4 v1, s[24:27], s42 offen offset:1024 sc1 lds
    buffer_load_dwordx4 v1, s[24:27], s42 offen offset:2048 sc1 lds
    buffer_load_dwordx4 v1, s[24:27], s42 offen offset:3072 sc1 lds
    s_add_u32 m0, s55, 73728
    s_add_u32 s42, s51, 4096
    buffer_load_dwordx4 v1, s[24:27], s42 offen offset:0 sc1 lds
    buffer_load_dwordx4 v1, s[24:27], s42 offen offset:1024 sc1 lds
    buffer_load_dwordx4 v1, s[24:27], s42 offen offset:2048 sc1 lds
    s_add_u32 s51, s51, 28672
    s_waitcnt vmcnt(14)
    s_barrier
    s_add_u32 m0, s55, 98304
    s_add_u32 s42, s51, 0
    buffer_load_dwordx4 v1, s[24:27], s42 offen offset:0 sc1 lds
    buffer_load_dwordx4 v1, s[24:27], s42 offen offset:1024 sc1 lds
    buffer_load_dwordx4 v1, s[24:27], s42 offen offset:2048 sc1 lds
    buffer_load_dwordx4 v1, s[24:27], s42 offen offset:3072 sc1 lds
    s_add_u32 m0, s55, 102400
    s_add_u32 s42, s51, 4096
    buffer_load_dwordx4 v1, s[24:27], s42 offen offset:0 sc1 lds
    buffer_load_dwordx4 v1, s[24:27], s42 offen offset:1024 sc1 lds
    buffer_load_dwordx4 v1, s[24:27], s42 offen offset:2048 sc1 lds
    s_add_u32 s51, s51, 28672
    s_waitcnt vmcnt(14)
    s_barrier
    s_mul_i32 s43, s21, 3072
    s_sub_u32 s55, s55, s43
    s_sub_u32 s51, s51, s43
    s_add_u32 m0, s55, 126976
    s_add_u32 s42, s51, 0
    buffer_load_dwordx4 v1, s[24:27], s42 offen offset:0 sc1 lds
    buffer_load_dwordx4 v1, s[24:27], s42 offen offset:1024 sc1 lds
    buffer_load_dwordx4 v1, s[24:27], s42 offen offset:2048 sc1 lds
    buffer_load_dwordx4 v1, s[24:27], s42 offen offset:3072 sc1 lds
    s_add_u32 s51, s51, 28672
    s_waitcnt vmcnt(11)
    s_barrier
    s_mul_i32 s55, s21, 7168
    s_mul_i32 s51, s23, 458752
    s_add_u32 s51, s51, s55
    s_add_u32 s51, s51, 0xd00000
    s_add_u32 m0, s55, 0
    s_add_u32 s42, s51, 0
    buffer_load_dwordx4 v1, s[24:27], s42 offen offset:0 sc1 lds
    buffer_load_dwordx4 v1, s[24:27], s42 offen offset:1024 sc1 lds
    buffer_load_dwordx4 v1, s[24:27], s42 offen offset:2048 sc1 lds
    buffer_load_dwordx4 v1, s[24:27], s42 offen offset:3072 sc1 lds
    s_add_u32 m0, s55, 4096
    s_add_u32 s42, s51, 4096
    buffer_load_dwordx4 v1, s[24:27], s42 offen offset:0 sc1 lds
    buffer_load_dwordx4 v1, s[24:27], s42 offen offset:1024 sc1 lds
    buffer_load_dwordx4 v1, s[24:27], s42 offen offset:2048 sc1 lds
    s_add_u32 s51, s51, 28672
    s_waitcnt vmcnt(11)
    s_barrier
    s_add_u32 m0, s55, 28672
    s_add_u32 s42, s51, 0
    buffer_load_dwordx4 v1, s[24:27], s42 offen offset:0 sc1 lds
    buffer_load_dwordx4 v1, s[24:27], s42 offen offset:1024 sc1 lds
    buffer_load_dwordx4 v1, s[24:27], s42 offen offset:2048 sc1 lds
    buffer_load_dwordx4 v1, s[24:27], s42 offen offset:3072 sc1 lds
    s_add_u32 m0, s55, 32768
    s_add_u32 s42, s51, 4096
    buffer_load_dwordx4 v1, s[24:27], s42 offen offset:0 sc1 lds
    buffer_load_dwordx4 v1, s[24:27], s42 offen offset:1024 sc1 lds
    buffer_load_dwordx4 v1, s[24:27], s42 offen offset:2048 sc1 lds
    s_add_u32 s51, s51, 28672
    s_waitcnt vmcnt(14)
    s_barrier
    s_add_u32 m0, s55, 57344
    s_add_u32 s42, s51, 0
    buffer_load_dwordx4 v1, s[24:27], s42 offen offset:0 sc1 lds
    buffer_load_dwordx4 v1, s[24:27], s42 offen offset:1024 sc1 lds
    buffer_load_dwordx4 v1, s[24:27], s42 offen offset:2048 sc1 lds
    buffer_load_dwordx4 v1, s[24:27], s42 offen offset:3072 sc1 lds
    s_add_u32 m0, s55, 61440
    s_add_u32 s42, s51, 4096
    buffer_load_dwordx4 v1, s[24:27], s42 offen offset:0 sc1 lds
    buffer_load_dwordx4 v1, s[24:27], s42 offen offset:1024 sc1 lds
    buffer_load_dwordx4 v1, s[24:27], s42 offen offset:2048 sc1 lds
    s_add_u32 s51, s51, 28672
    s_barrier
    s_add_u32 m0, s55, 86016
    s_add_u32 s42, s51, 0
    s_waitcnt vmcnt(4)
    buffer_load_dwordx4 v1, s[24:27], s42 offen offset:0 sc1 lds
    s_waitcnt vmcnt(4)
    buffer_load_dwordx4 v1, s[24:27], s42 offen offset:1024 sc1 lds
    s_waitcnt vmcnt(4)
    buffer_load_dwordx4 v1, s[24:27], s42 offen offset:2048 sc1 lds
    s_waitcnt vmcnt(4)
    buffer_load_dwordx4 v1, s[24:27], s42 offen offset:3072 sc1 lds
    s_add_u32 m0, s55, 90112
    s_add_u32 s42, s51, 4096
    s_waitcnt vmcnt(4)
    buffer_load_dwordx4 v1, s[24:27], s42 offen offset:0 sc1 lds
    s_waitcnt vmcnt(4)
    buffer_load_dwordx4 v1, s[24:27], s42 offen offset:1024 sc1 lds
    s_waitcnt vmcnt(4)
    buffer_load_dwordx4 v1, s[24:27], s42 offen offset:2048 sc1 lds
    s_add_u32 s51, s51, 28672
    s_add_u32 m0, s55, 114688
    s_add_u32 s42, s51, 0
    s_waitcnt vmcnt(4)
    buffer_load_dwordx4 v1, s[24:27], s42 offen offset:0 sc1 lds
    s_waitcnt vmcnt(4)
    buffer_load_dwordx4 v1, s[24:27], s42 offen offset:1024 sc1 lds
    s_waitcnt vmcnt(4)
    buffer_load_dwordx4 v1, s[24:27], s42 offen offset:2048 sc1 lds
    s_waitcnt vmcnt(4)
    buffer_load_dwordx4 v1, s[24:27], s42 offen offset:3072 sc1 lds
    s_add_u32 m0, s55, 118784
    s_add_u32 s42, s51, 4096
    s_waitcnt vmcnt(4)
    buffer_load_dwordx4 v1, s[24:27], s42 offen offset:0 sc1 lds
    s_waitcnt vmcnt(4)
    buffer_load_dwordx4 v1, s[24:27], s42 offen offset:1024 sc1 lds
    s_waitcnt vmcnt(4)
    buffer_load_dwordx4 v1, s[24:27], s42 offen offset:2048 sc1 lds
    s_add_u32 s51, s51, 28672
    s_waitcnt vmcnt(28)
    s_barrier
    s_and_b32 s43, s23, 1
    s_lshl_b32 s45, s59, 1
    s_add_u32 s45, s45, s43
    s_mul_i32 s47, s45, 1280
    s_add_u32 s47, s47, s40
    s_add_u32 s47, s47, 0x1d74000
    s_mov_b32 s58, 0x40000
    s_mov_b64 exec, 1
.Lpoll_52:
    v_mov_b32 v15, 0
    buffer_atomic_add v15, v2, s[24:27], s47 offen sc0 sc1
    s_waitcnt vmcnt(0)
    v_cmp_gt_u32 vcc, 8, v15
    s_cbranch_vccz .Lpollok_53
    s_sub_u32 s58, s58, 1
    s_cbranch_scc0 .Lpoll_52
.Lpollok_53:
    s_mov_b64 exec, -1
    s_waitcnt vmcnt(21)
    s_barrier
    s_waitcnt vmcnt(14)
    s_barrier
    s_and_b32 s43, s23, 1
    s_lshl_b32 s45, s59, 1
    s_add_u32 s45, s45, s43
    s_mul_i32 s47, s45, 1280
    s_add_u32 s47, s47, s40
    s_add_u32 s47, s47, 0x1d9c000
    s_mov_b32 s58, 0x40000
    s_mov_b64 exec, 1
.Lpoll_54:
    v_mov_b32 v15, 0
    buffer_atomic_add v15, v2, s[24:27], s47 offen sc0 sc1
    s_waitcnt vmcnt(0)
    v_cmp_gt_u32 vcc, 8, v15
    s_cbranch_vccz .Lpollok_55
    s_sub_u32 s58, s58, 1
    s_cbranch_scc0 .Lpoll_54
.Lpollok_55:
    s_mov_b64 exec, -1
    s_add_u32 m0, s55, 0
    s_add_u32 s42, s51, 0
    buffer_load_dwordx4 v1, s[24:27], s42 offen offset:0 sc1 lds
    buffer_load_dwordx4 v1, s[24:27], s42 offen offset:1024 sc1 lds
    buffer_load_dwordx4 v1, s[24:27], s42 offen offset:2048 sc1 lds
    buffer_load_dwordx4 v1, s[24:27], s42 offen offset:3072 sc1 lds
    s_add_u32 m0, s55, 4096
    s_add_u32 s42, s51, 4096
    buffer_load_dwordx4 v1, s[24:27], s42 offen offset:0 sc1 lds
    buffer_load_dwordx4 v1, s[24:27], s42 offen offset:1024 sc1 lds
    buffer_load_dwordx4 v1, s[24:27], s42 offen offset:2048 sc1 lds
    s_add_u32 s51, s51, 28672
    s_waitcnt vmcnt(14)
    s_barrier
    s_add_u32 m0, s55, 28672
    s_add_u32 s42, s51, 0
    buffer_load_dwordx4 v1, s[24:27], s42 offen offset:0 sc1 lds
    buffer_load_dwordx4 v1, s[24:27], s42 offen offset:1024 sc1 lds
    buffer_load_dwordx4 v1, s[24:27], s42 offen offset:2048 sc1 lds
    buffer_load_dwordx4 v1, s[24:27], s42 offen offset:3072 sc1 lds
    s_add_u32 m0, s55, 32768
    s_add_u32 s42, s51, 4096
    buffer_load_dwordx4 v1, s[24:27], s42 offen offset:0 sc1 lds
    buffer_load_dwordx4 v1, s[24:27], s42 offen offset:1024 sc1 lds
    buffer_load_dwordx4 v1, s[24:27], s42 offen offset:2048 sc1 lds
    s_add_u32 s51, s51, 28672
    s_waitcnt vmcnt(14)
    s_barrier
    s_add_u32 m0, s55, 57344
    s_add_u32 s42, s51, 0
    buffer_load_dwordx4 v1, s[24:27], s42 offen offset:0 sc1 lds
    buffer_load_dwordx4 v1, s[24:27], s42 offen offset:1024 sc1 lds
    buffer_load_dwordx4 v1, s[24:27], s42 offen offset:2048 sc1 lds
    buffer_load_dwordx4 v1, s[24:27], s42 offen offset:3072 sc1 lds
    s_add_u32 m0, s55, 61440
    s_add_u32 s42, s51, 4096
    buffer_load_dwordx4 v1, s[24:27], s42 offen offset:0 sc1 lds
    buffer_load_dwordx4 v1, s[24:27], s42 offen offset:1024 sc1 lds
    buffer_load_dwordx4 v1, s[24:27], s42 offen offset:2048 sc1 lds
    s_add_u32 s51, s51, 28672
    s_waitcnt vmcnt(14)
    s_barrier
    s_add_u32 m0, s55, 86016
    s_add_u32 s42, s51, 0
    buffer_load_dwordx4 v1, s[24:27], s42 offen offset:0 sc1 lds
    buffer_load_dwordx4 v1, s[24:27], s42 offen offset:1024 sc1 lds
    buffer_load_dwordx4 v1, s[24:27], s42 offen offset:2048 sc1 lds
    buffer_load_dwordx4 v1, s[24:27], s42 offen offset:3072 sc1 lds
    s_add_u32 m0, s55, 90112
    s_add_u32 s42, s51, 4096
    buffer_load_dwordx4 v1, s[24:27], s42 offen offset:0 sc1 lds
    buffer_load_dwordx4 v1, s[24:27], s42 offen offset:1024 sc1 lds
    buffer_load_dwordx4 v1, s[24:27], s42 offen offset:2048 sc1 lds
    s_add_u32 s51, s51, 28672
    s_waitcnt vmcnt(14)
    s_barrier
    s_add_u32 m0, s55, 114688
    s_add_u32 s42, s51, 0
    buffer_load_dwordx4 v1, s[24:27], s42 offen offset:0 sc1 lds
    buffer_load_dwordx4 v1, s[24:27], s42 offen offset:1024 sc1 lds
    buffer_load_dwordx4 v1, s[24:27], s42 offen offset:2048 sc1 lds
    buffer_load_dwordx4 v1, s[24:27], s42 offen offset:3072 sc1 lds
    s_add_u32 m0, s55, 118784
    s_add_u32 s42, s51, 4096
    buffer_load_dwordx4 v1, s[24:27], s42 offen offset:0 sc1 lds
    buffer_load_dwordx4 v1, s[24:27], s42 offen offset:1024 sc1 lds
    buffer_load_dwordx4 v1, s[24:27], s42 offen offset:2048 sc1 lds
    s_add_u32 s51, s51, 28672
    s_waitcnt vmcnt(14)
    s_barrier
    s_add_u32 m0, s55, 0
    s_add_u32 s42, s51, 0
    buffer_load_dwordx4 v1, s[24:27], s42 offen offset:0 sc1 lds
    buffer_load_dwordx4 v1, s[24:27], s42 offen offset:1024 sc1 lds
    buffer_load_dwordx4 v1, s[24:27], s42 offen offset:2048 sc1 lds
    buffer_load_dwordx4 v1, s[24:27], s42 offen offset:3072 sc1 lds
    s_add_u32 m0, s55, 4096
    s_add_u32 s42, s51, 4096
    buffer_load_dwordx4 v1, s[24:27], s42 offen offset:0 sc1 lds
    buffer_load_dwordx4 v1, s[24:27], s42 offen offset:1024 sc1 lds
    buffer_load_dwordx4 v1, s[24:27], s42 offen offset:2048 sc1 lds
    s_add_u32 s51, s51, 28672
    s_waitcnt vmcnt(14)
    s_barrier
    s_add_u32 m0, s55, 28672
    s_add_u32 s42, s51, 0
    buffer_load_dwordx4 v1, s[24:27], s42 offen offset:0 sc1 lds
    buffer_load_dwordx4 v1, s[24:27], s42 offen offset:1024 sc1 lds
    buffer_load_dwordx4 v1, s[24:27], s42 offen offset:2048 sc1 lds
    buffer_load_dwordx4 v1, s[24:27], s42 offen offset:3072 sc1 lds
    s_add_u32 m0, s55, 32768
    s_add_u32 s42, s51, 4096
    buffer_load_dwordx4 v1, s[24:27], s42 offen offset:0 sc1 lds
    buffer_load_dwordx4 v1, s[24:27], s42 offen offset:1024 sc1 lds
    buffer_load_dwordx4 v1, s[24:27], s42 offen offset:2048 sc1 lds
    s_add_u32 s51, s51, 28672
    s_waitcnt vmcnt(14)
    s_barrier
    s_add_u32 m0, s55, 57344
    s_add_u32 s42, s51, 0
    buffer_load_dwordx4 v1, s[24:27], s42 offen offset:0 sc1 lds
    buffer_load_dwordx4 v1, s[24:27], s42 offen offset:1024 sc1 lds
    buffer_load_dwordx4 v1, s[24:27], s42 offen offset:2048 sc1 lds
    buffer_load_dwordx4 v1, s[24:27], s42 offen offset:3072 sc1 lds
    s_add_u32 m0, s55, 61440
    s_add_u32 s42, s51, 4096
    buffer_load_dwordx4 v1, s[24:27], s42 offen offset:0 sc1 lds
    buffer_load_dwordx4 v1, s[24:27], s42 offen offset:1024 sc1 lds
    buffer_load_dwordx4 v1, s[24:27], s42 offen offset:2048 sc1 lds
    s_add_u32 s51, s51, 28672
    s_waitcnt vmcnt(14)
    s_barrier
    s_add_u32 m0, s55, 86016
    s_add_u32 s42, s51, 0
    buffer_load_dwordx4 v1, s[24:27], s42 offen offset:0 sc1 lds
    buffer_load_dwordx4 v1, s[24:27], s42 offen offset:1024 sc1 lds
    buffer_load_dwordx4 v1, s[24:27], s42 offen offset:2048 sc1 lds
    buffer_load_dwordx4 v1, s[24:27], s42 offen offset:3072 sc1 lds
    s_add_u32 m0, s55, 90112
    s_add_u32 s42, s51, 4096
    buffer_load_dwordx4 v1, s[24:27], s42 offen offset:0 sc1 lds
    buffer_load_dwordx4 v1, s[24:27], s42 offen offset:1024 sc1 lds
    buffer_load_dwordx4 v1, s[24:27], s42 offen offset:2048 sc1 lds
    s_add_u32 s51, s51, 28672
    s_waitcnt vmcnt(14)
    s_barrier
    s_add_u32 m0, s55, 114688
    s_add_u32 s42, s51, 0
    buffer_load_dwordx4 v1, s[24:27], s42 offen offset:0 sc1 lds
    buffer_load_dwordx4 v1, s[24:27], s42 offen offset:1024 sc1 lds
    buffer_load_dwordx4 v1, s[24:27], s42 offen offset:2048 sc1 lds
    buffer_load_dwordx4 v1, s[24:27], s42 offen offset:3072 sc1 lds
    s_add_u32 m0, s55, 118784
    s_add_u32 s42, s51, 4096
    buffer_load_dwordx4 v1, s[24:27], s42 offen offset:0 sc1 lds
    buffer_load_dwordx4 v1, s[24:27], s42 offen offset:1024 sc1 lds
    buffer_load_dwordx4 v1, s[24:27], s42 offen offset:2048 sc1 lds
    s_add_u32 s51, s51, 28672
    s_waitcnt vmcnt(14)
    s_barrier
    s_add_u32 m0, s55, 0
    s_add_u32 s42, s51, 0
    buffer_load_dwordx4 v1, s[24:27], s42 offen offset:0 sc1 lds
    buffer_load_dwordx4 v1, s[24:27], s42 offen offset:1024 sc1 lds
    buffer_load_dwordx4 v1, s[24:27], s42 offen offset:2048 sc1 lds
    buffer_load_dwordx4 v1, s[24:27], s42 offen offset:3072 sc1 lds
    s_add_u32 m0, s55, 4096
    s_add_u32 s42, s51, 4096
    buffer_load_dwordx4 v1, s[24:27], s42 offen offset:0 sc1 lds
    buffer_load_dwordx4 v1, s[24:27], s42 offen offset:1024 sc1 lds
    buffer_load_dwordx4 v1, s[24:27], s42 offen offset:2048 sc1 lds
    s_add_u32 s51, s51, 28672
    s_waitcnt vmcnt(14)
    s_barrier
    s_cmp_lg_u32 s41, 0
    s_cbranch_scc1 .Lnowq_56
    s_lshl_b32 s43, s21, 12
    s_mul_i32 s45, s23, 131072
    s_add_u32 s45, s45, s43
    s_add_u32 m0, s43, 32768
    s_add_u32 s42, s45, 32768
    buffer_load_dwordx4 v1, s[24:27], s42 offen offset:0 sc1 lds
    buffer_load_dwordx4 v1, s[24:27], s42 offen offset:1024 sc1 lds
    buffer_load_dwordx4 v1, s[24:27], s42 offen offset:2048 sc1 lds
    buffer_load_dwordx4 v1, s[24:27], s42 offen offset:3072 sc1 lds
.Lnowq_56:
    s_waitcnt vmcnt(7)
    s_barrier
    s_cmp_lg_u32 s41, 0
    s_cbranch_scc1 .Lnowq_57
    s_lshl_b32 s43, s21, 12
    s_mul_i32 s45, s23, 131072
    s_add_u32 s45, s45, s43
    s_add_u32 m0, s43, 49152
    s_add_u32 s42, s45, 49152
    buffer_load_dwordx4 v1, s[24:27], s42 offen offset:0 sc1 lds
    buffer_load_dwordx4 v1, s[24:27], s42 offen offset:1024 sc1 lds
    buffer_load_dwordx4 v1, s[24:27], s42 offen offset:2048 sc1 lds
    buffer_load_dwordx4 v1, s[24:27], s42 offen offset:3072 sc1 lds
    s_add_u32 m0, s43, 65536
    s_add_u32 s42, s45, 65536
    buffer_load_dwordx4 v1, s[24:27], s42 offen offset:0 sc1 lds
    buffer_load_dwordx4 v1, s[24:27], s42 offen offset:1024 sc1 lds
    buffer_load_dwordx4 v1, s[24:27], s42 offen offset:2048 sc1 lds
    buffer_load_dwordx4 v1, s[24:27], s42 offen offset:3072 sc1 lds
.Lnowq_57:
    s_waitcnt vmcnt(0)
    s_barrier
    s_cmp_lg_u32 s41, 0
    s_cbranch_scc1 .Lnowq_58
    s_lshl_b32 s43, s21, 12
    s_mul_i32 s45, s23, 131072
    s_add_u32 s45, s45, s43
    s_add_u32 m0, s43, 81920
    s_add_u32 s42, s45, 81920
    buffer_load_dwordx4 v1, s[24:27], s42 offen offset:0 sc1 lds
    buffer_load_dwordx4 v1, s[24:27], s42 offen offset:1024 sc1 lds
    buffer_load_dwordx4 v1, s[24:27], s42 offen offset:2048 sc1 lds
    buffer_load_dwordx4 v1, s[24:27], s42 offen offset:3072 sc1 lds
    s_add_u32 m0, s43, 98304
    s_add_u32 s42, s45, 98304
    buffer_load_dwordx4 v1, s[24:27], s42 offen offset:0 sc1 lds
    buffer_load_dwordx4 v1, s[24:27], s42 offen offset:1024 sc1 lds
    buffer_load_dwordx4 v1, s[24:27], s42 offen offset:2048 sc1 lds
    buffer_load_dwordx4 v1, s[24:27], s42 offen offset:3072 sc1 lds
.Lnowq_58:
    s_cmp_lg_u32 s41, 0
    s_cbranch_scc1 .Llend_59
    s_barrier
    s_mov_b32 s41, 1
    s_add_u32 s40, s40, 0x2300000
    s_add_u32 s28, s28, 0x2300000
    s_addc_u32 s29, s29, 0
    s_branch .Lltop_4
.Llend_59:
.Ldone_1:
    s_endpgm
.Lcode_end:
.Lslow_15:
    v_mov_b32 v10, 0xff800000
    v_mov_b32 v12, 0xff800000
    s_mov_b32 s43, 0
.Lsl1_60:
    buffer_load_dwordx4 v[64:67], v1, s[28:31], s43 offen offset:0 sc1
    buffer_load_dwordx4 v[68:71], v1, s[28:31], s43 offen offset:1024 sc1
    s_waitcnt vmcnt(0)
    v_mfma_f32_32x32x16_bf16 v[96:111], v[64:67], v[48:51], 0
    v_mfma_f32_32x32x16_bf16 v[96:111], v[68:71], v[52:55], v[96:111]
    v_mfma_f32_32x32x16_bf16 v[112:127], v[64:67], v[56:59], 0
    v_mfma_f32_32x32x16_bf16 v[112:127], v[68:71], v[60:63], v[112:127]
    s_nop 11
    v_max3_f32 v10, v96, v97, v10
    v_max3_f32 v10, v98, v99, v10
    v_max3_f32 v10, v100, v101, v10
    v_max3_f32 v10, v102, v103, v10
    v_max3_f32 v10, v104, v105, v10
    v_max3_f32 v10, v106, v107, v10
    v_max3_f32 v10, v108, v109, v10
    v_max3_f32 v10, v110, v111, v10
    v_max3_f32 v12, v112, v113, v12
    v_max3_f32 v12, v114, v115, v12
    v_max3_f32 v12, v116, v117, v12
    v_max3_f32 v12, v118, v119, v12
    v_max3_f32 v12, v120, v121, v12
    v_max3_f32 v12, v122, v123, v12
    v_max3_f32 v12, v124, v125, v12
    v_max3_f32 v12, v126, v127, v12
    s_add_u32 s43, s43, 4096
    s_cmp_lt_u32 s43, 0x40000
    s_cbranch_scc1 .Lsl1_60
    v_mov_b32 v11, v10
    v_mov_b32 v13, v12
    s_nop 1
    v_permlane32_swap_b32 v10, v11
    v_permlane32_swap_b32 v12, v13
    v_max_f32 v10, v10, v11
    v_max_f32 v12, v12, v13
    v_sub_f32 v128, 0, v10
    v_sub_f32 v129, 0, v10
    v_sub_f32 v130, 0, v10
    v_sub_f32 v131, 0, v10
    v_sub_f32 v132, 0, v10
    v_sub_f32 v133, 0, v10
    v_sub_f32 v134, 0, v10
    v_sub_f32 v135, 0, v10
    v_sub_f32 v136, 0, v10
    v_sub_f32 v137, 0, v10
    v_sub_f32 v138, 0, v10
    v_sub_f32 v139, 0, v10
    v_sub_f32 v140, 0, v10
    v_sub_f32 v141, 0, v10
    v_sub_f32 v142, 0, v10
    v_sub_f32 v143, 0, v10
    v_sub_f32 v160, 0, v12
    v_sub_f32 v161, 0, v12
    v_sub_f32 v162, 0, v12
    v_sub_f32 v163, 0, v12
    v_sub_f32 v164, 0, v12
    v_sub_f32 v165, 0, v12
    v_sub_f32 v166, 0, v12
    v_sub_f32 v167, 0, v12
    v_sub_f32 v168, 0, v12
    v_sub_f32 v169, 0, v12
    v_sub_f32 v170, 0, v12
    v_sub_f32 v171, 0, v12
    v_sub_f32 v172, 0, v12
    v_sub_f32 v173, 0, v12
    v_sub_f32 v174, 0, v12
    v_sub_f32 v175, 0, v12
    v_mov_b32 v16, 0
    v_mov_b32 v17, 0
    v_mov_b32 v18, 0
    v_mov_b32 v19, 0
    v_mov_b32 v20, 0
    v_mov_b32 v21, 0
    v_mov_b32 v22, 0
    v_mov_b32 v23, 0
    v_mov_b32 v24, 0
    v_mov_b32 v25, 0
    v_mov_b32 v26, 0
    v_mov_b32 v27, 0
    v_mov_b32 v28, 0
    v_mov_b32 v29, 0
    v_mov_b32 v30, 0
    v_mov_b32 v31, 0
    v_mov_b32 v32, 0
    v_mov_b32 v33, 0
    v_mov_b32 v34, 0
    v_mov_b32 v35, 0
    v_mov_b32 v36, 0
    v_mov_b32 v37, 0
    v_mov_b32 v38, 0
    v_mov_b32 v39, 0
    v_mov_b32 v40, 0
    v_mov_b32 v41, 0
    v_mov_b32 v42, 0
    v_mov_b32 v43, 0
    v_mov_b32 v44, 0
    v_mov_b32 v45, 0
    v_mov_b32 v46, 0
    v_mov_b32 v47, 0
    v_mov_b32 v144, 0
    v_mov_b32 v145, 0
    v_mov_b32 v146, 0
    v_mov_b32 v147, 0
    v_mov_b32 v148, 0
    v_mov_b32 v149, 0
    v_mov_b32 v150, 0
    v_mov_b32 v151, 0
    s_mov_b32 s43, 0
.Lsl2_61:
    buffer_load_dwordx4 v[64:67], v1, s[28:31], s43 offen offset:0 sc1
    buffer_load_dwordx4 v[80:83], v1, s[28:31], s43 offen offset:2048 sc1
    buffer_load_dwordx4 v[68:71], v1, s[28:31], s43 offen offset:1024 sc1
    buffer_load_dwordx4 v[84:87], v1, s[28:31], s43 offen offset:3072 sc1
    s_waitcnt vmcnt(0)
    v_mfma_f32_32x32x16_bf16 v[96:111], v[64:67], v[48:51], v[128:143]
    v_mfma_f32_32x32x16_bf16 v[96:111], v[68:71], v[52:55], v[96:111]
    v_mfma_f32_32x32x16_bf16 v[112:127], v[64:67], v[56:59], v[160:175]
    v_mfma_f32_32x32x16_bf16 v[112:127], v[68:71], v[60:63], v[112:127]
    s_nop 11
    v_exp_f32 v96, v96
    v_exp_f32 v97, v97
    v_exp_f32 v98, v98
    v_exp_f32 v99, v99
    v_exp_f32 v100, v100
    v_exp_f32 v101, v101
    v_exp_f32 v102, v102
    v_exp_f32 v103, v103
    v_exp_f32 v104, v104
    v_exp_f32 v105, v105
    v_exp_f32 v106, v106
    v_exp_f32 v107, v107
    v_exp_f32 v108, v108
    v_exp_f32 v109, v109
    v_exp_f32 v110, v110
    v_exp_f32 v111, v111
    v_exp_f32 v112, v112
    v_exp_f32 v113, v113
    v_exp_f32 v114, v114
    v_exp_f32 v115, v115
    v_exp_f32 v116, v116
    v_exp_f32 v117, v117
    v_exp_f32 v118, v118
    v_exp_f32 v119, v119
    v_exp_f32 v120, v120
    v_exp_f32 v121, v121
    v_exp_f32 v122, v122
    v_exp_f32 v123, v123
    v_exp_f32 v124, v124
    v_exp_f32 v125, v125
    v_exp_f32 v126, v126
    v_exp_f32 v127, v127
    s_nop 1
    v_smfmac_f32_32x32x32_bf16 v[16:31], v[80:83], v[96:103], v7
    v_smfmac_f32_16x16x64_bf16 v[144:147], v[152:155], v[96:103], v7
    v_smfmac_f32_32x32x32_bf16 v[16:31], v[84:87], v[104:111], v7
    v_smfmac_f32_16x16x64_bf16 v[144:147], v[152:155], v[104:111], v7
    v_smfmac_f32_32x32x32_bf16 v[32:47], v[80:83], v[112:119], v7
    v_smfmac_f32_16x16x64_bf16 v[148:151], v[152:155], v[112:119], v7
    v_smfmac_f32_32x32x32_bf16 v[32:47], v[84:87], v[120:127], v7
    v_smfmac_f32_16x16x64_bf16 v[148:151], v[152:155], v[120:127], v7
    s_add_u32 s43, s43, 4096
    s_cmp_lt_u32 s43, 0x40000
    s_cbranch_scc1 .Lsl2_61
    s_nop 11
    v_mov_b32 v145, v144
    v_mov_b32 v149, v148
    s_nop 0
    v_permlane32_swap_b32 v144, v145
    v_permlane32_swap_b32 v148, v149
    s_branch .Lback_16
.section .rodata,"a"
.p2align 6
.amdhsa_kernel interleave_layers__grouped_kv_mqa__mixer_channel_mlp__prompt_kernel
  .amdhsa_next_free_vgpr 256
  .amdhsa_next_free_sgpr 102
  .amdhsa_accum_offset 256
  .amdhsa_group_segment_fixed_size 0
  .amdhsa_kernarg_size 104
  .amdhsa_user_sgpr_count 2
  .amdhsa_user_sgpr_kernarg_segment_ptr 1
  .amdhsa_system_sgpr_workgroup_id_x 1
.end_amdhsa_kernel
```
